```python
import torch

def _softmax(x, axis=-1):
    return torch.softmax(x, dim=axis)
def _gelu(x):
    return torch.nn.functional.gelu(x, approximate="tanh")
def _silu(x):
    return torch.nn.functional.silu(x)
def _sigmoid(x):
    return torch.sigmoid(x)
def _layernorm(x, axis=-1, eps=1e-5):
    m = x.mean(dim=axis, keepdim=True)
    v = x.var(dim=axis, keepdim=True, unbiased=False)
    return (x - m) / torch.sqrt(v + eps)
def _scatter_add(tgt, idx, src, axis=0):
    return tgt.clone().index_add_(axis, idx, src)
def _segment_sum(src, seg, n):
    out = torch.zeros((n,) + src.shape[1:], dtype=src.dtype)
    return out.index_add_(0, seg, src)
def _pad(x, pw):
    flat = tuple(v for pair in reversed(pw) for v in pair)
    return torch.nn.functional.pad(x, flat)

kernel_name = 'concat_heads__mha_block__sliding_block__prompt'

def setup_inputs():

    _w = (lambda a: (lambda t: t.to(torch.bfloat16) if t.is_floating_point() else t)(torch.as_tensor(a)))
    def _A_setup():
        B, S, D, H = 1, 2048, 576, 32
        return {
            "x": _w((lambda *s: torch.randn(*s, dtype=torch.bfloat16) * 0.2)(B, S, D)),
            "wqkv": _w((lambda *s: torch.randn(*s, dtype=torch.bfloat16) * 0.4)(D, 3 * D)),
            "wo": _w((lambda *s: torch.randn(*s, dtype=torch.bfloat16) * 0.1)(D, D)),
        }
    _A_in = _A_setup()

    def _B_setup():
        B, S, D = 1, 2048, 576
        return {
            "x": _w((lambda *s: torch.randn(*s, dtype=torch.bfloat16) * 0.4)(B, S, D)),
            "wqkv": _w((lambda *s: torch.randn(*s, dtype=torch.bfloat16) * 0.4)(D, 3 * D)),
            "wo": _w((lambda *s: torch.randn(*s, dtype=torch.bfloat16) * 0.05)(D, D)),
        }
    _B_in = _B_setup()

    return {
        "A_x": _A_in["x"],
        "A_wqkv": _A_in["wqkv"],
        "A_wo": _A_in["wo"],
        "B_x": _B_in["x"],
        "B_wqkv": _B_in["wqkv"],
        "B_wo": _B_in["wo"],
    }

def reference(A_x, A_wqkv, A_wo, B_x, B_wqkv, B_wo):
    def _A_ref(x, wqkv, wo):
        B, S, D = x.shape
        H = 32
        Dh = D // H
        qkv = (lambda x, *d: x.permute(*d))((x @ wqkv).reshape(B, S, 3, H, Dh), 2, 0, 3, 1, 4)
        q, k, v = qkv[0], qkv[1], qkv[2]
        scores = torch.einsum("bhqd,bhkd->bhqk", q, k) * (Dh ** -0.5)
        p = _softmax(scores, axis=-1)
        o = torch.einsum("bhqk,bhkd->bhqd", p, v)
        return (lambda x, *d: x.permute(*d))(o, 0, 2, 1, 3).reshape(B, S, D) @ wo

    def _B_ref(x, wqkv, wo):
        B, S, D = x.shape
        H = 32; Dh = D // H; W = 256
        qkv = (lambda x, *d: x.permute(*d))((x @ wqkv).reshape(B, S, 3, H, Dh), 2, 0, 3, 1, 4)
        q, k, v = qkv[0], qkv[1], qkv[2]
        scores = torch.einsum("bhqd,bhkd->bhqk", q, k) * (Dh ** -0.5)
        idx = torch.arange(S)
        mask = (idx[:, None] - idx[None, :] >= 0) & (idx[:, None] - idx[None, :] < W)
        scores = torch.where(mask[None, None], scores, -1e9)
        p = _softmax(scores, axis=-1)
        o = torch.einsum("bhqk,bhkd->bhqd", p, v)
        return (lambda x, *d: x.permute(*d))(o, 0, 2, 1, 3).reshape(B, S, D) @ wo

    a = _A_ref(A_x, A_wqkv, A_wo)
    b = _B_ref(B_x, B_wqkv, B_wo)
    return torch.concatenate([a, b], axis=-1)
```

```asm
; @launch kernel=qkv_kernel grid=(256,1,1) block=(512,1,1) lds=159744
; @launch kernel=attn_kernel grid=(512,1,1) block=(256,1,1) lds=65664
; @launch kernel=proj_kernel grid=(256,1,1) block=(256,1,1) lds=82944
.amdgcn_target "amdgcn-amd-amdhsa--gfx950"
.text
.globl qkv_kernel
    .p2align 8
    .type qkv_kernel,@function
qkv_kernel:
    s_cmp_ge_u32 s2, 256
    s_cbranch_scc1 K1_END
    s_load_dwordx4 s[4:7], s[0:1], 0
    s_load_dwordx4 s[8:11], s[0:1], 24
    v_lshrrev_b32 v1, 6, v0
    s_bfe_u32 s12, s2, 0x10002
    v_readfirstlane_b32 s3, v1
    s_and_b32 s15, s2, 1
    s_bfe_u32 s16, s2, 0x10001
    s_bfe_u32 s13, s2, 0x30003
    s_lshl_b32 s15, s15, 3
    s_or_b32 s13, s13, s15
    s_bfe_u32 s14, s2, 0x20006
    s_lshl_b32 s16, s16, 2
    s_or_b32 s14, s14, s16
    s_cmp_lt_u32 s3, 4
    s_cbranch_scc1 K1_CONS
    s_cmp_ge_u32 s3, 6
    s_cbranch_scc1 K1_LOADER1
    s_setprio 3
    v_and_b32 v0, 63, v0
    s_sub_u32 s3, s3, 4
    v_lshrrev_b32 v10, 3, v0
    s_lshl_b32 s16, s13, 7
    s_lshl_b32 s17, s3, 3
    s_add_u32 s16, s16, s17
    v_add_u32 v10, s16, v10
    v_bfe_u32 v11, v10, 1, 3
    v_mul_u32_u24 v10, 1152, v10
    v_and_b32 v12, 7, v0
    v_xor_b32 v11, v11, v12
    v_lshl_add_u32 v6, v11, 4, v10
    s_mul_i32 s15, s14, 144
    s_and_b32 s39, s15, 63
    s_andn2_b32 s41, s15, 63
    s_add_u32 s40, s39, 144
    s_lshl_b32 s16, s3, 10
    s_add_u32 s30, s16, 0
    s_add_u32 s31, s16, 4096
    s_add_u32 s32, s16, 8192
    s_add_u32 s33, s16, 12288
    s_add_u32 s34, s16, 16384
    s_add_u32 s35, s16, 110592
    s_waitcnt lgkmcnt(0)
    s_cmp_eq_u32 s12, 0
    s_cselect_b32 s20, s4, s8
    s_cselect_b32 s21, s5, s9
    s_cselect_b32 s24, s6, s10
    s_cselect_b32 s25, s7, s11
    s_and_b32 s21, s21, 0xffff
    s_and_b32 s25, s25, 0xffff
    s_mov_b32 s22, 2359296
    s_mov_b32 s23, 0x00020000
    s_mov_b32 s26, 1990656
    s_mov_b32 s27, 0x00020000
    s_bfe_u32 s15, s2, 0x30003
    s_lshl_b32 s15, s15, 2
    s_lshr_b32 s15, 0x76543210, s15
    s_and_b32 s15, s15, 15
    s_bfe_u32 s16, s2, 0x20006
    s_lshl_b32 s16, s16, 2
    s_lshr_b32 s16, 0x7520, s16
    s_and_b32 s16, s16, 15
    s_add_u32 s51, s15, s16
    s_cmp_ge_u32 s51, 9
    s_cselect_b32 s15, 9, 0
    s_sub_u32 s51, s51, s15
    s_lshl_b32 s51, s51, 1
    s_lshr_b32 s52, s51, 1
    s_lshl_b32 s38, s52, 7
    s_add_u32 s52, s52, 1
    s_cmp_eq_u32 s52, 9
    s_cselect_b32 s52, 0, s52
    s_add_u32 m0, s35, 0
    s_nop 0
    buffer_load_dwordx4 v6, s[20:23], s38 offen  lds
    s_add_u32 m0, s35, 4096
    s_add_u32 s38, s38, 36864
    buffer_load_dwordx4 v6, s[20:23], s38 offen  lds
    s_add_u32 m0, s35, 8192
    s_add_u32 s38, s38, 36864
    buffer_load_dwordx4 v6, s[20:23], s38 offen  lds
    s_add_u32 m0, s35, 12288
    s_add_u32 s38, s38, 36864
    buffer_load_dwordx4 v6, s[20:23], s38 offen  lds
    s_mul_i32 s37, s51, 110592
    s_add_u32 s51, s51, 1
    s_cmp_eq_u32 s51, 18
    s_cselect_b32 s51, 0, s51
    s_lshl_b32 s16, s3, 6
    s_add_u32 s16, s16, 0
    v_add_u32 v10, s16, v0
    v_mul_u32_u24 v11, 1821, v10
    v_lshrrev_b32 v11, 16, v11
    v_mul_u32_u24 v12, 36, v11
    v_sub_u32 v12, v10, v12
    v_lshrrev_b32 v13, 2, v11
    v_and_b32 v13, 2, v13
    v_xor_b32 v12, v12, v13
    v_mul_u32_u24 v13, 43, v12
    v_lshrrev_b32 v13, 9, v13
    v_mul_u32_u24 v14, 12, v13
    v_sub_u32 v14, v12, v14
    v_lshlrev_b32 v14, 4, v14
    v_mul_u32_u24 v13, 1152, v13
    v_mul_u32_u24 v15, 3456, v11
    v_add3_u32 v15, v15, v13, v14
    v_add_u32 v15, s41, v15
    v_cmp_le_u32 vcc, s39, v14
    v_cmp_gt_u32 s[42:43], s40, v14
    v_bfrev_b32 v17, 1
    s_and_b64 vcc, vcc, s[42:43]
    s_nop 1
    v_cndmask_b32 v1, v17, v15, vcc
    s_add_u32 m0, s30, 0
    s_nop 0
    buffer_load_dwordx4 v1, s[24:27], s37 offen  lds
    s_lshl_b32 s16, s3, 6
    s_add_u32 s16, s16, 256
    v_add_u32 v10, s16, v0
    v_mul_u32_u24 v11, 1821, v10
    v_lshrrev_b32 v11, 16, v11
    v_mul_u32_u24 v12, 36, v11
    v_sub_u32 v12, v10, v12
    v_lshrrev_b32 v13, 2, v11
    v_and_b32 v13, 2, v13
    v_xor_b32 v12, v12, v13
    v_mul_u32_u24 v13, 43, v12
    v_lshrrev_b32 v13, 9, v13
    v_mul_u32_u24 v14, 12, v13
    v_sub_u32 v14, v12, v14
    v_lshlrev_b32 v14, 4, v14
    v_mul_u32_u24 v13, 1152, v13
    v_mul_u32_u24 v15, 3456, v11
    v_add3_u32 v15, v15, v13, v14
    v_add_u32 v15, s41, v15
    v_cmp_le_u32 vcc, s39, v14
    v_cmp_gt_u32 s[42:43], s40, v14
    v_bfrev_b32 v17, 1
    s_and_b64 vcc, vcc, s[42:43]
    s_nop 1
    v_cndmask_b32 v2, v17, v15, vcc
    s_add_u32 m0, s31, 0
    s_nop 0
    buffer_load_dwordx4 v2, s[24:27], s37 offen  lds
    s_lshl_b32 s16, s3, 6
    s_add_u32 s16, s16, 512
    v_add_u32 v10, s16, v0
    v_mul_u32_u24 v11, 1821, v10
    v_lshrrev_b32 v11, 16, v11
    v_mul_u32_u24 v12, 36, v11
    v_sub_u32 v12, v10, v12
    v_lshrrev_b32 v13, 2, v11
    v_and_b32 v13, 2, v13
    v_xor_b32 v12, v12, v13
    v_mul_u32_u24 v13, 43, v12
    v_lshrrev_b32 v13, 9, v13
    v_mul_u32_u24 v14, 12, v13
    v_sub_u32 v14, v12, v14
    v_lshlrev_b32 v14, 4, v14
    v_mul_u32_u24 v13, 1152, v13
    v_mul_u32_u24 v15, 3456, v11
    v_add3_u32 v15, v15, v13, v14
    v_add_u32 v15, s41, v15
    v_cmp_le_u32 vcc, s39, v14
    v_cmp_gt_u32 s[42:43], s40, v14
    v_bfrev_b32 v17, 1
    s_and_b64 vcc, vcc, s[42:43]
    s_nop 1
    v_cndmask_b32 v3, v17, v15, vcc
    s_add_u32 m0, s32, 0
    s_nop 0
    buffer_load_dwordx4 v3, s[24:27], s37 offen  lds
    s_lshl_b32 s16, s3, 6
    s_add_u32 s16, s16, 768
    v_add_u32 v10, s16, v0
    v_mul_u32_u24 v11, 1821, v10
    v_lshrrev_b32 v11, 16, v11
    v_mul_u32_u24 v12, 36, v11
    v_sub_u32 v12, v10, v12
    v_lshrrev_b32 v13, 2, v11
    v_and_b32 v13, 2, v13
    v_xor_b32 v12, v12, v13
    v_mul_u32_u24 v13, 43, v12
    v_lshrrev_b32 v13, 9, v13
    v_mul_u32_u24 v14, 12, v13
    v_sub_u32 v14, v12, v14
    v_lshlrev_b32 v14, 4, v14
    v_mul_u32_u24 v13, 1152, v13
    v_mul_u32_u24 v15, 3456, v11
    v_add3_u32 v15, v15, v13, v14
    v_add_u32 v15, s41, v15
    v_cmp_le_u32 vcc, s39, v14
    v_cmp_gt_u32 s[42:43], s40, v14
    v_bfrev_b32 v17, 1
    s_and_b64 vcc, vcc, s[42:43]
    s_nop 1
    v_cndmask_b32 v4, v17, v15, vcc
    s_add_u32 m0, s33, 0
    s_nop 0
    buffer_load_dwordx4 v4, s[24:27], s37 offen  lds
    s_lshl_b32 s16, s3, 6
    s_add_u32 s16, s16, 1024
    v_add_u32 v10, s16, v0
    v_mul_u32_u24 v11, 1821, v10
    v_lshrrev_b32 v11, 16, v11
    v_mul_u32_u24 v12, 36, v11
    v_sub_u32 v12, v10, v12
    v_lshrrev_b32 v13, 2, v11
    v_and_b32 v13, 2, v13
    v_xor_b32 v12, v12, v13
    v_mul_u32_u24 v13, 43, v12
    v_lshrrev_b32 v13, 9, v13
    v_mul_u32_u24 v14, 12, v13
    v_sub_u32 v14, v12, v14
    v_lshlrev_b32 v14, 4, v14
    v_mul_u32_u24 v13, 1152, v13
    v_mul_u32_u24 v15, 3456, v11
    v_add3_u32 v15, v15, v13, v14
    v_add_u32 v15, s41, v15
    v_cmp_le_u32 vcc, s39, v14
    v_cmp_gt_u32 s[42:43], s40, v14
    v_bfrev_b32 v17, 1
    s_and_b64 vcc, vcc, s[42:43]
    s_nop 1
    v_cndmask_b32 v5, v17, v15, vcc
    s_add_u32 m0, s34, 0
    s_nop 0
    buffer_load_dwordx4 v5, s[24:27], s37 offen  lds
    s_mul_i32 s37, s51, 110592
    s_add_u32 s51, s51, 1
    s_cmp_eq_u32 s51, 18
    s_cselect_b32 s51, 0, s51
    s_add_u32 m0, s30, 18432
    s_nop 0
    buffer_load_dwordx4 v1, s[24:27], s37 offen  lds
    s_add_u32 m0, s31, 18432
    s_nop 0
    buffer_load_dwordx4 v2, s[24:27], s37 offen  lds
    s_add_u32 m0, s32, 18432
    s_nop 0
    buffer_load_dwordx4 v3, s[24:27], s37 offen  lds
    s_add_u32 m0, s33, 18432
    s_nop 0
    buffer_load_dwordx4 v4, s[24:27], s37 offen  lds
    s_add_u32 m0, s34, 18432
    s_nop 0
    buffer_load_dwordx4 v5, s[24:27], s37 offen  lds
    s_lshl_b32 s38, s52, 7
    s_add_u32 s52, s52, 1
    s_cmp_eq_u32 s52, 9
    s_cselect_b32 s52, 0, s52
    s_add_u32 m0, s35, 16384
    s_nop 0
    buffer_load_dwordx4 v6, s[20:23], s38 offen  lds
    s_add_u32 m0, s35, 20480
    s_add_u32 s38, s38, 36864
    buffer_load_dwordx4 v6, s[20:23], s38 offen  lds
    s_add_u32 m0, s35, 24576
    s_add_u32 s38, s38, 36864
    buffer_load_dwordx4 v6, s[20:23], s38 offen  lds
    s_add_u32 m0, s35, 28672
    s_add_u32 s38, s38, 36864
    buffer_load_dwordx4 v6, s[20:23], s38 offen  lds
    s_mul_i32 s37, s51, 110592
    s_add_u32 s51, s51, 1
    s_cmp_eq_u32 s51, 18
    s_cselect_b32 s51, 0, s51
    s_add_u32 m0, s30, 36864
    s_nop 0
    buffer_load_dwordx4 v1, s[24:27], s37 offen  lds
    s_add_u32 m0, s31, 36864
    s_nop 0
    buffer_load_dwordx4 v2, s[24:27], s37 offen  lds
    s_add_u32 m0, s32, 36864
    s_nop 0
    buffer_load_dwordx4 v3, s[24:27], s37 offen  lds
    s_add_u32 m0, s33, 36864
    s_nop 0
    buffer_load_dwordx4 v4, s[24:27], s37 offen  lds
    s_add_u32 m0, s34, 36864
    s_nop 0
    buffer_load_dwordx4 v5, s[24:27], s37 offen  lds
    s_waitcnt vmcnt(14)
    s_barrier
    s_mul_i32 s37, s51, 110592
    s_add_u32 s51, s51, 1
    s_cmp_eq_u32 s51, 18
    s_cselect_b32 s51, 0, s51
    s_add_u32 m0, s30, 55296
    s_nop 0
    buffer_load_dwordx4 v1, s[24:27], s37 offen  lds
    s_add_u32 m0, s31, 55296
    s_nop 0
    buffer_load_dwordx4 v2, s[24:27], s37 offen  lds
    s_add_u32 m0, s32, 55296
    s_nop 0
    buffer_load_dwordx4 v3, s[24:27], s37 offen  lds
    s_add_u32 m0, s33, 55296
    s_nop 0
    buffer_load_dwordx4 v4, s[24:27], s37 offen  lds
    s_add_u32 m0, s34, 55296
    s_nop 0
    buffer_load_dwordx4 v5, s[24:27], s37 offen  lds
    s_lshl_b32 s38, s52, 7
    s_add_u32 s52, s52, 1
    s_cmp_eq_u32 s52, 9
    s_cselect_b32 s52, 0, s52
    s_add_u32 m0, s35, 32768
    s_nop 0
    buffer_load_dwordx4 v6, s[20:23], s38 offen  lds
    s_add_u32 m0, s35, 36864
    s_add_u32 s38, s38, 36864
    buffer_load_dwordx4 v6, s[20:23], s38 offen  lds
    s_add_u32 m0, s35, 40960
    s_add_u32 s38, s38, 36864
    buffer_load_dwordx4 v6, s[20:23], s38 offen  lds
    s_add_u32 m0, s35, 45056
    s_add_u32 s38, s38, 36864
    buffer_load_dwordx4 v6, s[20:23], s38 offen  lds
    s_mul_i32 s37, s51, 110592
    s_add_u32 s51, s51, 1
    s_cmp_eq_u32 s51, 18
    s_cselect_b32 s51, 0, s51
    s_add_u32 m0, s30, 73728
    s_nop 0
    buffer_load_dwordx4 v1, s[24:27], s37 offen  lds
    s_add_u32 m0, s31, 73728
    s_nop 0
    buffer_load_dwordx4 v2, s[24:27], s37 offen  lds
    s_add_u32 m0, s32, 73728
    s_nop 0
    buffer_load_dwordx4 v3, s[24:27], s37 offen  lds
    s_add_u32 m0, s33, 73728
    s_nop 0
    buffer_load_dwordx4 v4, s[24:27], s37 offen  lds
    s_add_u32 m0, s34, 73728
    s_nop 0
    buffer_load_dwordx4 v5, s[24:27], s37 offen  lds
    s_waitcnt vmcnt(23)
    s_barrier
    s_mul_i32 s37, s51, 110592
    s_add_u32 s51, s51, 1
    s_cmp_eq_u32 s51, 18
    s_cselect_b32 s51, 0, s51
    s_add_u32 m0, s30, 92160
    s_nop 0
    buffer_load_dwordx4 v1, s[24:27], s37 offen  lds
    s_add_u32 m0, s31, 92160
    s_nop 0
    buffer_load_dwordx4 v2, s[24:27], s37 offen  lds
    s_add_u32 m0, s32, 92160
    s_nop 0
    buffer_load_dwordx4 v3, s[24:27], s37 offen  lds
    s_add_u32 m0, s33, 92160
    s_nop 0
    buffer_load_dwordx4 v4, s[24:27], s37 offen  lds
    s_add_u32 m0, s34, 92160
    s_nop 0
    buffer_load_dwordx4 v5, s[24:27], s37 offen  lds
    s_mul_i32 s37, s51, 110592
    s_add_u32 s51, s51, 1
    s_cmp_eq_u32 s51, 18
    s_cselect_b32 s51, 0, s51
    s_add_u32 m0, s30, 0
    s_nop 0
    buffer_load_dwordx4 v1, s[24:27], s37 offen  lds
    s_add_u32 m0, s31, 0
    s_nop 0
    buffer_load_dwordx4 v2, s[24:27], s37 offen  lds
    s_add_u32 m0, s32, 0
    s_nop 0
    buffer_load_dwordx4 v3, s[24:27], s37 offen  lds
    s_add_u32 m0, s33, 0
    s_nop 0
    buffer_load_dwordx4 v4, s[24:27], s37 offen  lds
    s_add_u32 m0, s34, 0
    s_nop 0
    buffer_load_dwordx4 v5, s[24:27], s37 offen  lds
    s_waitcnt vmcnt(24)
    s_barrier
    s_lshl_b32 s38, s52, 7
    s_add_u32 s52, s52, 1
    s_cmp_eq_u32 s52, 9
    s_cselect_b32 s52, 0, s52
    s_add_u32 m0, s35, 0
    s_nop 0
    buffer_load_dwordx4 v6, s[20:23], s38 offen  lds
    s_add_u32 m0, s35, 4096
    s_add_u32 s38, s38, 36864
    buffer_load_dwordx4 v6, s[20:23], s38 offen  lds
    s_add_u32 m0, s35, 8192
    s_add_u32 s38, s38, 36864
    buffer_load_dwordx4 v6, s[20:23], s38 offen  lds
    s_add_u32 m0, s35, 12288
    s_add_u32 s38, s38, 36864
    buffer_load_dwordx4 v6, s[20:23], s38 offen  lds
    s_mul_i32 s37, s51, 110592
    s_add_u32 s51, s51, 1
    s_cmp_eq_u32 s51, 18
    s_cselect_b32 s51, 0, s51
    s_add_u32 m0, s30, 18432
    s_nop 0
    buffer_load_dwordx4 v1, s[24:27], s37 offen  lds
    s_add_u32 m0, s31, 18432
    s_nop 0
    buffer_load_dwordx4 v2, s[24:27], s37 offen  lds
    s_add_u32 m0, s32, 18432
    s_nop 0
    buffer_load_dwordx4 v3, s[24:27], s37 offen  lds
    s_add_u32 m0, s33, 18432
    s_nop 0
    buffer_load_dwordx4 v4, s[24:27], s37 offen  lds
    s_add_u32 m0, s34, 18432
    s_nop 0
    buffer_load_dwordx4 v5, s[24:27], s37 offen  lds
    s_waitcnt vmcnt(28)
    s_barrier
    s_mul_i32 s37, s51, 110592
    s_add_u32 s51, s51, 1
    s_cmp_eq_u32 s51, 18
    s_cselect_b32 s51, 0, s51
    s_add_u32 m0, s30, 36864
    s_nop 0
    buffer_load_dwordx4 v1, s[24:27], s37 offen  lds
    s_add_u32 m0, s31, 36864
    s_nop 0
    buffer_load_dwordx4 v2, s[24:27], s37 offen  lds
    s_add_u32 m0, s32, 36864
    s_nop 0
    buffer_load_dwordx4 v3, s[24:27], s37 offen  lds
    s_add_u32 m0, s33, 36864
    s_nop 0
    buffer_load_dwordx4 v4, s[24:27], s37 offen  lds
    s_add_u32 m0, s34, 36864
    s_nop 0
    buffer_load_dwordx4 v5, s[24:27], s37 offen  lds
    s_waitcnt vmcnt(24)
    s_barrier
    s_lshl_b32 s38, s52, 7
    s_add_u32 s52, s52, 1
    s_cmp_eq_u32 s52, 9
    s_cselect_b32 s52, 0, s52
    s_add_u32 m0, s35, 16384
    s_nop 0
    buffer_load_dwordx4 v6, s[20:23], s38 offen  lds
    s_add_u32 m0, s35, 20480
    s_add_u32 s38, s38, 36864
    buffer_load_dwordx4 v6, s[20:23], s38 offen  lds
    s_add_u32 m0, s35, 24576
    s_add_u32 s38, s38, 36864
    buffer_load_dwordx4 v6, s[20:23], s38 offen  lds
    s_add_u32 m0, s35, 28672
    s_add_u32 s38, s38, 36864
    buffer_load_dwordx4 v6, s[20:23], s38 offen  lds
    s_mul_i32 s37, s51, 110592
    s_add_u32 s51, s51, 1
    s_cmp_eq_u32 s51, 18
    s_cselect_b32 s51, 0, s51
    s_add_u32 m0, s30, 55296
    s_nop 0
    buffer_load_dwordx4 v1, s[24:27], s37 offen  lds
    s_add_u32 m0, s31, 55296
    s_nop 0
    buffer_load_dwordx4 v2, s[24:27], s37 offen  lds
    s_add_u32 m0, s32, 55296
    s_nop 0
    buffer_load_dwordx4 v3, s[24:27], s37 offen  lds
    s_add_u32 m0, s33, 55296
    s_nop 0
    buffer_load_dwordx4 v4, s[24:27], s37 offen  lds
    s_add_u32 m0, s34, 55296
    s_nop 0
    buffer_load_dwordx4 v5, s[24:27], s37 offen  lds
    s_waitcnt vmcnt(28)
    s_barrier
    s_mul_i32 s37, s51, 110592
    s_add_u32 s51, s51, 1
    s_cmp_eq_u32 s51, 18
    s_cselect_b32 s51, 0, s51
    s_add_u32 m0, s30, 73728
    s_nop 0
    buffer_load_dwordx4 v1, s[24:27], s37 offen  lds
    s_add_u32 m0, s31, 73728
    s_nop 0
    buffer_load_dwordx4 v2, s[24:27], s37 offen  lds
    s_add_u32 m0, s32, 73728
    s_nop 0
    buffer_load_dwordx4 v3, s[24:27], s37 offen  lds
    s_add_u32 m0, s33, 73728
    s_nop 0
    buffer_load_dwordx4 v4, s[24:27], s37 offen  lds
    s_add_u32 m0, s34, 73728
    s_nop 0
    buffer_load_dwordx4 v5, s[24:27], s37 offen  lds
    s_waitcnt vmcnt(24)
    s_barrier
    s_lshl_b32 s38, s52, 7
    s_add_u32 s52, s52, 1
    s_cmp_eq_u32 s52, 9
    s_cselect_b32 s52, 0, s52
    s_add_u32 m0, s35, 32768
    s_nop 0
    buffer_load_dwordx4 v6, s[20:23], s38 offen  lds
    s_add_u32 m0, s35, 36864
    s_add_u32 s38, s38, 36864
    buffer_load_dwordx4 v6, s[20:23], s38 offen  lds
    s_add_u32 m0, s35, 40960
    s_add_u32 s38, s38, 36864
    buffer_load_dwordx4 v6, s[20:23], s38 offen  lds
    s_add_u32 m0, s35, 45056
    s_add_u32 s38, s38, 36864
    buffer_load_dwordx4 v6, s[20:23], s38 offen  lds
    s_mul_i32 s37, s51, 110592
    s_add_u32 s51, s51, 1
    s_cmp_eq_u32 s51, 18
    s_cselect_b32 s51, 0, s51
    s_add_u32 m0, s30, 92160
    s_nop 0
    buffer_load_dwordx4 v1, s[24:27], s37 offen  lds
    s_add_u32 m0, s31, 92160
    s_nop 0
    buffer_load_dwordx4 v2, s[24:27], s37 offen  lds
    s_add_u32 m0, s32, 92160
    s_nop 0
    buffer_load_dwordx4 v3, s[24:27], s37 offen  lds
    s_add_u32 m0, s33, 92160
    s_nop 0
    buffer_load_dwordx4 v4, s[24:27], s37 offen  lds
    s_add_u32 m0, s34, 92160
    s_nop 0
    buffer_load_dwordx4 v5, s[24:27], s37 offen  lds
    s_waitcnt vmcnt(28)
    s_barrier
    s_mul_i32 s37, s51, 110592
    s_add_u32 s51, s51, 1
    s_cmp_eq_u32 s51, 18
    s_cselect_b32 s51, 0, s51
    s_add_u32 m0, s30, 0
    s_nop 0
    buffer_load_dwordx4 v1, s[24:27], s37 offen  lds
    s_add_u32 m0, s31, 0
    s_nop 0
    buffer_load_dwordx4 v2, s[24:27], s37 offen  lds
    s_add_u32 m0, s32, 0
    s_nop 0
    buffer_load_dwordx4 v3, s[24:27], s37 offen  lds
    s_add_u32 m0, s33, 0
    s_nop 0
    buffer_load_dwordx4 v4, s[24:27], s37 offen  lds
    s_add_u32 m0, s34, 0
    s_nop 0
    buffer_load_dwordx4 v5, s[24:27], s37 offen  lds
    s_waitcnt vmcnt(24)
    s_barrier
    s_lshl_b32 s38, s52, 7
    s_add_u32 s52, s52, 1
    s_cmp_eq_u32 s52, 9
    s_cselect_b32 s52, 0, s52
    s_add_u32 m0, s35, 0
    s_nop 0
    buffer_load_dwordx4 v6, s[20:23], s38 offen  lds
    s_add_u32 m0, s35, 4096
    s_add_u32 s38, s38, 36864
    buffer_load_dwordx4 v6, s[20:23], s38 offen  lds
    s_add_u32 m0, s35, 8192
    s_add_u32 s38, s38, 36864
    buffer_load_dwordx4 v6, s[20:23], s38 offen  lds
    s_add_u32 m0, s35, 12288
    s_add_u32 s38, s38, 36864
    buffer_load_dwordx4 v6, s[20:23], s38 offen  lds
    s_mul_i32 s37, s51, 110592
    s_add_u32 s51, s51, 1
    s_cmp_eq_u32 s51, 18
    s_cselect_b32 s51, 0, s51
    s_add_u32 m0, s30, 18432
    s_nop 0
    buffer_load_dwordx4 v1, s[24:27], s37 offen  lds
    s_add_u32 m0, s31, 18432
    s_nop 0
    buffer_load_dwordx4 v2, s[24:27], s37 offen  lds
    s_add_u32 m0, s32, 18432
    s_nop 0
    buffer_load_dwordx4 v3, s[24:27], s37 offen  lds
    s_add_u32 m0, s33, 18432
    s_nop 0
    buffer_load_dwordx4 v4, s[24:27], s37 offen  lds
    s_add_u32 m0, s34, 18432
    s_nop 0
    buffer_load_dwordx4 v5, s[24:27], s37 offen  lds
    s_waitcnt vmcnt(28)
    s_barrier
    s_mul_i32 s37, s51, 110592
    s_add_u32 s51, s51, 1
    s_cmp_eq_u32 s51, 18
    s_cselect_b32 s51, 0, s51
    s_add_u32 m0, s30, 36864
    s_nop 0
    buffer_load_dwordx4 v1, s[24:27], s37 offen  lds
    s_add_u32 m0, s31, 36864
    s_nop 0
    buffer_load_dwordx4 v2, s[24:27], s37 offen  lds
    s_add_u32 m0, s32, 36864
    s_nop 0
    buffer_load_dwordx4 v3, s[24:27], s37 offen  lds
    s_add_u32 m0, s33, 36864
    s_nop 0
    buffer_load_dwordx4 v4, s[24:27], s37 offen  lds
    s_add_u32 m0, s34, 36864
    s_nop 0
    buffer_load_dwordx4 v5, s[24:27], s37 offen  lds
    s_waitcnt vmcnt(24)
    s_barrier
    s_lshl_b32 s38, s52, 7
    s_add_u32 s52, s52, 1
    s_cmp_eq_u32 s52, 9
    s_cselect_b32 s52, 0, s52
    s_add_u32 m0, s35, 16384
    s_nop 0
    buffer_load_dwordx4 v6, s[20:23], s38 offen  lds
    s_add_u32 m0, s35, 20480
    s_add_u32 s38, s38, 36864
    buffer_load_dwordx4 v6, s[20:23], s38 offen  lds
    s_add_u32 m0, s35, 24576
    s_add_u32 s38, s38, 36864
    buffer_load_dwordx4 v6, s[20:23], s38 offen  lds
    s_add_u32 m0, s35, 28672
    s_add_u32 s38, s38, 36864
    buffer_load_dwordx4 v6, s[20:23], s38 offen  lds
    s_mul_i32 s37, s51, 110592
    s_add_u32 s51, s51, 1
    s_cmp_eq_u32 s51, 18
    s_cselect_b32 s51, 0, s51
    s_add_u32 m0, s30, 55296
    s_nop 0
    buffer_load_dwordx4 v1, s[24:27], s37 offen  lds
    s_add_u32 m0, s31, 55296
    s_nop 0
    buffer_load_dwordx4 v2, s[24:27], s37 offen  lds
    s_add_u32 m0, s32, 55296
    s_nop 0
    buffer_load_dwordx4 v3, s[24:27], s37 offen  lds
    s_add_u32 m0, s33, 55296
    s_nop 0
    buffer_load_dwordx4 v4, s[24:27], s37 offen  lds
    s_add_u32 m0, s34, 55296
    s_nop 0
    buffer_load_dwordx4 v5, s[24:27], s37 offen  lds
    s_waitcnt vmcnt(28)
    s_barrier
    s_mul_i32 s37, s51, 110592
    s_add_u32 s51, s51, 1
    s_cmp_eq_u32 s51, 18
    s_cselect_b32 s51, 0, s51
    s_add_u32 m0, s30, 73728
    s_nop 0
    buffer_load_dwordx4 v1, s[24:27], s37 offen  lds
    s_add_u32 m0, s31, 73728
    s_nop 0
    buffer_load_dwordx4 v2, s[24:27], s37 offen  lds
    s_add_u32 m0, s32, 73728
    s_nop 0
    buffer_load_dwordx4 v3, s[24:27], s37 offen  lds
    s_add_u32 m0, s33, 73728
    s_nop 0
    buffer_load_dwordx4 v4, s[24:27], s37 offen  lds
    s_add_u32 m0, s34, 73728
    s_nop 0
    buffer_load_dwordx4 v5, s[24:27], s37 offen  lds
    s_waitcnt vmcnt(24)
    s_barrier
    s_lshl_b32 s38, s52, 7
    s_add_u32 s52, s52, 1
    s_cmp_eq_u32 s52, 9
    s_cselect_b32 s52, 0, s52
    s_add_u32 m0, s35, 32768
    s_nop 0
    buffer_load_dwordx4 v6, s[20:23], s38 offen  lds
    s_add_u32 m0, s35, 36864
    s_add_u32 s38, s38, 36864
    buffer_load_dwordx4 v6, s[20:23], s38 offen  lds
    s_add_u32 m0, s35, 40960
    s_add_u32 s38, s38, 36864
    buffer_load_dwordx4 v6, s[20:23], s38 offen  lds
    s_add_u32 m0, s35, 45056
    s_add_u32 s38, s38, 36864
    buffer_load_dwordx4 v6, s[20:23], s38 offen  lds
    s_mul_i32 s37, s51, 110592
    s_add_u32 s51, s51, 1
    s_cmp_eq_u32 s51, 18
    s_cselect_b32 s51, 0, s51
    s_add_u32 m0, s30, 92160
    s_nop 0
    buffer_load_dwordx4 v1, s[24:27], s37 offen  lds
    s_add_u32 m0, s31, 92160
    s_nop 0
    buffer_load_dwordx4 v2, s[24:27], s37 offen  lds
    s_add_u32 m0, s32, 92160
    s_nop 0
    buffer_load_dwordx4 v3, s[24:27], s37 offen  lds
    s_add_u32 m0, s33, 92160
    s_nop 0
    buffer_load_dwordx4 v4, s[24:27], s37 offen  lds
    s_add_u32 m0, s34, 92160
    s_nop 0
    buffer_load_dwordx4 v5, s[24:27], s37 offen  lds
    s_waitcnt vmcnt(28)
    s_barrier
    s_waitcnt vmcnt(19)
    s_barrier
    s_waitcnt vmcnt(14)
    s_barrier
    s_waitcnt vmcnt(5)
    s_barrier
    s_waitcnt vmcnt(0)
    s_barrier
    s_endpgm
K1_LOADER1:
    s_setprio 3
    v_and_b32 v0, 63, v0
    s_sub_u32 s3, s3, 4
    v_lshrrev_b32 v10, 3, v0
    s_lshl_b32 s16, s13, 7
    s_lshl_b32 s17, s3, 3
    s_add_u32 s16, s16, s17
    v_add_u32 v10, s16, v10
    v_bfe_u32 v11, v10, 1, 3
    v_mul_u32_u24 v10, 1152, v10
    v_and_b32 v12, 7, v0
    v_xor_b32 v11, v11, v12
    v_lshl_add_u32 v6, v11, 4, v10
    s_mul_i32 s15, s14, 144
    s_and_b32 s39, s15, 63
    s_andn2_b32 s41, s15, 63
    s_add_u32 s40, s39, 144
    s_lshl_b32 s16, s3, 10
    s_add_u32 s30, s16, 0
    s_add_u32 s31, s16, 4096
    s_add_u32 s32, s16, 8192
    s_add_u32 s33, s16, 12288
    s_add_u32 s35, s16, 110592
    s_waitcnt lgkmcnt(0)
    s_cmp_eq_u32 s12, 0
    s_cselect_b32 s20, s4, s8
    s_cselect_b32 s21, s5, s9
    s_cselect_b32 s24, s6, s10
    s_cselect_b32 s25, s7, s11
    s_and_b32 s21, s21, 0xffff
    s_and_b32 s25, s25, 0xffff
    s_mov_b32 s22, 2359296
    s_mov_b32 s23, 0x00020000
    s_mov_b32 s26, 1990656
    s_mov_b32 s27, 0x00020000
    s_bfe_u32 s15, s2, 0x30003
    s_lshl_b32 s15, s15, 2
    s_lshr_b32 s15, 0x76543210, s15
    s_and_b32 s15, s15, 15
    s_bfe_u32 s16, s2, 0x20006
    s_lshl_b32 s16, s16, 2
    s_lshr_b32 s16, 0x7520, s16
    s_and_b32 s16, s16, 15
    s_add_u32 s51, s15, s16
    s_cmp_ge_u32 s51, 9
    s_cselect_b32 s15, 9, 0
    s_sub_u32 s51, s51, s15
    s_lshl_b32 s51, s51, 1
    s_lshr_b32 s52, s51, 1
    s_lshl_b32 s38, s52, 7
    s_add_u32 s52, s52, 1
    s_cmp_eq_u32 s52, 9
    s_cselect_b32 s52, 0, s52
    s_add_u32 m0, s35, 0
    s_nop 0
    buffer_load_dwordx4 v6, s[20:23], s38 offen  lds
    s_add_u32 m0, s35, 4096
    s_add_u32 s38, s38, 36864
    buffer_load_dwordx4 v6, s[20:23], s38 offen  lds
    s_add_u32 m0, s35, 8192
    s_add_u32 s38, s38, 36864
    buffer_load_dwordx4 v6, s[20:23], s38 offen  lds
    s_add_u32 m0, s35, 12288
    s_add_u32 s38, s38, 36864
    buffer_load_dwordx4 v6, s[20:23], s38 offen  lds
    s_mul_i32 s37, s51, 110592
    s_add_u32 s51, s51, 1
    s_cmp_eq_u32 s51, 18
    s_cselect_b32 s51, 0, s51
    s_lshl_b32 s16, s3, 6
    s_add_u32 s16, s16, 0
    v_add_u32 v10, s16, v0
    v_mul_u32_u24 v11, 1821, v10
    v_lshrrev_b32 v11, 16, v11
    v_mul_u32_u24 v12, 36, v11
    v_sub_u32 v12, v10, v12
    v_lshrrev_b32 v13, 2, v11
    v_and_b32 v13, 2, v13
    v_xor_b32 v12, v12, v13
    v_mul_u32_u24 v13, 43, v12
    v_lshrrev_b32 v13, 9, v13
    v_mul_u32_u24 v14, 12, v13
    v_sub_u32 v14, v12, v14
    v_lshlrev_b32 v14, 4, v14
    v_mul_u32_u24 v13, 1152, v13
    v_mul_u32_u24 v15, 3456, v11
    v_add3_u32 v15, v15, v13, v14
    v_add_u32 v15, s41, v15
    v_cmp_le_u32 vcc, s39, v14
    v_cmp_gt_u32 s[42:43], s40, v14
    v_bfrev_b32 v17, 1
    s_and_b64 vcc, vcc, s[42:43]
    s_nop 1
    v_cndmask_b32 v1, v17, v15, vcc
    s_add_u32 m0, s30, 0
    s_nop 0
    buffer_load_dwordx4 v1, s[24:27], s37 offen  lds
    s_lshl_b32 s16, s3, 6
    s_add_u32 s16, s16, 256
    v_add_u32 v10, s16, v0
    v_mul_u32_u24 v11, 1821, v10
    v_lshrrev_b32 v11, 16, v11
    v_mul_u32_u24 v12, 36, v11
    v_sub_u32 v12, v10, v12
    v_lshrrev_b32 v13, 2, v11
    v_and_b32 v13, 2, v13
    v_xor_b32 v12, v12, v13
    v_mul_u32_u24 v13, 43, v12
    v_lshrrev_b32 v13, 9, v13
    v_mul_u32_u24 v14, 12, v13
    v_sub_u32 v14, v12, v14
    v_lshlrev_b32 v14, 4, v14
    v_mul_u32_u24 v13, 1152, v13
    v_mul_u32_u24 v15, 3456, v11
    v_add3_u32 v15, v15, v13, v14
    v_add_u32 v15, s41, v15
    v_cmp_le_u32 vcc, s39, v14
    v_cmp_gt_u32 s[42:43], s40, v14
    v_bfrev_b32 v17, 1
    s_and_b64 vcc, vcc, s[42:43]
    s_nop 1
    v_cndmask_b32 v2, v17, v15, vcc
    s_add_u32 m0, s31, 0
    s_nop 0
    buffer_load_dwordx4 v2, s[24:27], s37 offen  lds
    s_lshl_b32 s16, s3, 6
    s_add_u32 s16, s16, 512
    v_add_u32 v10, s16, v0
    v_mul_u32_u24 v11, 1821, v10
    v_lshrrev_b32 v11, 16, v11
    v_mul_u32_u24 v12, 36, v11
    v_sub_u32 v12, v10, v12
    v_lshrrev_b32 v13, 2, v11
    v_and_b32 v13, 2, v13
    v_xor_b32 v12, v12, v13
    v_mul_u32_u24 v13, 43, v12
    v_lshrrev_b32 v13, 9, v13
    v_mul_u32_u24 v14, 12, v13
    v_sub_u32 v14, v12, v14
    v_lshlrev_b32 v14, 4, v14
    v_mul_u32_u24 v13, 1152, v13
    v_mul_u32_u24 v15, 3456, v11
    v_add3_u32 v15, v15, v13, v14
    v_add_u32 v15, s41, v15
    v_cmp_le_u32 vcc, s39, v14
    v_cmp_gt_u32 s[42:43], s40, v14
    v_bfrev_b32 v17, 1
    s_and_b64 vcc, vcc, s[42:43]
    s_nop 1
    v_cndmask_b32 v3, v17, v15, vcc
    s_add_u32 m0, s32, 0
    s_nop 0
    buffer_load_dwordx4 v3, s[24:27], s37 offen  lds
    s_lshl_b32 s16, s3, 6
    s_add_u32 s16, s16, 768
    v_add_u32 v10, s16, v0
    v_mul_u32_u24 v11, 1821, v10
    v_lshrrev_b32 v11, 16, v11
    v_mul_u32_u24 v12, 36, v11
    v_sub_u32 v12, v10, v12
    v_lshrrev_b32 v13, 2, v11
    v_and_b32 v13, 2, v13
    v_xor_b32 v12, v12, v13
    v_mul_u32_u24 v13, 43, v12
    v_lshrrev_b32 v13, 9, v13
    v_mul_u32_u24 v14, 12, v13
    v_sub_u32 v14, v12, v14
    v_lshlrev_b32 v14, 4, v14
    v_mul_u32_u24 v13, 1152, v13
    v_mul_u32_u24 v15, 3456, v11
    v_add3_u32 v15, v15, v13, v14
    v_add_u32 v15, s41, v15
    v_cmp_le_u32 vcc, s39, v14
    v_cmp_gt_u32 s[42:43], s40, v14
    v_bfrev_b32 v17, 1
    s_and_b64 vcc, vcc, s[42:43]
    s_nop 1
    v_cndmask_b32 v4, v17, v15, vcc
    s_add_u32 m0, s33, 0
    s_nop 0
    buffer_load_dwordx4 v4, s[24:27], s37 offen  lds
    s_mul_i32 s37, s51, 110592
    s_add_u32 s51, s51, 1
    s_cmp_eq_u32 s51, 18
    s_cselect_b32 s51, 0, s51
    s_add_u32 m0, s30, 18432
    s_nop 0
    buffer_load_dwordx4 v1, s[24:27], s37 offen  lds
    s_add_u32 m0, s31, 18432
    s_nop 0
    buffer_load_dwordx4 v2, s[24:27], s37 offen  lds
    s_add_u32 m0, s32, 18432
    s_nop 0
    buffer_load_dwordx4 v3, s[24:27], s37 offen  lds
    s_add_u32 m0, s33, 18432
    s_nop 0
    buffer_load_dwordx4 v4, s[24:27], s37 offen  lds
    s_lshl_b32 s38, s52, 7
    s_add_u32 s52, s52, 1
    s_cmp_eq_u32 s52, 9
    s_cselect_b32 s52, 0, s52
    s_add_u32 m0, s35, 16384
    s_nop 0
    buffer_load_dwordx4 v6, s[20:23], s38 offen  lds
    s_add_u32 m0, s35, 20480
    s_add_u32 s38, s38, 36864
    buffer_load_dwordx4 v6, s[20:23], s38 offen  lds
    s_add_u32 m0, s35, 24576
    s_add_u32 s38, s38, 36864
    buffer_load_dwordx4 v6, s[20:23], s38 offen  lds
    s_add_u32 m0, s35, 28672
    s_add_u32 s38, s38, 36864
    buffer_load_dwordx4 v6, s[20:23], s38 offen  lds
    s_mul_i32 s37, s51, 110592
    s_add_u32 s51, s51, 1
    s_cmp_eq_u32 s51, 18
    s_cselect_b32 s51, 0, s51
    s_add_u32 m0, s30, 36864
    s_nop 0
    buffer_load_dwordx4 v1, s[24:27], s37 offen  lds
    s_add_u32 m0, s31, 36864
    s_nop 0
    buffer_load_dwordx4 v2, s[24:27], s37 offen  lds
    s_add_u32 m0, s32, 36864
    s_nop 0
    buffer_load_dwordx4 v3, s[24:27], s37 offen  lds
    s_add_u32 m0, s33, 36864
    s_nop 0
    buffer_load_dwordx4 v4, s[24:27], s37 offen  lds
    s_waitcnt vmcnt(12)
    s_barrier
    s_mul_i32 s37, s51, 110592
    s_add_u32 s51, s51, 1
    s_cmp_eq_u32 s51, 18
    s_cselect_b32 s51, 0, s51
    s_add_u32 m0, s30, 55296
    s_nop 0
    buffer_load_dwordx4 v1, s[24:27], s37 offen  lds
    s_add_u32 m0, s31, 55296
    s_nop 0
    buffer_load_dwordx4 v2, s[24:27], s37 offen  lds
    s_add_u32 m0, s32, 55296
    s_nop 0
    buffer_load_dwordx4 v3, s[24:27], s37 offen  lds
    s_add_u32 m0, s33, 55296
    s_nop 0
    buffer_load_dwordx4 v4, s[24:27], s37 offen  lds
    s_lshl_b32 s38, s52, 7
    s_add_u32 s52, s52, 1
    s_cmp_eq_u32 s52, 9
    s_cselect_b32 s52, 0, s52
    s_add_u32 m0, s35, 32768
    s_nop 0
    buffer_load_dwordx4 v6, s[20:23], s38 offen  lds
    s_add_u32 m0, s35, 36864
    s_add_u32 s38, s38, 36864
    buffer_load_dwordx4 v6, s[20:23], s38 offen  lds
    s_add_u32 m0, s35, 40960
    s_add_u32 s38, s38, 36864
    buffer_load_dwordx4 v6, s[20:23], s38 offen  lds
    s_add_u32 m0, s35, 45056
    s_add_u32 s38, s38, 36864
    buffer_load_dwordx4 v6, s[20:23], s38 offen  lds
    s_mul_i32 s37, s51, 110592
    s_add_u32 s51, s51, 1
    s_cmp_eq_u32 s51, 18
    s_cselect_b32 s51, 0, s51
    s_add_u32 m0, s30, 73728
    s_nop 0
    buffer_load_dwordx4 v1, s[24:27], s37 offen  lds
    s_add_u32 m0, s31, 73728
    s_nop 0
    buffer_load_dwordx4 v2, s[24:27], s37 offen  lds
    s_add_u32 m0, s32, 73728
    s_nop 0
    buffer_load_dwordx4 v3, s[24:27], s37 offen  lds
    s_add_u32 m0, s33, 73728
    s_nop 0
    buffer_load_dwordx4 v4, s[24:27], s37 offen  lds
    s_waitcnt vmcnt(20)
    s_barrier
    s_mul_i32 s37, s51, 110592
    s_add_u32 s51, s51, 1
    s_cmp_eq_u32 s51, 18
    s_cselect_b32 s51, 0, s51
    s_add_u32 m0, s30, 92160
    s_nop 0
    buffer_load_dwordx4 v1, s[24:27], s37 offen  lds
    s_add_u32 m0, s31, 92160
    s_nop 0
    buffer_load_dwordx4 v2, s[24:27], s37 offen  lds
    s_add_u32 m0, s32, 92160
    s_nop 0
    buffer_load_dwordx4 v3, s[24:27], s37 offen  lds
    s_add_u32 m0, s33, 92160
    s_nop 0
    buffer_load_dwordx4 v4, s[24:27], s37 offen  lds
    s_mul_i32 s37, s51, 110592
    s_add_u32 s51, s51, 1
    s_cmp_eq_u32 s51, 18
    s_cselect_b32 s51, 0, s51
    s_add_u32 m0, s30, 0
    s_nop 0
    buffer_load_dwordx4 v1, s[24:27], s37 offen  lds
    s_add_u32 m0, s31, 0
    s_nop 0
    buffer_load_dwordx4 v2, s[24:27], s37 offen  lds
    s_add_u32 m0, s32, 0
    s_nop 0
    buffer_load_dwordx4 v3, s[24:27], s37 offen  lds
    s_add_u32 m0, s33, 0
    s_nop 0
    buffer_load_dwordx4 v4, s[24:27], s37 offen  lds
    s_waitcnt vmcnt(20)
    s_barrier
    s_lshl_b32 s38, s52, 7
    s_add_u32 s52, s52, 1
    s_cmp_eq_u32 s52, 9
    s_cselect_b32 s52, 0, s52
    s_add_u32 m0, s35, 0
    s_nop 0
    buffer_load_dwordx4 v6, s[20:23], s38 offen  lds
    s_add_u32 m0, s35, 4096
    s_add_u32 s38, s38, 36864
    buffer_load_dwordx4 v6, s[20:23], s38 offen  lds
    s_add_u32 m0, s35, 8192
    s_add_u32 s38, s38, 36864
    buffer_load_dwordx4 v6, s[20:23], s38 offen  lds
    s_add_u32 m0, s35, 12288
    s_add_u32 s38, s38, 36864
    buffer_load_dwordx4 v6, s[20:23], s38 offen  lds
    s_mul_i32 s37, s51, 110592
    s_add_u32 s51, s51, 1
    s_cmp_eq_u32 s51, 18
    s_cselect_b32 s51, 0, s51
    s_add_u32 m0, s30, 18432
    s_nop 0
    buffer_load_dwordx4 v1, s[24:27], s37 offen  lds
    s_add_u32 m0, s31, 18432
    s_nop 0
    buffer_load_dwordx4 v2, s[24:27], s37 offen  lds
    s_add_u32 m0, s32, 18432
    s_nop 0
    buffer_load_dwordx4 v3, s[24:27], s37 offen  lds
    s_add_u32 m0, s33, 18432
    s_nop 0
    buffer_load_dwordx4 v4, s[24:27], s37 offen  lds
    s_waitcnt vmcnt(24)
    s_barrier
    s_mul_i32 s37, s51, 110592
    s_add_u32 s51, s51, 1
    s_cmp_eq_u32 s51, 18
    s_cselect_b32 s51, 0, s51
    s_add_u32 m0, s30, 36864
    s_nop 0
    buffer_load_dwordx4 v1, s[24:27], s37 offen  lds
    s_add_u32 m0, s31, 36864
    s_nop 0
    buffer_load_dwordx4 v2, s[24:27], s37 offen  lds
    s_add_u32 m0, s32, 36864
    s_nop 0
    buffer_load_dwordx4 v3, s[24:27], s37 offen  lds
    s_add_u32 m0, s33, 36864
    s_nop 0
    buffer_load_dwordx4 v4, s[24:27], s37 offen  lds
    s_waitcnt vmcnt(20)
    s_barrier
    s_lshl_b32 s38, s52, 7
    s_add_u32 s52, s52, 1
    s_cmp_eq_u32 s52, 9
    s_cselect_b32 s52, 0, s52
    s_add_u32 m0, s35, 16384
    s_nop 0
    buffer_load_dwordx4 v6, s[20:23], s38 offen  lds
    s_add_u32 m0, s35, 20480
    s_add_u32 s38, s38, 36864
    buffer_load_dwordx4 v6, s[20:23], s38 offen  lds
    s_add_u32 m0, s35, 24576
    s_add_u32 s38, s38, 36864
    buffer_load_dwordx4 v6, s[20:23], s38 offen  lds
    s_add_u32 m0, s35, 28672
    s_add_u32 s38, s38, 36864
    buffer_load_dwordx4 v6, s[20:23], s38 offen  lds
    s_mul_i32 s37, s51, 110592
    s_add_u32 s51, s51, 1
    s_cmp_eq_u32 s51, 18
    s_cselect_b32 s51, 0, s51
    s_add_u32 m0, s30, 55296
    s_nop 0
    buffer_load_dwordx4 v1, s[24:27], s37 offen  lds
    s_add_u32 m0, s31, 55296
    s_nop 0
    buffer_load_dwordx4 v2, s[24:27], s37 offen  lds
    s_add_u32 m0, s32, 55296
    s_nop 0
    buffer_load_dwordx4 v3, s[24:27], s37 offen  lds
    s_add_u32 m0, s33, 55296
    s_nop 0
    buffer_load_dwordx4 v4, s[24:27], s37 offen  lds
    s_waitcnt vmcnt(24)
    s_barrier
    s_mul_i32 s37, s51, 110592
    s_add_u32 s51, s51, 1
    s_cmp_eq_u32 s51, 18
    s_cselect_b32 s51, 0, s51
    s_add_u32 m0, s30, 73728
    s_nop 0
    buffer_load_dwordx4 v1, s[24:27], s37 offen  lds
    s_add_u32 m0, s31, 73728
    s_nop 0
    buffer_load_dwordx4 v2, s[24:27], s37 offen  lds
    s_add_u32 m0, s32, 73728
    s_nop 0
    buffer_load_dwordx4 v3, s[24:27], s37 offen  lds
    s_add_u32 m0, s33, 73728
    s_nop 0
    buffer_load_dwordx4 v4, s[24:27], s37 offen  lds
    s_waitcnt vmcnt(20)
    s_barrier
    s_lshl_b32 s38, s52, 7
    s_add_u32 s52, s52, 1
    s_cmp_eq_u32 s52, 9
    s_cselect_b32 s52, 0, s52
    s_add_u32 m0, s35, 32768
    s_nop 0
    buffer_load_dwordx4 v6, s[20:23], s38 offen  lds
    s_add_u32 m0, s35, 36864
    s_add_u32 s38, s38, 36864
    buffer_load_dwordx4 v6, s[20:23], s38 offen  lds
    s_add_u32 m0, s35, 40960
    s_add_u32 s38, s38, 36864
    buffer_load_dwordx4 v6, s[20:23], s38 offen  lds
    s_add_u32 m0, s35, 45056
    s_add_u32 s38, s38, 36864
    buffer_load_dwordx4 v6, s[20:23], s38 offen  lds
    s_mul_i32 s37, s51, 110592
    s_add_u32 s51, s51, 1
    s_cmp_eq_u32 s51, 18
    s_cselect_b32 s51, 0, s51
    s_add_u32 m0, s30, 92160
    s_nop 0
    buffer_load_dwordx4 v1, s[24:27], s37 offen  lds
    s_add_u32 m0, s31, 92160
    s_nop 0
    buffer_load_dwordx4 v2, s[24:27], s37 offen  lds
    s_add_u32 m0, s32, 92160
    s_nop 0
    buffer_load_dwordx4 v3, s[24:27], s37 offen  lds
    s_add_u32 m0, s33, 92160
    s_nop 0
    buffer_load_dwordx4 v4, s[24:27], s37 offen  lds
    s_waitcnt vmcnt(24)
    s_barrier
    s_mul_i32 s37, s51, 110592
    s_add_u32 s51, s51, 1
    s_cmp_eq_u32 s51, 18
    s_cselect_b32 s51, 0, s51
    s_add_u32 m0, s30, 0
    s_nop 0
    buffer_load_dwordx4 v1, s[24:27], s37 offen  lds
    s_add_u32 m0, s31, 0
    s_nop 0
    buffer_load_dwordx4 v2, s[24:27], s37 offen  lds
    s_add_u32 m0, s32, 0
    s_nop 0
    buffer_load_dwordx4 v3, s[24:27], s37 offen  lds
    s_add_u32 m0, s33, 0
    s_nop 0
    buffer_load_dwordx4 v4, s[24:27], s37 offen  lds
    s_waitcnt vmcnt(20)
    s_barrier
    s_lshl_b32 s38, s52, 7
    s_add_u32 s52, s52, 1
    s_cmp_eq_u32 s52, 9
    s_cselect_b32 s52, 0, s52
    s_add_u32 m0, s35, 0
    s_nop 0
    buffer_load_dwordx4 v6, s[20:23], s38 offen  lds
    s_add_u32 m0, s35, 4096
    s_add_u32 s38, s38, 36864
    buffer_load_dwordx4 v6, s[20:23], s38 offen  lds
    s_add_u32 m0, s35, 8192
    s_add_u32 s38, s38, 36864
    buffer_load_dwordx4 v6, s[20:23], s38 offen  lds
    s_add_u32 m0, s35, 12288
    s_add_u32 s38, s38, 36864
    buffer_load_dwordx4 v6, s[20:23], s38 offen  lds
    s_mul_i32 s37, s51, 110592
    s_add_u32 s51, s51, 1
    s_cmp_eq_u32 s51, 18
    s_cselect_b32 s51, 0, s51
    s_add_u32 m0, s30, 18432
    s_nop 0
    buffer_load_dwordx4 v1, s[24:27], s37 offen  lds
    s_add_u32 m0, s31, 18432
    s_nop 0
    buffer_load_dwordx4 v2, s[24:27], s37 offen  lds
    s_add_u32 m0, s32, 18432
    s_nop 0
    buffer_load_dwordx4 v3, s[24:27], s37 offen  lds
    s_add_u32 m0, s33, 18432
    s_nop 0
    buffer_load_dwordx4 v4, s[24:27], s37 offen  lds
    s_waitcnt vmcnt(24)
    s_barrier
    s_mul_i32 s37, s51, 110592
    s_add_u32 s51, s51, 1
    s_cmp_eq_u32 s51, 18
    s_cselect_b32 s51, 0, s51
    s_add_u32 m0, s30, 36864
    s_nop 0
    buffer_load_dwordx4 v1, s[24:27], s37 offen  lds
    s_add_u32 m0, s31, 36864
    s_nop 0
    buffer_load_dwordx4 v2, s[24:27], s37 offen  lds
    s_add_u32 m0, s32, 36864
    s_nop 0
    buffer_load_dwordx4 v3, s[24:27], s37 offen  lds
    s_add_u32 m0, s33, 36864
    s_nop 0
    buffer_load_dwordx4 v4, s[24:27], s37 offen  lds
    s_waitcnt vmcnt(20)
    s_barrier
    s_lshl_b32 s38, s52, 7
    s_add_u32 s52, s52, 1
    s_cmp_eq_u32 s52, 9
    s_cselect_b32 s52, 0, s52
    s_add_u32 m0, s35, 16384
    s_nop 0
    buffer_load_dwordx4 v6, s[20:23], s38 offen  lds
    s_add_u32 m0, s35, 20480
    s_add_u32 s38, s38, 36864
    buffer_load_dwordx4 v6, s[20:23], s38 offen  lds
    s_add_u32 m0, s35, 24576
    s_add_u32 s38, s38, 36864
    buffer_load_dwordx4 v6, s[20:23], s38 offen  lds
    s_add_u32 m0, s35, 28672
    s_add_u32 s38, s38, 36864
    buffer_load_dwordx4 v6, s[20:23], s38 offen  lds
    s_mul_i32 s37, s51, 110592
    s_add_u32 s51, s51, 1
    s_cmp_eq_u32 s51, 18
    s_cselect_b32 s51, 0, s51
    s_add_u32 m0, s30, 55296
    s_nop 0
    buffer_load_dwordx4 v1, s[24:27], s37 offen  lds
    s_add_u32 m0, s31, 55296
    s_nop 0
    buffer_load_dwordx4 v2, s[24:27], s37 offen  lds
    s_add_u32 m0, s32, 55296
    s_nop 0
    buffer_load_dwordx4 v3, s[24:27], s37 offen  lds
    s_add_u32 m0, s33, 55296
    s_nop 0
    buffer_load_dwordx4 v4, s[24:27], s37 offen  lds
    s_waitcnt vmcnt(24)
    s_barrier
    s_mul_i32 s37, s51, 110592
    s_add_u32 s51, s51, 1
    s_cmp_eq_u32 s51, 18
    s_cselect_b32 s51, 0, s51
    s_add_u32 m0, s30, 73728
    s_nop 0
    buffer_load_dwordx4 v1, s[24:27], s37 offen  lds
    s_add_u32 m0, s31, 73728
    s_nop 0
    buffer_load_dwordx4 v2, s[24:27], s37 offen  lds
    s_add_u32 m0, s32, 73728
    s_nop 0
    buffer_load_dwordx4 v3, s[24:27], s37 offen  lds
    s_add_u32 m0, s33, 73728
    s_nop 0
    buffer_load_dwordx4 v4, s[24:27], s37 offen  lds
    s_waitcnt vmcnt(20)
    s_barrier
    s_lshl_b32 s38, s52, 7
    s_add_u32 s52, s52, 1
    s_cmp_eq_u32 s52, 9
    s_cselect_b32 s52, 0, s52
    s_add_u32 m0, s35, 32768
    s_nop 0
    buffer_load_dwordx4 v6, s[20:23], s38 offen  lds
    s_add_u32 m0, s35, 36864
    s_add_u32 s38, s38, 36864
    buffer_load_dwordx4 v6, s[20:23], s38 offen  lds
    s_add_u32 m0, s35, 40960
    s_add_u32 s38, s38, 36864
    buffer_load_dwordx4 v6, s[20:23], s38 offen  lds
    s_add_u32 m0, s35, 45056
    s_add_u32 s38, s38, 36864
    buffer_load_dwordx4 v6, s[20:23], s38 offen  lds
    s_mul_i32 s37, s51, 110592
    s_add_u32 s51, s51, 1
    s_cmp_eq_u32 s51, 18
    s_cselect_b32 s51, 0, s51
    s_add_u32 m0, s30, 92160
    s_nop 0
    buffer_load_dwordx4 v1, s[24:27], s37 offen  lds
    s_add_u32 m0, s31, 92160
    s_nop 0
    buffer_load_dwordx4 v2, s[24:27], s37 offen  lds
    s_add_u32 m0, s32, 92160
    s_nop 0
    buffer_load_dwordx4 v3, s[24:27], s37 offen  lds
    s_add_u32 m0, s33, 92160
    s_nop 0
    buffer_load_dwordx4 v4, s[24:27], s37 offen  lds
    s_waitcnt vmcnt(24)
    s_barrier
    s_waitcnt vmcnt(16)
    s_barrier
    s_waitcnt vmcnt(12)
    s_barrier
    s_waitcnt vmcnt(4)
    s_barrier
    s_waitcnt vmcnt(0)
    s_barrier
    s_endpgm
K1_CONS:
    s_cmp_ge_u32 s3, 2
    s_cbranch_scc1 K1_CONS1
    v_and_b32 v217, 63, v0
    s_and_b32 s17, s3, 1
    v_lshrrev_b32 v220, 4, v217
    v_bfe_u32 v221, v217, 2, 2
    v_and_b32 v222, 3, v217
    v_lshl_add_u32 v223, v220, 3, v221
    v_mul_u32_u24 v223, 576, v223
    v_and_b32 v225, 1, v220
    v_lshlrev_b32 v225, 5, v225
    s_mul_i32 s15, s14, 144
    s_and_b32 s15, s15, 63
    s_add_u32 s16, s15, 0
    v_lshl_add_u32 v226, v222, 3, s16
    v_xor_b32 v226, v226, v225
    v_add_u32 v200, v226, v223
    s_add_u32 s16, s15, 40
    v_lshl_add_u32 v226, v222, 3, s16
    v_xor_b32 v226, v226, v225
    v_add_u32 v202, v226, v223
    v_and_b32 v227, 1, v222
    v_mul_u32_u24 v227, 72, v227
    s_add_u32 s16, s15, 32
    v_add_u32 v227, s16, v227
    v_xor_b32 v227, v227, v225
    v_lshrrev_b32 v224, 1, v222
    v_mul_u32_u24 v224, 192, v224
    v_add3_u32 v204, v227, v223, v224
    v_and_b32 v226, 15, v217
    v_bfe_u32 v227, v217, 1, 3
    v_xor_b32 v227, v227, v220
    v_lshlrev_b32 v227, 4, v227
    v_lshl_add_u32 v227, v226, 7, v227
    s_lshl_b32 s15, s17, 13
    s_add_u32 s15, s15, 110592
    v_add_u32 v206, s15, v227
    v_xor_b32 v207, 64, v206
    v_add_u32 v201, 55296, v200
    v_add_u32 v203, 55296, v202
    v_add_u32 v205, 55296, v204
    v_lshlrev_b32 v212, 4, v217
    v_and_b32 v229, 4, v217
    v_and_b32 v228, 0xfffffff3, v217
    v_lshl_or_b32 v228, v229, 1, v228
    v_and_b32 v229, 8, v217
    v_lshrrev_b32 v229, 1, v229
    v_or_b32 v228, v228, v229
    v_lshlrev_b32 v213, 4, v228
    v_and_b32 v229, 1, v220
    v_lshrrev_b32 v230, 1, v220
    v_lshl_add_u32 v229, v229, 1, v230
    v_mul_u32_u24 v229, 304, v229
    v_lshl_add_u32 v214, v226, 4, v229
    v_and_b32 v230, 15, v228
    v_cmp_gt_u32 vcc, 32, v217
    s_nop 1
    v_cndmask_b32 v230, v230, v226, vcc
    v_and_b32 v231, 1, v220
    v_lshlrev_b32 v231, 14, v231
    v_lshl_add_u32 v231, v230, 2, v231
    v_add_u32 v230, 524288, v231
    v_cndmask_b32 v215, v230, v231, vcc
    s_mov_b32 s15, 0x3eae1a93
    v_mov_b32 v230, s15
    v_cndmask_b32 v216, 1.0, v230, vcc
    s_lshl_b32 s15, s14, 2
    s_add_u32 s15, s15, 0
    s_lshl_b32 s16, s13, 1
    s_add_u32 s16, s16, s17
    s_lshl_b32 s44, s15, 16
    s_lshl_b32 s45, s16, 11
    s_add_u32 s44, s44, s45
    s_lshl_b32 s45, s12, 21
    s_add_u32 s44, s44, s45
    s_add_u32 s45, s44, 4194304
    s_mul_i32 s46, s15, 77824
    s_mul_i32 s47, s16, 2432
    s_add_u32 s46, s46, s47
    s_mul_i32 s47, s12, 2490368
    s_add_u32 s46, s46, s47
    s_add_u32 s46, s46, 9437184
    s_lshl_b32 s47, s15, 13
    s_lshl_b32 s48, s16, 8
    s_add_u32 s47, s47, s48
    s_lshl_b32 s48, s12, 18
    s_add_u32 s47, s47, s48
    s_add_u32 s47, s47, 8388608
    s_add_u32 s48, s47, 8192
    s_add_u32 s49, s44, 65536
    s_add_u32 s50, s45, 65536
    s_add_u32 s51, s46, 77824
    s_mov_b32 s52, 0x3eae1a93
    s_mov_b32 s53, 0x3eae1a93
    s_load_dwordx2 s[20:21], s[0:1], 64
    s_barrier
    ds_read_b128 v[112:115], v206 offset:0
    ds_read_b64_tr_b16 v[128:129], v200 offset:0
    ds_read_b64_tr_b16 v[130:131], v200 offset:2304
    ds_read_b128 v[116:119], v206 offset:2048
    ds_read_b128 v[120:123], v206 offset:4096
    ds_read_b128 v[124:127], v206 offset:6144
    ds_read_b64_tr_b16 v[132:133], v202 offset:0
    ds_read_b64_tr_b16 v[134:135], v202 offset:2304
    ds_read_b64_tr_b16 v[136:137], v200 offset:192
    ds_read_b64_tr_b16 v[138:139], v200 offset:2496
    ds_read_b64_tr_b16 v[140:141], v202 offset:192
    ds_read_b64_tr_b16 v[142:143], v202 offset:2496
    ds_read_b64_tr_b16 v[144:145], v200 offset:384
    ds_read_b64_tr_b16 v[146:147], v200 offset:2688
    ds_read_b64_tr_b16 v[148:149], v202 offset:384
    ds_read_b64_tr_b16 v[150:151], v202 offset:2688
    ds_read_b64_tr_b16 v[152:153], v204 offset:0
    ds_read_b64_tr_b16 v[154:155], v204 offset:2304
    s_waitcnt lgkmcnt(0)
    v_mfma_f32_16x16x32_bf16 v[0:3], v[128:131], v[112:115], 0
    v_mfma_f32_16x16x32_bf16 v[4:7], v[128:131], v[116:119], 0
    s_barrier
    v_mfma_f32_16x16x32_bf16 v[8:11], v[128:131], v[120:123], 0
    ds_read_b128 v[156:159], v207 offset:0
    v_mfma_f32_16x16x32_bf16 v[12:15], v[128:131], v[124:127], 0
    ds_read_b64_tr_b16 v[172:173], v200 offset:18432
    v_mfma_f32_16x16x32_bf16 v[16:19], v[132:135], v[112:115], 0
    ds_read_b64_tr_b16 v[174:175], v200 offset:20736
    v_mfma_f32_16x16x32_bf16 v[20:23], v[132:135], v[116:119], 0
    ds_read_b128 v[160:163], v207 offset:2048
    v_mfma_f32_16x16x32_bf16 v[24:27], v[132:135], v[120:123], 0
    ds_read_b128 v[164:167], v207 offset:4096
    v_mfma_f32_16x16x32_bf16 v[28:31], v[132:135], v[124:127], 0
    ds_read_b128 v[168:171], v207 offset:6144
    v_mfma_f32_16x16x32_bf16 v[32:35], v[136:139], v[112:115], 0
    ds_read_b64_tr_b16 v[176:177], v202 offset:18432
    v_mfma_f32_16x16x32_bf16 v[36:39], v[136:139], v[116:119], 0
    ds_read_b64_tr_b16 v[178:179], v202 offset:20736
    v_mfma_f32_16x16x32_bf16 v[40:43], v[136:139], v[120:123], 0
    ds_read_b64_tr_b16 v[180:181], v200 offset:18624
    v_mfma_f32_16x16x32_bf16 v[44:47], v[136:139], v[124:127], 0
    ds_read_b64_tr_b16 v[182:183], v200 offset:20928
    v_mfma_f32_16x16x32_bf16 v[48:51], v[140:143], v[112:115], 0
    ds_read_b64_tr_b16 v[184:185], v202 offset:18624
    v_mfma_f32_16x16x32_bf16 v[52:55], v[140:143], v[116:119], 0
    ds_read_b64_tr_b16 v[186:187], v202 offset:20928
    v_mfma_f32_16x16x32_bf16 v[56:59], v[140:143], v[120:123], 0
    ds_read_b64_tr_b16 v[188:189], v200 offset:18816
    v_mfma_f32_16x16x32_bf16 v[60:63], v[140:143], v[124:127], 0
    ds_read_b64_tr_b16 v[190:191], v200 offset:21120
    v_mfma_f32_16x16x32_bf16 v[64:67], v[112:115], v[144:147], 0
    ds_read_b64_tr_b16 v[192:193], v202 offset:18816
    v_mfma_f32_16x16x32_bf16 v[68:71], v[116:119], v[144:147], 0
    ds_read_b64_tr_b16 v[194:195], v202 offset:21120
    v_mfma_f32_16x16x32_bf16 v[72:75], v[120:123], v[144:147], 0
    ds_read_b64_tr_b16 v[196:197], v204 offset:18432
    v_mfma_f32_16x16x32_bf16 v[76:79], v[124:127], v[144:147], 0
    ds_read_b64_tr_b16 v[198:199], v204 offset:20736
    v_mfma_f32_16x16x32_bf16 v[80:83], v[112:115], v[148:151], 0
    v_mfma_f32_16x16x32_bf16 v[84:87], v[116:119], v[148:151], 0
    v_mfma_f32_16x16x32_bf16 v[88:91], v[120:123], v[148:151], 0
    v_mfma_f32_16x16x32_bf16 v[92:95], v[124:127], v[148:151], 0
    v_mfma_f32_16x16x32_bf16 v[96:99], v[152:155], v[112:115], 0
    v_mfma_f32_16x16x32_bf16 v[100:103], v[152:155], v[116:119], 0
    v_mfma_f32_16x16x32_bf16 v[104:107], v[152:155], v[120:123], 0
    v_mfma_f32_16x16x32_bf16 v[108:111], v[152:155], v[124:127], 0
    s_waitcnt lgkmcnt(0)
    v_mfma_f32_16x16x32_bf16 v[0:3], v[172:175], v[156:159], v[0:3]
    v_mfma_f32_16x16x32_bf16 v[4:7], v[172:175], v[160:163], v[4:7]
    s_barrier
    v_mfma_f32_16x16x32_bf16 v[8:11], v[172:175], v[164:167], v[8:11]
    ds_read_b128 v[112:115], v206 offset:16384
    v_mfma_f32_16x16x32_bf16 v[12:15], v[172:175], v[168:171], v[12:15]
    ds_read_b64_tr_b16 v[128:129], v200 offset:36864
    v_mfma_f32_16x16x32_bf16 v[16:19], v[176:179], v[156:159], v[16:19]
    ds_read_b64_tr_b16 v[130:131], v200 offset:39168
    v_mfma_f32_16x16x32_bf16 v[20:23], v[176:179], v[160:163], v[20:23]
    ds_read_b128 v[116:119], v206 offset:18432
    v_mfma_f32_16x16x32_bf16 v[24:27], v[176:179], v[164:167], v[24:27]
    ds_read_b128 v[120:123], v206 offset:20480
    v_mfma_f32_16x16x32_bf16 v[28:31], v[176:179], v[168:171], v[28:31]
    ds_read_b128 v[124:127], v206 offset:22528
    v_mfma_f32_16x16x32_bf16 v[32:35], v[180:183], v[156:159], v[32:35]
    ds_read_b64_tr_b16 v[132:133], v202 offset:36864
    v_mfma_f32_16x16x32_bf16 v[36:39], v[180:183], v[160:163], v[36:39]
    ds_read_b64_tr_b16 v[134:135], v202 offset:39168
    v_mfma_f32_16x16x32_bf16 v[40:43], v[180:183], v[164:167], v[40:43]
    ds_read_b64_tr_b16 v[136:137], v200 offset:37056
    v_mfma_f32_16x16x32_bf16 v[44:47], v[180:183], v[168:171], v[44:47]
    ds_read_b64_tr_b16 v[138:139], v200 offset:39360
    v_mfma_f32_16x16x32_bf16 v[48:51], v[184:187], v[156:159], v[48:51]
    ds_read_b64_tr_b16 v[140:141], v202 offset:37056
    v_mfma_f32_16x16x32_bf16 v[52:55], v[184:187], v[160:163], v[52:55]
    ds_read_b64_tr_b16 v[142:143], v202 offset:39360
    v_mfma_f32_16x16x32_bf16 v[56:59], v[184:187], v[164:167], v[56:59]
    ds_read_b64_tr_b16 v[144:145], v200 offset:37248
    v_mfma_f32_16x16x32_bf16 v[60:63], v[184:187], v[168:171], v[60:63]
    ds_read_b64_tr_b16 v[146:147], v200 offset:39552
    v_mfma_f32_16x16x32_bf16 v[64:67], v[156:159], v[188:191], v[64:67]
    ds_read_b64_tr_b16 v[148:149], v202 offset:37248
    v_mfma_f32_16x16x32_bf16 v[68:71], v[160:163], v[188:191], v[68:71]
    ds_read_b64_tr_b16 v[150:151], v202 offset:39552
    v_mfma_f32_16x16x32_bf16 v[72:75], v[164:167], v[188:191], v[72:75]
    ds_read_b64_tr_b16 v[152:153], v204 offset:36864
    v_mfma_f32_16x16x32_bf16 v[76:79], v[168:171], v[188:191], v[76:79]
    ds_read_b64_tr_b16 v[154:155], v204 offset:39168
    v_mfma_f32_16x16x32_bf16 v[80:83], v[156:159], v[192:195], v[80:83]
    v_mfma_f32_16x16x32_bf16 v[84:87], v[160:163], v[192:195], v[84:87]
    v_mfma_f32_16x16x32_bf16 v[88:91], v[164:167], v[192:195], v[88:91]
    v_mfma_f32_16x16x32_bf16 v[92:95], v[168:171], v[192:195], v[92:95]
    v_mfma_f32_16x16x32_bf16 v[96:99], v[196:199], v[156:159], v[96:99]
    v_mfma_f32_16x16x32_bf16 v[100:103], v[196:199], v[160:163], v[100:103]
    v_mfma_f32_16x16x32_bf16 v[104:107], v[196:199], v[164:167], v[104:107]
    v_mfma_f32_16x16x32_bf16 v[108:111], v[196:199], v[168:171], v[108:111]
    s_waitcnt lgkmcnt(0)
    v_mfma_f32_16x16x32_bf16 v[0:3], v[128:131], v[112:115], v[0:3]
    v_mfma_f32_16x16x32_bf16 v[4:7], v[128:131], v[116:119], v[4:7]
    s_barrier
    v_mfma_f32_16x16x32_bf16 v[8:11], v[128:131], v[120:123], v[8:11]
    ds_read_b128 v[156:159], v207 offset:16384
    v_mfma_f32_16x16x32_bf16 v[12:15], v[128:131], v[124:127], v[12:15]
    ds_read_b64_tr_b16 v[172:173], v201 offset:0
    v_mfma_f32_16x16x32_bf16 v[16:19], v[132:135], v[112:115], v[16:19]
    ds_read_b64_tr_b16 v[174:175], v201 offset:2304
    v_mfma_f32_16x16x32_bf16 v[20:23], v[132:135], v[116:119], v[20:23]
    ds_read_b128 v[160:163], v207 offset:18432
    v_mfma_f32_16x16x32_bf16 v[24:27], v[132:135], v[120:123], v[24:27]
    ds_read_b128 v[164:167], v207 offset:20480
    v_mfma_f32_16x16x32_bf16 v[28:31], v[132:135], v[124:127], v[28:31]
    ds_read_b128 v[168:171], v207 offset:22528
    v_mfma_f32_16x16x32_bf16 v[32:35], v[136:139], v[112:115], v[32:35]
    ds_read_b64_tr_b16 v[176:177], v203 offset:0
    v_mfma_f32_16x16x32_bf16 v[36:39], v[136:139], v[116:119], v[36:39]
    ds_read_b64_tr_b16 v[178:179], v203 offset:2304
    v_mfma_f32_16x16x32_bf16 v[40:43], v[136:139], v[120:123], v[40:43]
    ds_read_b64_tr_b16 v[180:181], v201 offset:192
    v_mfma_f32_16x16x32_bf16 v[44:47], v[136:139], v[124:127], v[44:47]
    ds_read_b64_tr_b16 v[182:183], v201 offset:2496
    v_mfma_f32_16x16x32_bf16 v[48:51], v[140:143], v[112:115], v[48:51]
    ds_read_b64_tr_b16 v[184:185], v203 offset:192
    v_mfma_f32_16x16x32_bf16 v[52:55], v[140:143], v[116:119], v[52:55]
    ds_read_b64_tr_b16 v[186:187], v203 offset:2496
    v_mfma_f32_16x16x32_bf16 v[56:59], v[140:143], v[120:123], v[56:59]
    ds_read_b64_tr_b16 v[188:189], v201 offset:384
    v_mfma_f32_16x16x32_bf16 v[60:63], v[140:143], v[124:127], v[60:63]
    ds_read_b64_tr_b16 v[190:191], v201 offset:2688
    v_mfma_f32_16x16x32_bf16 v[64:67], v[112:115], v[144:147], v[64:67]
    ds_read_b64_tr_b16 v[192:193], v203 offset:384
    v_mfma_f32_16x16x32_bf16 v[68:71], v[116:119], v[144:147], v[68:71]
    ds_read_b64_tr_b16 v[194:195], v203 offset:2688
    v_mfma_f32_16x16x32_bf16 v[72:75], v[120:123], v[144:147], v[72:75]
    ds_read_b64_tr_b16 v[196:197], v205 offset:0
    v_mfma_f32_16x16x32_bf16 v[76:79], v[124:127], v[144:147], v[76:79]
    ds_read_b64_tr_b16 v[198:199], v205 offset:2304
    v_mfma_f32_16x16x32_bf16 v[80:83], v[112:115], v[148:151], v[80:83]
    v_mfma_f32_16x16x32_bf16 v[84:87], v[116:119], v[148:151], v[84:87]
    v_mfma_f32_16x16x32_bf16 v[88:91], v[120:123], v[148:151], v[88:91]
    v_mfma_f32_16x16x32_bf16 v[92:95], v[124:127], v[148:151], v[92:95]
    v_mfma_f32_16x16x32_bf16 v[96:99], v[152:155], v[112:115], v[96:99]
    v_mfma_f32_16x16x32_bf16 v[100:103], v[152:155], v[116:119], v[100:103]
    v_mfma_f32_16x16x32_bf16 v[104:107], v[152:155], v[120:123], v[104:107]
    v_mfma_f32_16x16x32_bf16 v[108:111], v[152:155], v[124:127], v[108:111]
    s_waitcnt lgkmcnt(0)
    v_mfma_f32_16x16x32_bf16 v[0:3], v[172:175], v[156:159], v[0:3]
    v_mfma_f32_16x16x32_bf16 v[4:7], v[172:175], v[160:163], v[4:7]
    s_barrier
    v_mfma_f32_16x16x32_bf16 v[8:11], v[172:175], v[164:167], v[8:11]
    ds_read_b128 v[112:115], v206 offset:32768
    v_mfma_f32_16x16x32_bf16 v[12:15], v[172:175], v[168:171], v[12:15]
    ds_read_b64_tr_b16 v[128:129], v201 offset:18432
    v_mfma_f32_16x16x32_bf16 v[16:19], v[176:179], v[156:159], v[16:19]
    ds_read_b64_tr_b16 v[130:131], v201 offset:20736
    v_mfma_f32_16x16x32_bf16 v[20:23], v[176:179], v[160:163], v[20:23]
    ds_read_b128 v[116:119], v206 offset:34816
    v_mfma_f32_16x16x32_bf16 v[24:27], v[176:179], v[164:167], v[24:27]
    ds_read_b128 v[120:123], v206 offset:36864
    v_mfma_f32_16x16x32_bf16 v[28:31], v[176:179], v[168:171], v[28:31]
    ds_read_b128 v[124:127], v206 offset:38912
    v_mfma_f32_16x16x32_bf16 v[32:35], v[180:183], v[156:159], v[32:35]
    ds_read_b64_tr_b16 v[132:133], v203 offset:18432
    v_mfma_f32_16x16x32_bf16 v[36:39], v[180:183], v[160:163], v[36:39]
    ds_read_b64_tr_b16 v[134:135], v203 offset:20736
    v_mfma_f32_16x16x32_bf16 v[40:43], v[180:183], v[164:167], v[40:43]
    ds_read_b64_tr_b16 v[136:137], v201 offset:18624
    v_mfma_f32_16x16x32_bf16 v[44:47], v[180:183], v[168:171], v[44:47]
    ds_read_b64_tr_b16 v[138:139], v201 offset:20928
    v_mfma_f32_16x16x32_bf16 v[48:51], v[184:187], v[156:159], v[48:51]
    ds_read_b64_tr_b16 v[140:141], v203 offset:18624
    v_mfma_f32_16x16x32_bf16 v[52:55], v[184:187], v[160:163], v[52:55]
    ds_read_b64_tr_b16 v[142:143], v203 offset:20928
    v_mfma_f32_16x16x32_bf16 v[56:59], v[184:187], v[164:167], v[56:59]
    ds_read_b64_tr_b16 v[144:145], v201 offset:18816
    v_mfma_f32_16x16x32_bf16 v[60:63], v[184:187], v[168:171], v[60:63]
    ds_read_b64_tr_b16 v[146:147], v201 offset:21120
    v_mfma_f32_16x16x32_bf16 v[64:67], v[156:159], v[188:191], v[64:67]
    ds_read_b64_tr_b16 v[148:149], v203 offset:18816
    v_mfma_f32_16x16x32_bf16 v[68:71], v[160:163], v[188:191], v[68:71]
    ds_read_b64_tr_b16 v[150:151], v203 offset:21120
    v_mfma_f32_16x16x32_bf16 v[72:75], v[164:167], v[188:191], v[72:75]
    ds_read_b64_tr_b16 v[152:153], v205 offset:18432
    v_mfma_f32_16x16x32_bf16 v[76:79], v[168:171], v[188:191], v[76:79]
    ds_read_b64_tr_b16 v[154:155], v205 offset:20736
    v_mfma_f32_16x16x32_bf16 v[80:83], v[156:159], v[192:195], v[80:83]
    v_mfma_f32_16x16x32_bf16 v[84:87], v[160:163], v[192:195], v[84:87]
    v_mfma_f32_16x16x32_bf16 v[88:91], v[164:167], v[192:195], v[88:91]
    v_mfma_f32_16x16x32_bf16 v[92:95], v[168:171], v[192:195], v[92:95]
    v_mfma_f32_16x16x32_bf16 v[96:99], v[196:199], v[156:159], v[96:99]
    v_mfma_f32_16x16x32_bf16 v[100:103], v[196:199], v[160:163], v[100:103]
    v_mfma_f32_16x16x32_bf16 v[104:107], v[196:199], v[164:167], v[104:107]
    v_mfma_f32_16x16x32_bf16 v[108:111], v[196:199], v[168:171], v[108:111]
    s_waitcnt lgkmcnt(0)
    v_mfma_f32_16x16x32_bf16 v[0:3], v[128:131], v[112:115], v[0:3]
    v_mfma_f32_16x16x32_bf16 v[4:7], v[128:131], v[116:119], v[4:7]
    s_barrier
    v_mfma_f32_16x16x32_bf16 v[8:11], v[128:131], v[120:123], v[8:11]
    ds_read_b128 v[156:159], v207 offset:32768
    v_mfma_f32_16x16x32_bf16 v[12:15], v[128:131], v[124:127], v[12:15]
    ds_read_b64_tr_b16 v[172:173], v201 offset:36864
    v_mfma_f32_16x16x32_bf16 v[16:19], v[132:135], v[112:115], v[16:19]
    ds_read_b64_tr_b16 v[174:175], v201 offset:39168
    v_mfma_f32_16x16x32_bf16 v[20:23], v[132:135], v[116:119], v[20:23]
    ds_read_b128 v[160:163], v207 offset:34816
    v_mfma_f32_16x16x32_bf16 v[24:27], v[132:135], v[120:123], v[24:27]
    ds_read_b128 v[164:167], v207 offset:36864
    v_mfma_f32_16x16x32_bf16 v[28:31], v[132:135], v[124:127], v[28:31]
    ds_read_b128 v[168:171], v207 offset:38912
    v_mfma_f32_16x16x32_bf16 v[32:35], v[136:139], v[112:115], v[32:35]
    ds_read_b64_tr_b16 v[176:177], v203 offset:36864
    v_mfma_f32_16x16x32_bf16 v[36:39], v[136:139], v[116:119], v[36:39]
    ds_read_b64_tr_b16 v[178:179], v203 offset:39168
    v_mfma_f32_16x16x32_bf16 v[40:43], v[136:139], v[120:123], v[40:43]
    ds_read_b64_tr_b16 v[180:181], v201 offset:37056
    v_mfma_f32_16x16x32_bf16 v[44:47], v[136:139], v[124:127], v[44:47]
    ds_read_b64_tr_b16 v[182:183], v201 offset:39360
    v_mfma_f32_16x16x32_bf16 v[48:51], v[140:143], v[112:115], v[48:51]
    ds_read_b64_tr_b16 v[184:185], v203 offset:37056
    v_mfma_f32_16x16x32_bf16 v[52:55], v[140:143], v[116:119], v[52:55]
    ds_read_b64_tr_b16 v[186:187], v203 offset:39360
    v_mfma_f32_16x16x32_bf16 v[56:59], v[140:143], v[120:123], v[56:59]
    ds_read_b64_tr_b16 v[188:189], v201 offset:37248
    v_mfma_f32_16x16x32_bf16 v[60:63], v[140:143], v[124:127], v[60:63]
    ds_read_b64_tr_b16 v[190:191], v201 offset:39552
    v_mfma_f32_16x16x32_bf16 v[64:67], v[112:115], v[144:147], v[64:67]
    ds_read_b64_tr_b16 v[192:193], v203 offset:37248
    v_mfma_f32_16x16x32_bf16 v[68:71], v[116:119], v[144:147], v[68:71]
    ds_read_b64_tr_b16 v[194:195], v203 offset:39552
    v_mfma_f32_16x16x32_bf16 v[72:75], v[120:123], v[144:147], v[72:75]
    ds_read_b64_tr_b16 v[196:197], v205 offset:36864
    v_mfma_f32_16x16x32_bf16 v[76:79], v[124:127], v[144:147], v[76:79]
    ds_read_b64_tr_b16 v[198:199], v205 offset:39168
    v_mfma_f32_16x16x32_bf16 v[80:83], v[112:115], v[148:151], v[80:83]
    v_mfma_f32_16x16x32_bf16 v[84:87], v[116:119], v[148:151], v[84:87]
    v_mfma_f32_16x16x32_bf16 v[88:91], v[120:123], v[148:151], v[88:91]
    v_mfma_f32_16x16x32_bf16 v[92:95], v[124:127], v[148:151], v[92:95]
    v_mfma_f32_16x16x32_bf16 v[96:99], v[152:155], v[112:115], v[96:99]
    v_mfma_f32_16x16x32_bf16 v[100:103], v[152:155], v[116:119], v[100:103]
    v_mfma_f32_16x16x32_bf16 v[104:107], v[152:155], v[120:123], v[104:107]
    v_mfma_f32_16x16x32_bf16 v[108:111], v[152:155], v[124:127], v[108:111]
    s_waitcnt lgkmcnt(0)
    v_mfma_f32_16x16x32_bf16 v[0:3], v[172:175], v[156:159], v[0:3]
    v_mfma_f32_16x16x32_bf16 v[4:7], v[172:175], v[160:163], v[4:7]
    s_barrier
    v_mfma_f32_16x16x32_bf16 v[8:11], v[172:175], v[164:167], v[8:11]
    ds_read_b128 v[112:115], v206 offset:0
    v_mfma_f32_16x16x32_bf16 v[12:15], v[172:175], v[168:171], v[12:15]
    ds_read_b64_tr_b16 v[128:129], v200 offset:0
    v_mfma_f32_16x16x32_bf16 v[16:19], v[176:179], v[156:159], v[16:19]
    ds_read_b64_tr_b16 v[130:131], v200 offset:2304
    v_mfma_f32_16x16x32_bf16 v[20:23], v[176:179], v[160:163], v[20:23]
    ds_read_b128 v[116:119], v206 offset:2048
    v_mfma_f32_16x16x32_bf16 v[24:27], v[176:179], v[164:167], v[24:27]
    ds_read_b128 v[120:123], v206 offset:4096
    v_mfma_f32_16x16x32_bf16 v[28:31], v[176:179], v[168:171], v[28:31]
    ds_read_b128 v[124:127], v206 offset:6144
    v_mfma_f32_16x16x32_bf16 v[32:35], v[180:183], v[156:159], v[32:35]
    ds_read_b64_tr_b16 v[132:133], v202 offset:0
    v_mfma_f32_16x16x32_bf16 v[36:39], v[180:183], v[160:163], v[36:39]
    ds_read_b64_tr_b16 v[134:135], v202 offset:2304
    v_mfma_f32_16x16x32_bf16 v[40:43], v[180:183], v[164:167], v[40:43]
    ds_read_b64_tr_b16 v[136:137], v200 offset:192
    v_mfma_f32_16x16x32_bf16 v[44:47], v[180:183], v[168:171], v[44:47]
    ds_read_b64_tr_b16 v[138:139], v200 offset:2496
    v_mfma_f32_16x16x32_bf16 v[48:51], v[184:187], v[156:159], v[48:51]
    ds_read_b64_tr_b16 v[140:141], v202 offset:192
    v_mfma_f32_16x16x32_bf16 v[52:55], v[184:187], v[160:163], v[52:55]
    ds_read_b64_tr_b16 v[142:143], v202 offset:2496
    v_mfma_f32_16x16x32_bf16 v[56:59], v[184:187], v[164:167], v[56:59]
    ds_read_b64_tr_b16 v[144:145], v200 offset:384
    v_mfma_f32_16x16x32_bf16 v[60:63], v[184:187], v[168:171], v[60:63]
    ds_read_b64_tr_b16 v[146:147], v200 offset:2688
    v_mfma_f32_16x16x32_bf16 v[64:67], v[156:159], v[188:191], v[64:67]
    ds_read_b64_tr_b16 v[148:149], v202 offset:384
    v_mfma_f32_16x16x32_bf16 v[68:71], v[160:163], v[188:191], v[68:71]
    ds_read_b64_tr_b16 v[150:151], v202 offset:2688
    v_mfma_f32_16x16x32_bf16 v[72:75], v[164:167], v[188:191], v[72:75]
    ds_read_b64_tr_b16 v[152:153], v204 offset:0
    v_mfma_f32_16x16x32_bf16 v[76:79], v[168:171], v[188:191], v[76:79]
    ds_read_b64_tr_b16 v[154:155], v204 offset:2304
    v_mfma_f32_16x16x32_bf16 v[80:83], v[156:159], v[192:195], v[80:83]
    v_mfma_f32_16x16x32_bf16 v[84:87], v[160:163], v[192:195], v[84:87]
    v_mfma_f32_16x16x32_bf16 v[88:91], v[164:167], v[192:195], v[88:91]
    v_mfma_f32_16x16x32_bf16 v[92:95], v[168:171], v[192:195], v[92:95]
    v_mfma_f32_16x16x32_bf16 v[96:99], v[196:199], v[156:159], v[96:99]
    v_mfma_f32_16x16x32_bf16 v[100:103], v[196:199], v[160:163], v[100:103]
    v_mfma_f32_16x16x32_bf16 v[104:107], v[196:199], v[164:167], v[104:107]
    v_mfma_f32_16x16x32_bf16 v[108:111], v[196:199], v[168:171], v[108:111]
    s_waitcnt lgkmcnt(0)
    v_mfma_f32_16x16x32_bf16 v[0:3], v[128:131], v[112:115], v[0:3]
    v_mfma_f32_16x16x32_bf16 v[4:7], v[128:131], v[116:119], v[4:7]
    s_barrier
    v_mfma_f32_16x16x32_bf16 v[8:11], v[128:131], v[120:123], v[8:11]
    ds_read_b128 v[156:159], v207 offset:0
    v_mfma_f32_16x16x32_bf16 v[12:15], v[128:131], v[124:127], v[12:15]
    ds_read_b64_tr_b16 v[172:173], v200 offset:18432
    v_mfma_f32_16x16x32_bf16 v[16:19], v[132:135], v[112:115], v[16:19]
    ds_read_b64_tr_b16 v[174:175], v200 offset:20736
    v_mfma_f32_16x16x32_bf16 v[20:23], v[132:135], v[116:119], v[20:23]
    ds_read_b128 v[160:163], v207 offset:2048
    v_mfma_f32_16x16x32_bf16 v[24:27], v[132:135], v[120:123], v[24:27]
    ds_read_b128 v[164:167], v207 offset:4096
    v_mfma_f32_16x16x32_bf16 v[28:31], v[132:135], v[124:127], v[28:31]
    ds_read_b128 v[168:171], v207 offset:6144
    v_mfma_f32_16x16x32_bf16 v[32:35], v[136:139], v[112:115], v[32:35]
    ds_read_b64_tr_b16 v[176:177], v202 offset:18432
    v_mfma_f32_16x16x32_bf16 v[36:39], v[136:139], v[116:119], v[36:39]
    ds_read_b64_tr_b16 v[178:179], v202 offset:20736
    v_mfma_f32_16x16x32_bf16 v[40:43], v[136:139], v[120:123], v[40:43]
    ds_read_b64_tr_b16 v[180:181], v200 offset:18624
    v_mfma_f32_16x16x32_bf16 v[44:47], v[136:139], v[124:127], v[44:47]
    ds_read_b64_tr_b16 v[182:183], v200 offset:20928
    v_mfma_f32_16x16x32_bf16 v[48:51], v[140:143], v[112:115], v[48:51]
    ds_read_b64_tr_b16 v[184:185], v202 offset:18624
    v_mfma_f32_16x16x32_bf16 v[52:55], v[140:143], v[116:119], v[52:55]
    ds_read_b64_tr_b16 v[186:187], v202 offset:20928
    v_mfma_f32_16x16x32_bf16 v[56:59], v[140:143], v[120:123], v[56:59]
    ds_read_b64_tr_b16 v[188:189], v200 offset:18816
    v_mfma_f32_16x16x32_bf16 v[60:63], v[140:143], v[124:127], v[60:63]
    ds_read_b64_tr_b16 v[190:191], v200 offset:21120
    v_mfma_f32_16x16x32_bf16 v[64:67], v[112:115], v[144:147], v[64:67]
    ds_read_b64_tr_b16 v[192:193], v202 offset:18816
    v_mfma_f32_16x16x32_bf16 v[68:71], v[116:119], v[144:147], v[68:71]
    ds_read_b64_tr_b16 v[194:195], v202 offset:21120
    v_mfma_f32_16x16x32_bf16 v[72:75], v[120:123], v[144:147], v[72:75]
    ds_read_b64_tr_b16 v[196:197], v204 offset:18432
    v_mfma_f32_16x16x32_bf16 v[76:79], v[124:127], v[144:147], v[76:79]
    ds_read_b64_tr_b16 v[198:199], v204 offset:20736
    v_mfma_f32_16x16x32_bf16 v[80:83], v[112:115], v[148:151], v[80:83]
    v_mfma_f32_16x16x32_bf16 v[84:87], v[116:119], v[148:151], v[84:87]
    v_mfma_f32_16x16x32_bf16 v[88:91], v[120:123], v[148:151], v[88:91]
    v_mfma_f32_16x16x32_bf16 v[92:95], v[124:127], v[148:151], v[92:95]
    v_mfma_f32_16x16x32_bf16 v[96:99], v[152:155], v[112:115], v[96:99]
    v_mfma_f32_16x16x32_bf16 v[100:103], v[152:155], v[116:119], v[100:103]
    v_mfma_f32_16x16x32_bf16 v[104:107], v[152:155], v[120:123], v[104:107]
    v_mfma_f32_16x16x32_bf16 v[108:111], v[152:155], v[124:127], v[108:111]
    s_waitcnt lgkmcnt(0)
    v_mfma_f32_16x16x32_bf16 v[0:3], v[172:175], v[156:159], v[0:3]
    v_mfma_f32_16x16x32_bf16 v[4:7], v[172:175], v[160:163], v[4:7]
    s_barrier
    v_mfma_f32_16x16x32_bf16 v[8:11], v[172:175], v[164:167], v[8:11]
    ds_read_b128 v[112:115], v206 offset:16384
    v_mfma_f32_16x16x32_bf16 v[12:15], v[172:175], v[168:171], v[12:15]
    ds_read_b64_tr_b16 v[128:129], v200 offset:36864
    v_mfma_f32_16x16x32_bf16 v[16:19], v[176:179], v[156:159], v[16:19]
    ds_read_b64_tr_b16 v[130:131], v200 offset:39168
    v_mfma_f32_16x16x32_bf16 v[20:23], v[176:179], v[160:163], v[20:23]
    ds_read_b128 v[116:119], v206 offset:18432
    v_mfma_f32_16x16x32_bf16 v[24:27], v[176:179], v[164:167], v[24:27]
    ds_read_b128 v[120:123], v206 offset:20480
    v_mfma_f32_16x16x32_bf16 v[28:31], v[176:179], v[168:171], v[28:31]
    ds_read_b128 v[124:127], v206 offset:22528
    v_mfma_f32_16x16x32_bf16 v[32:35], v[180:183], v[156:159], v[32:35]
    ds_read_b64_tr_b16 v[132:133], v202 offset:36864
    v_mfma_f32_16x16x32_bf16 v[36:39], v[180:183], v[160:163], v[36:39]
    ds_read_b64_tr_b16 v[134:135], v202 offset:39168
    v_mfma_f32_16x16x32_bf16 v[40:43], v[180:183], v[164:167], v[40:43]
    ds_read_b64_tr_b16 v[136:137], v200 offset:37056
    v_mfma_f32_16x16x32_bf16 v[44:47], v[180:183], v[168:171], v[44:47]
    ds_read_b64_tr_b16 v[138:139], v200 offset:39360
    v_mfma_f32_16x16x32_bf16 v[48:51], v[184:187], v[156:159], v[48:51]
    ds_read_b64_tr_b16 v[140:141], v202 offset:37056
    v_mfma_f32_16x16x32_bf16 v[52:55], v[184:187], v[160:163], v[52:55]
    ds_read_b64_tr_b16 v[142:143], v202 offset:39360
    v_mfma_f32_16x16x32_bf16 v[56:59], v[184:187], v[164:167], v[56:59]
    ds_read_b64_tr_b16 v[144:145], v200 offset:37248
    v_mfma_f32_16x16x32_bf16 v[60:63], v[184:187], v[168:171], v[60:63]
    ds_read_b64_tr_b16 v[146:147], v200 offset:39552
    v_mfma_f32_16x16x32_bf16 v[64:67], v[156:159], v[188:191], v[64:67]
    ds_read_b64_tr_b16 v[148:149], v202 offset:37248
    v_mfma_f32_16x16x32_bf16 v[68:71], v[160:163], v[188:191], v[68:71]
    ds_read_b64_tr_b16 v[150:151], v202 offset:39552
    v_mfma_f32_16x16x32_bf16 v[72:75], v[164:167], v[188:191], v[72:75]
    ds_read_b64_tr_b16 v[152:153], v204 offset:36864
    v_mfma_f32_16x16x32_bf16 v[76:79], v[168:171], v[188:191], v[76:79]
    ds_read_b64_tr_b16 v[154:155], v204 offset:39168
    v_mfma_f32_16x16x32_bf16 v[80:83], v[156:159], v[192:195], v[80:83]
    v_mfma_f32_16x16x32_bf16 v[84:87], v[160:163], v[192:195], v[84:87]
    v_mfma_f32_16x16x32_bf16 v[88:91], v[164:167], v[192:195], v[88:91]
    v_mfma_f32_16x16x32_bf16 v[92:95], v[168:171], v[192:195], v[92:95]
    v_mfma_f32_16x16x32_bf16 v[96:99], v[196:199], v[156:159], v[96:99]
    v_mfma_f32_16x16x32_bf16 v[100:103], v[196:199], v[160:163], v[100:103]
    v_mfma_f32_16x16x32_bf16 v[104:107], v[196:199], v[164:167], v[104:107]
    v_mfma_f32_16x16x32_bf16 v[108:111], v[196:199], v[168:171], v[108:111]
    s_waitcnt lgkmcnt(0)
    v_mfma_f32_16x16x32_bf16 v[0:3], v[128:131], v[112:115], v[0:3]
    v_mfma_f32_16x16x32_bf16 v[4:7], v[128:131], v[116:119], v[4:7]
    s_barrier
    v_mfma_f32_16x16x32_bf16 v[8:11], v[128:131], v[120:123], v[8:11]
    ds_read_b128 v[156:159], v207 offset:16384
    v_mfma_f32_16x16x32_bf16 v[12:15], v[128:131], v[124:127], v[12:15]
    ds_read_b64_tr_b16 v[172:173], v201 offset:0
    v_mfma_f32_16x16x32_bf16 v[16:19], v[132:135], v[112:115], v[16:19]
    ds_read_b64_tr_b16 v[174:175], v201 offset:2304
    v_mfma_f32_16x16x32_bf16 v[20:23], v[132:135], v[116:119], v[20:23]
    ds_read_b128 v[160:163], v207 offset:18432
    v_mfma_f32_16x16x32_bf16 v[24:27], v[132:135], v[120:123], v[24:27]
    ds_read_b128 v[164:167], v207 offset:20480
    v_mfma_f32_16x16x32_bf16 v[28:31], v[132:135], v[124:127], v[28:31]
    ds_read_b128 v[168:171], v207 offset:22528
    v_mfma_f32_16x16x32_bf16 v[32:35], v[136:139], v[112:115], v[32:35]
    ds_read_b64_tr_b16 v[176:177], v203 offset:0
    v_mfma_f32_16x16x32_bf16 v[36:39], v[136:139], v[116:119], v[36:39]
    ds_read_b64_tr_b16 v[178:179], v203 offset:2304
    v_mfma_f32_16x16x32_bf16 v[40:43], v[136:139], v[120:123], v[40:43]
    ds_read_b64_tr_b16 v[180:181], v201 offset:192
    v_mfma_f32_16x16x32_bf16 v[44:47], v[136:139], v[124:127], v[44:47]
    ds_read_b64_tr_b16 v[182:183], v201 offset:2496
    v_mfma_f32_16x16x32_bf16 v[48:51], v[140:143], v[112:115], v[48:51]
    ds_read_b64_tr_b16 v[184:185], v203 offset:192
    v_mfma_f32_16x16x32_bf16 v[52:55], v[140:143], v[116:119], v[52:55]
    ds_read_b64_tr_b16 v[186:187], v203 offset:2496
    v_mfma_f32_16x16x32_bf16 v[56:59], v[140:143], v[120:123], v[56:59]
    ds_read_b64_tr_b16 v[188:189], v201 offset:384
    v_mfma_f32_16x16x32_bf16 v[60:63], v[140:143], v[124:127], v[60:63]
    ds_read_b64_tr_b16 v[190:191], v201 offset:2688
    v_mfma_f32_16x16x32_bf16 v[64:67], v[112:115], v[144:147], v[64:67]
    ds_read_b64_tr_b16 v[192:193], v203 offset:384
    v_mfma_f32_16x16x32_bf16 v[68:71], v[116:119], v[144:147], v[68:71]
    ds_read_b64_tr_b16 v[194:195], v203 offset:2688
    v_mfma_f32_16x16x32_bf16 v[72:75], v[120:123], v[144:147], v[72:75]
    ds_read_b64_tr_b16 v[196:197], v205 offset:0
    v_mfma_f32_16x16x32_bf16 v[76:79], v[124:127], v[144:147], v[76:79]
    ds_read_b64_tr_b16 v[198:199], v205 offset:2304
    v_mfma_f32_16x16x32_bf16 v[80:83], v[112:115], v[148:151], v[80:83]
    v_mfma_f32_16x16x32_bf16 v[84:87], v[116:119], v[148:151], v[84:87]
    v_mfma_f32_16x16x32_bf16 v[88:91], v[120:123], v[148:151], v[88:91]
    v_mfma_f32_16x16x32_bf16 v[92:95], v[124:127], v[148:151], v[92:95]
    v_mfma_f32_16x16x32_bf16 v[96:99], v[152:155], v[112:115], v[96:99]
    v_mfma_f32_16x16x32_bf16 v[100:103], v[152:155], v[116:119], v[100:103]
    v_mfma_f32_16x16x32_bf16 v[104:107], v[152:155], v[120:123], v[104:107]
    v_mfma_f32_16x16x32_bf16 v[108:111], v[152:155], v[124:127], v[108:111]
    s_waitcnt lgkmcnt(0)
    v_mfma_f32_16x16x32_bf16 v[0:3], v[172:175], v[156:159], v[0:3]
    v_mfma_f32_16x16x32_bf16 v[4:7], v[172:175], v[160:163], v[4:7]
    s_barrier
    v_mfma_f32_16x16x32_bf16 v[8:11], v[172:175], v[164:167], v[8:11]
    ds_read_b128 v[112:115], v206 offset:32768
    v_mfma_f32_16x16x32_bf16 v[12:15], v[172:175], v[168:171], v[12:15]
    ds_read_b64_tr_b16 v[128:129], v201 offset:18432
    v_mfma_f32_16x16x32_bf16 v[16:19], v[176:179], v[156:159], v[16:19]
    ds_read_b64_tr_b16 v[130:131], v201 offset:20736
    v_mfma_f32_16x16x32_bf16 v[20:23], v[176:179], v[160:163], v[20:23]
    ds_read_b128 v[116:119], v206 offset:34816
    v_mfma_f32_16x16x32_bf16 v[24:27], v[176:179], v[164:167], v[24:27]
    ds_read_b128 v[120:123], v206 offset:36864
    v_mfma_f32_16x16x32_bf16 v[28:31], v[176:179], v[168:171], v[28:31]
    ds_read_b128 v[124:127], v206 offset:38912
    v_mfma_f32_16x16x32_bf16 v[32:35], v[180:183], v[156:159], v[32:35]
    ds_read_b64_tr_b16 v[132:133], v203 offset:18432
    v_mfma_f32_16x16x32_bf16 v[36:39], v[180:183], v[160:163], v[36:39]
    ds_read_b64_tr_b16 v[134:135], v203 offset:20736
    v_mfma_f32_16x16x32_bf16 v[40:43], v[180:183], v[164:167], v[40:43]
    ds_read_b64_tr_b16 v[136:137], v201 offset:18624
    v_mfma_f32_16x16x32_bf16 v[44:47], v[180:183], v[168:171], v[44:47]
    ds_read_b64_tr_b16 v[138:139], v201 offset:20928
    v_mfma_f32_16x16x32_bf16 v[48:51], v[184:187], v[156:159], v[48:51]
    ds_read_b64_tr_b16 v[140:141], v203 offset:18624
    v_mfma_f32_16x16x32_bf16 v[52:55], v[184:187], v[160:163], v[52:55]
    ds_read_b64_tr_b16 v[142:143], v203 offset:20928
    v_mfma_f32_16x16x32_bf16 v[56:59], v[184:187], v[164:167], v[56:59]
    ds_read_b64_tr_b16 v[144:145], v201 offset:18816
    v_mfma_f32_16x16x32_bf16 v[60:63], v[184:187], v[168:171], v[60:63]
    ds_read_b64_tr_b16 v[146:147], v201 offset:21120
    v_mfma_f32_16x16x32_bf16 v[64:67], v[156:159], v[188:191], v[64:67]
    ds_read_b64_tr_b16 v[148:149], v203 offset:18816
    v_mfma_f32_16x16x32_bf16 v[68:71], v[160:163], v[188:191], v[68:71]
    ds_read_b64_tr_b16 v[150:151], v203 offset:21120
    v_mfma_f32_16x16x32_bf16 v[72:75], v[164:167], v[188:191], v[72:75]
    ds_read_b64_tr_b16 v[152:153], v205 offset:18432
    v_mfma_f32_16x16x32_bf16 v[76:79], v[168:171], v[188:191], v[76:79]
    ds_read_b64_tr_b16 v[154:155], v205 offset:20736
    v_mfma_f32_16x16x32_bf16 v[80:83], v[156:159], v[192:195], v[80:83]
    v_mfma_f32_16x16x32_bf16 v[84:87], v[160:163], v[192:195], v[84:87]
    v_mfma_f32_16x16x32_bf16 v[88:91], v[164:167], v[192:195], v[88:91]
    v_mfma_f32_16x16x32_bf16 v[92:95], v[168:171], v[192:195], v[92:95]
    v_mfma_f32_16x16x32_bf16 v[96:99], v[196:199], v[156:159], v[96:99]
    v_mfma_f32_16x16x32_bf16 v[100:103], v[196:199], v[160:163], v[100:103]
    v_mfma_f32_16x16x32_bf16 v[104:107], v[196:199], v[164:167], v[104:107]
    v_mfma_f32_16x16x32_bf16 v[108:111], v[196:199], v[168:171], v[108:111]
    s_waitcnt lgkmcnt(0)
    v_mfma_f32_16x16x32_bf16 v[0:3], v[128:131], v[112:115], v[0:3]
    v_mfma_f32_16x16x32_bf16 v[4:7], v[128:131], v[116:119], v[4:7]
    s_barrier
    v_mfma_f32_16x16x32_bf16 v[8:11], v[128:131], v[120:123], v[8:11]
    ds_read_b128 v[156:159], v207 offset:32768
    v_mfma_f32_16x16x32_bf16 v[12:15], v[128:131], v[124:127], v[12:15]
    ds_read_b64_tr_b16 v[172:173], v201 offset:36864
    v_mfma_f32_16x16x32_bf16 v[16:19], v[132:135], v[112:115], v[16:19]
    ds_read_b64_tr_b16 v[174:175], v201 offset:39168
    v_mfma_f32_16x16x32_bf16 v[20:23], v[132:135], v[116:119], v[20:23]
    ds_read_b128 v[160:163], v207 offset:34816
    v_mfma_f32_16x16x32_bf16 v[24:27], v[132:135], v[120:123], v[24:27]
    ds_read_b128 v[164:167], v207 offset:36864
    v_mfma_f32_16x16x32_bf16 v[28:31], v[132:135], v[124:127], v[28:31]
    ds_read_b128 v[168:171], v207 offset:38912
    v_mfma_f32_16x16x32_bf16 v[32:35], v[136:139], v[112:115], v[32:35]
    ds_read_b64_tr_b16 v[176:177], v203 offset:36864
    v_mfma_f32_16x16x32_bf16 v[36:39], v[136:139], v[116:119], v[36:39]
    ds_read_b64_tr_b16 v[178:179], v203 offset:39168
    v_mfma_f32_16x16x32_bf16 v[40:43], v[136:139], v[120:123], v[40:43]
    ds_read_b64_tr_b16 v[180:181], v201 offset:37056
    v_mfma_f32_16x16x32_bf16 v[44:47], v[136:139], v[124:127], v[44:47]
    ds_read_b64_tr_b16 v[182:183], v201 offset:39360
    v_mfma_f32_16x16x32_bf16 v[48:51], v[140:143], v[112:115], v[48:51]
    ds_read_b64_tr_b16 v[184:185], v203 offset:37056
    v_mfma_f32_16x16x32_bf16 v[52:55], v[140:143], v[116:119], v[52:55]
    ds_read_b64_tr_b16 v[186:187], v203 offset:39360
    v_mfma_f32_16x16x32_bf16 v[56:59], v[140:143], v[120:123], v[56:59]
    ds_read_b64_tr_b16 v[188:189], v201 offset:37248
    v_mfma_f32_16x16x32_bf16 v[60:63], v[140:143], v[124:127], v[60:63]
    ds_read_b64_tr_b16 v[190:191], v201 offset:39552
    v_mfma_f32_16x16x32_bf16 v[64:67], v[112:115], v[144:147], v[64:67]
    ds_read_b64_tr_b16 v[192:193], v203 offset:37248
    v_mfma_f32_16x16x32_bf16 v[68:71], v[116:119], v[144:147], v[68:71]
    ds_read_b64_tr_b16 v[194:195], v203 offset:39552
    v_mfma_f32_16x16x32_bf16 v[72:75], v[120:123], v[144:147], v[72:75]
    ds_read_b64_tr_b16 v[196:197], v205 offset:36864
    v_mfma_f32_16x16x32_bf16 v[76:79], v[124:127], v[144:147], v[76:79]
    ds_read_b64_tr_b16 v[198:199], v205 offset:39168
    v_mfma_f32_16x16x32_bf16 v[80:83], v[112:115], v[148:151], v[80:83]
    v_mfma_f32_16x16x32_bf16 v[84:87], v[116:119], v[148:151], v[84:87]
    v_mfma_f32_16x16x32_bf16 v[88:91], v[120:123], v[148:151], v[88:91]
    v_mfma_f32_16x16x32_bf16 v[92:95], v[124:127], v[148:151], v[92:95]
    v_mfma_f32_16x16x32_bf16 v[96:99], v[152:155], v[112:115], v[96:99]
    v_mfma_f32_16x16x32_bf16 v[100:103], v[152:155], v[116:119], v[100:103]
    v_mfma_f32_16x16x32_bf16 v[104:107], v[152:155], v[120:123], v[104:107]
    v_mfma_f32_16x16x32_bf16 v[108:111], v[152:155], v[124:127], v[108:111]
    s_waitcnt lgkmcnt(0)
    v_mfma_f32_16x16x32_bf16 v[0:3], v[172:175], v[156:159], v[0:3]
    v_mfma_f32_16x16x32_bf16 v[4:7], v[172:175], v[160:163], v[4:7]
    s_barrier
    v_mfma_f32_16x16x32_bf16 v[8:11], v[172:175], v[164:167], v[8:11]
    ds_read_b128 v[112:115], v206 offset:0
    v_mfma_f32_16x16x32_bf16 v[12:15], v[172:175], v[168:171], v[12:15]
    ds_read_b64_tr_b16 v[128:129], v200 offset:0
    v_mfma_f32_16x16x32_bf16 v[16:19], v[176:179], v[156:159], v[16:19]
    ds_read_b64_tr_b16 v[130:131], v200 offset:2304
    v_mfma_f32_16x16x32_bf16 v[20:23], v[176:179], v[160:163], v[20:23]
    ds_read_b128 v[116:119], v206 offset:2048
    v_mfma_f32_16x16x32_bf16 v[24:27], v[176:179], v[164:167], v[24:27]
    ds_read_b128 v[120:123], v206 offset:4096
    v_mfma_f32_16x16x32_bf16 v[28:31], v[176:179], v[168:171], v[28:31]
    ds_read_b128 v[124:127], v206 offset:6144
    v_mfma_f32_16x16x32_bf16 v[32:35], v[180:183], v[156:159], v[32:35]
    ds_read_b64_tr_b16 v[132:133], v202 offset:0
    v_mfma_f32_16x16x32_bf16 v[36:39], v[180:183], v[160:163], v[36:39]
    ds_read_b64_tr_b16 v[134:135], v202 offset:2304
    v_mfma_f32_16x16x32_bf16 v[40:43], v[180:183], v[164:167], v[40:43]
    ds_read_b64_tr_b16 v[136:137], v200 offset:192
    v_mfma_f32_16x16x32_bf16 v[44:47], v[180:183], v[168:171], v[44:47]
    ds_read_b64_tr_b16 v[138:139], v200 offset:2496
    v_mfma_f32_16x16x32_bf16 v[48:51], v[184:187], v[156:159], v[48:51]
    ds_read_b64_tr_b16 v[140:141], v202 offset:192
    v_mfma_f32_16x16x32_bf16 v[52:55], v[184:187], v[160:163], v[52:55]
    ds_read_b64_tr_b16 v[142:143], v202 offset:2496
    v_mfma_f32_16x16x32_bf16 v[56:59], v[184:187], v[164:167], v[56:59]
    ds_read_b64_tr_b16 v[144:145], v200 offset:384
    v_mfma_f32_16x16x32_bf16 v[60:63], v[184:187], v[168:171], v[60:63]
    ds_read_b64_tr_b16 v[146:147], v200 offset:2688
    v_mfma_f32_16x16x32_bf16 v[64:67], v[156:159], v[188:191], v[64:67]
    ds_read_b64_tr_b16 v[148:149], v202 offset:384
    v_mfma_f32_16x16x32_bf16 v[68:71], v[160:163], v[188:191], v[68:71]
    ds_read_b64_tr_b16 v[150:151], v202 offset:2688
    v_mfma_f32_16x16x32_bf16 v[72:75], v[164:167], v[188:191], v[72:75]
    ds_read_b64_tr_b16 v[152:153], v204 offset:0
    v_mfma_f32_16x16x32_bf16 v[76:79], v[168:171], v[188:191], v[76:79]
    ds_read_b64_tr_b16 v[154:155], v204 offset:2304
    v_mfma_f32_16x16x32_bf16 v[80:83], v[156:159], v[192:195], v[80:83]
    v_mfma_f32_16x16x32_bf16 v[84:87], v[160:163], v[192:195], v[84:87]
    v_mfma_f32_16x16x32_bf16 v[88:91], v[164:167], v[192:195], v[88:91]
    v_mfma_f32_16x16x32_bf16 v[92:95], v[168:171], v[192:195], v[92:95]
    v_mfma_f32_16x16x32_bf16 v[96:99], v[196:199], v[156:159], v[96:99]
    v_mfma_f32_16x16x32_bf16 v[100:103], v[196:199], v[160:163], v[100:103]
    v_mfma_f32_16x16x32_bf16 v[104:107], v[196:199], v[164:167], v[104:107]
    v_mfma_f32_16x16x32_bf16 v[108:111], v[196:199], v[168:171], v[108:111]
    s_waitcnt lgkmcnt(0)
    v_mfma_f32_16x16x32_bf16 v[0:3], v[128:131], v[112:115], v[0:3]
    v_mfma_f32_16x16x32_bf16 v[4:7], v[128:131], v[116:119], v[4:7]
    s_barrier
    v_mfma_f32_16x16x32_bf16 v[8:11], v[128:131], v[120:123], v[8:11]
    ds_read_b128 v[156:159], v207 offset:0
    v_mfma_f32_16x16x32_bf16 v[12:15], v[128:131], v[124:127], v[12:15]
    ds_read_b64_tr_b16 v[172:173], v200 offset:18432
    v_mfma_f32_16x16x32_bf16 v[16:19], v[132:135], v[112:115], v[16:19]
    ds_read_b64_tr_b16 v[174:175], v200 offset:20736
    v_mfma_f32_16x16x32_bf16 v[20:23], v[132:135], v[116:119], v[20:23]
    ds_read_b128 v[160:163], v207 offset:2048
    v_mfma_f32_16x16x32_bf16 v[24:27], v[132:135], v[120:123], v[24:27]
    ds_read_b128 v[164:167], v207 offset:4096
    v_mfma_f32_16x16x32_bf16 v[28:31], v[132:135], v[124:127], v[28:31]
    ds_read_b128 v[168:171], v207 offset:6144
    v_mfma_f32_16x16x32_bf16 v[32:35], v[136:139], v[112:115], v[32:35]
    ds_read_b64_tr_b16 v[176:177], v202 offset:18432
    v_mfma_f32_16x16x32_bf16 v[36:39], v[136:139], v[116:119], v[36:39]
    ds_read_b64_tr_b16 v[178:179], v202 offset:20736
    v_mfma_f32_16x16x32_bf16 v[40:43], v[136:139], v[120:123], v[40:43]
    ds_read_b64_tr_b16 v[180:181], v200 offset:18624
    v_mfma_f32_16x16x32_bf16 v[44:47], v[136:139], v[124:127], v[44:47]
    ds_read_b64_tr_b16 v[182:183], v200 offset:20928
    v_mfma_f32_16x16x32_bf16 v[48:51], v[140:143], v[112:115], v[48:51]
    ds_read_b64_tr_b16 v[184:185], v202 offset:18624
    v_mfma_f32_16x16x32_bf16 v[52:55], v[140:143], v[116:119], v[52:55]
    ds_read_b64_tr_b16 v[186:187], v202 offset:20928
    v_mfma_f32_16x16x32_bf16 v[56:59], v[140:143], v[120:123], v[56:59]
    ds_read_b64_tr_b16 v[188:189], v200 offset:18816
    v_mfma_f32_16x16x32_bf16 v[60:63], v[140:143], v[124:127], v[60:63]
    ds_read_b64_tr_b16 v[190:191], v200 offset:21120
    v_mfma_f32_16x16x32_bf16 v[64:67], v[112:115], v[144:147], v[64:67]
    ds_read_b64_tr_b16 v[192:193], v202 offset:18816
    v_mfma_f32_16x16x32_bf16 v[68:71], v[116:119], v[144:147], v[68:71]
    ds_read_b64_tr_b16 v[194:195], v202 offset:21120
    v_mfma_f32_16x16x32_bf16 v[72:75], v[120:123], v[144:147], v[72:75]
    ds_read_b64_tr_b16 v[196:197], v204 offset:18432
    v_mfma_f32_16x16x32_bf16 v[76:79], v[124:127], v[144:147], v[76:79]
    ds_read_b64_tr_b16 v[198:199], v204 offset:20736
    v_mfma_f32_16x16x32_bf16 v[80:83], v[112:115], v[148:151], v[80:83]
    v_mfma_f32_16x16x32_bf16 v[84:87], v[116:119], v[148:151], v[84:87]
    v_mfma_f32_16x16x32_bf16 v[88:91], v[120:123], v[148:151], v[88:91]
    v_mfma_f32_16x16x32_bf16 v[92:95], v[124:127], v[148:151], v[92:95]
    v_mfma_f32_16x16x32_bf16 v[96:99], v[152:155], v[112:115], v[96:99]
    v_mfma_f32_16x16x32_bf16 v[100:103], v[152:155], v[116:119], v[100:103]
    v_mfma_f32_16x16x32_bf16 v[104:107], v[152:155], v[120:123], v[104:107]
    v_mfma_f32_16x16x32_bf16 v[108:111], v[152:155], v[124:127], v[108:111]
    s_waitcnt lgkmcnt(0)
    v_mfma_f32_16x16x32_bf16 v[0:3], v[172:175], v[156:159], v[0:3]
    v_mfma_f32_16x16x32_bf16 v[4:7], v[172:175], v[160:163], v[4:7]
    s_barrier
    v_mfma_f32_16x16x32_bf16 v[8:11], v[172:175], v[164:167], v[8:11]
    ds_read_b128 v[112:115], v206 offset:16384
    v_mfma_f32_16x16x32_bf16 v[12:15], v[172:175], v[168:171], v[12:15]
    ds_read_b64_tr_b16 v[128:129], v200 offset:36864
    v_mfma_f32_16x16x32_bf16 v[16:19], v[176:179], v[156:159], v[16:19]
    ds_read_b64_tr_b16 v[130:131], v200 offset:39168
    v_mfma_f32_16x16x32_bf16 v[20:23], v[176:179], v[160:163], v[20:23]
    ds_read_b128 v[116:119], v206 offset:18432
    v_mfma_f32_16x16x32_bf16 v[24:27], v[176:179], v[164:167], v[24:27]
    ds_read_b128 v[120:123], v206 offset:20480
    v_mfma_f32_16x16x32_bf16 v[28:31], v[176:179], v[168:171], v[28:31]
    ds_read_b128 v[124:127], v206 offset:22528
    v_mfma_f32_16x16x32_bf16 v[32:35], v[180:183], v[156:159], v[32:35]
    ds_read_b64_tr_b16 v[132:133], v202 offset:36864
    v_mfma_f32_16x16x32_bf16 v[36:39], v[180:183], v[160:163], v[36:39]
    ds_read_b64_tr_b16 v[134:135], v202 offset:39168
    v_mfma_f32_16x16x32_bf16 v[40:43], v[180:183], v[164:167], v[40:43]
    ds_read_b64_tr_b16 v[136:137], v200 offset:37056
    v_mfma_f32_16x16x32_bf16 v[44:47], v[180:183], v[168:171], v[44:47]
    ds_read_b64_tr_b16 v[138:139], v200 offset:39360
    v_mfma_f32_16x16x32_bf16 v[48:51], v[184:187], v[156:159], v[48:51]
    ds_read_b64_tr_b16 v[140:141], v202 offset:37056
    v_mfma_f32_16x16x32_bf16 v[52:55], v[184:187], v[160:163], v[52:55]
    ds_read_b64_tr_b16 v[142:143], v202 offset:39360
    v_mfma_f32_16x16x32_bf16 v[56:59], v[184:187], v[164:167], v[56:59]
    ds_read_b64_tr_b16 v[144:145], v200 offset:37248
    v_mfma_f32_16x16x32_bf16 v[60:63], v[184:187], v[168:171], v[60:63]
    ds_read_b64_tr_b16 v[146:147], v200 offset:39552
    v_mfma_f32_16x16x32_bf16 v[64:67], v[156:159], v[188:191], v[64:67]
    ds_read_b64_tr_b16 v[148:149], v202 offset:37248
    v_mfma_f32_16x16x32_bf16 v[68:71], v[160:163], v[188:191], v[68:71]
    ds_read_b64_tr_b16 v[150:151], v202 offset:39552
    v_mfma_f32_16x16x32_bf16 v[72:75], v[164:167], v[188:191], v[72:75]
    ds_read_b64_tr_b16 v[152:153], v204 offset:36864
    v_mfma_f32_16x16x32_bf16 v[76:79], v[168:171], v[188:191], v[76:79]
    ds_read_b64_tr_b16 v[154:155], v204 offset:39168
    v_mfma_f32_16x16x32_bf16 v[80:83], v[156:159], v[192:195], v[80:83]
    v_mfma_f32_16x16x32_bf16 v[84:87], v[160:163], v[192:195], v[84:87]
    v_mfma_f32_16x16x32_bf16 v[88:91], v[164:167], v[192:195], v[88:91]
    v_mfma_f32_16x16x32_bf16 v[92:95], v[168:171], v[192:195], v[92:95]
    v_mfma_f32_16x16x32_bf16 v[96:99], v[196:199], v[156:159], v[96:99]
    v_mfma_f32_16x16x32_bf16 v[100:103], v[196:199], v[160:163], v[100:103]
    v_mfma_f32_16x16x32_bf16 v[104:107], v[196:199], v[164:167], v[104:107]
    v_mfma_f32_16x16x32_bf16 v[108:111], v[196:199], v[168:171], v[108:111]
    s_waitcnt lgkmcnt(0)
    v_mfma_f32_16x16x32_bf16 v[0:3], v[128:131], v[112:115], v[0:3]
    v_mfma_f32_16x16x32_bf16 v[4:7], v[128:131], v[116:119], v[4:7]
    s_barrier
    v_mfma_f32_16x16x32_bf16 v[8:11], v[128:131], v[120:123], v[8:11]
    ds_read_b128 v[156:159], v207 offset:16384
    v_mfma_f32_16x16x32_bf16 v[12:15], v[128:131], v[124:127], v[12:15]
    ds_read_b64_tr_b16 v[172:173], v201 offset:0
    v_mfma_f32_16x16x32_bf16 v[16:19], v[132:135], v[112:115], v[16:19]
    ds_read_b64_tr_b16 v[174:175], v201 offset:2304
    v_mfma_f32_16x16x32_bf16 v[20:23], v[132:135], v[116:119], v[20:23]
    ds_read_b128 v[160:163], v207 offset:18432
    v_mfma_f32_16x16x32_bf16 v[24:27], v[132:135], v[120:123], v[24:27]
    ds_read_b128 v[164:167], v207 offset:20480
    v_mfma_f32_16x16x32_bf16 v[28:31], v[132:135], v[124:127], v[28:31]
    ds_read_b128 v[168:171], v207 offset:22528
    v_mfma_f32_16x16x32_bf16 v[32:35], v[136:139], v[112:115], v[32:35]
    ds_read_b64_tr_b16 v[176:177], v203 offset:0
    v_mfma_f32_16x16x32_bf16 v[36:39], v[136:139], v[116:119], v[36:39]
    ds_read_b64_tr_b16 v[178:179], v203 offset:2304
    v_mfma_f32_16x16x32_bf16 v[40:43], v[136:139], v[120:123], v[40:43]
    ds_read_b64_tr_b16 v[180:181], v201 offset:192
    v_mfma_f32_16x16x32_bf16 v[44:47], v[136:139], v[124:127], v[44:47]
    ds_read_b64_tr_b16 v[182:183], v201 offset:2496
    v_mfma_f32_16x16x32_bf16 v[48:51], v[140:143], v[112:115], v[48:51]
    ds_read_b64_tr_b16 v[184:185], v203 offset:192
    v_mfma_f32_16x16x32_bf16 v[52:55], v[140:143], v[116:119], v[52:55]
    ds_read_b64_tr_b16 v[186:187], v203 offset:2496
    v_mfma_f32_16x16x32_bf16 v[56:59], v[140:143], v[120:123], v[56:59]
    ds_read_b64_tr_b16 v[188:189], v201 offset:384
    v_mfma_f32_16x16x32_bf16 v[60:63], v[140:143], v[124:127], v[60:63]
    ds_read_b64_tr_b16 v[190:191], v201 offset:2688
    v_mfma_f32_16x16x32_bf16 v[64:67], v[112:115], v[144:147], v[64:67]
    ds_read_b64_tr_b16 v[192:193], v203 offset:384
    v_mfma_f32_16x16x32_bf16 v[68:71], v[116:119], v[144:147], v[68:71]
    ds_read_b64_tr_b16 v[194:195], v203 offset:2688
    v_mfma_f32_16x16x32_bf16 v[72:75], v[120:123], v[144:147], v[72:75]
    ds_read_b64_tr_b16 v[196:197], v205 offset:0
    v_mfma_f32_16x16x32_bf16 v[76:79], v[124:127], v[144:147], v[76:79]
    ds_read_b64_tr_b16 v[198:199], v205 offset:2304
    v_mfma_f32_16x16x32_bf16 v[80:83], v[112:115], v[148:151], v[80:83]
    v_mfma_f32_16x16x32_bf16 v[84:87], v[116:119], v[148:151], v[84:87]
    v_mfma_f32_16x16x32_bf16 v[88:91], v[120:123], v[148:151], v[88:91]
    v_mfma_f32_16x16x32_bf16 v[92:95], v[124:127], v[148:151], v[92:95]
    v_mfma_f32_16x16x32_bf16 v[96:99], v[152:155], v[112:115], v[96:99]
    v_mfma_f32_16x16x32_bf16 v[100:103], v[152:155], v[116:119], v[100:103]
    v_mfma_f32_16x16x32_bf16 v[104:107], v[152:155], v[120:123], v[104:107]
    v_mfma_f32_16x16x32_bf16 v[108:111], v[152:155], v[124:127], v[108:111]
    s_waitcnt lgkmcnt(0)
    v_mfma_f32_16x16x32_bf16 v[0:3], v[172:175], v[156:159], v[0:3]
    v_mfma_f32_16x16x32_bf16 v[4:7], v[172:175], v[160:163], v[4:7]
    s_barrier
    v_mfma_f32_16x16x32_bf16 v[8:11], v[172:175], v[164:167], v[8:11]
    ds_read_b128 v[112:115], v206 offset:32768
    v_mfma_f32_16x16x32_bf16 v[12:15], v[172:175], v[168:171], v[12:15]
    ds_read_b64_tr_b16 v[128:129], v201 offset:18432
    v_mfma_f32_16x16x32_bf16 v[16:19], v[176:179], v[156:159], v[16:19]
    ds_read_b64_tr_b16 v[130:131], v201 offset:20736
    v_mfma_f32_16x16x32_bf16 v[20:23], v[176:179], v[160:163], v[20:23]
    ds_read_b128 v[116:119], v206 offset:34816
    v_mfma_f32_16x16x32_bf16 v[24:27], v[176:179], v[164:167], v[24:27]
    ds_read_b128 v[120:123], v206 offset:36864
    v_mfma_f32_16x16x32_bf16 v[28:31], v[176:179], v[168:171], v[28:31]
    ds_read_b128 v[124:127], v206 offset:38912
    v_mfma_f32_16x16x32_bf16 v[32:35], v[180:183], v[156:159], v[32:35]
    ds_read_b64_tr_b16 v[132:133], v203 offset:18432
    v_mfma_f32_16x16x32_bf16 v[36:39], v[180:183], v[160:163], v[36:39]
    ds_read_b64_tr_b16 v[134:135], v203 offset:20736
    v_mfma_f32_16x16x32_bf16 v[40:43], v[180:183], v[164:167], v[40:43]
    ds_read_b64_tr_b16 v[136:137], v201 offset:18624
    v_mfma_f32_16x16x32_bf16 v[44:47], v[180:183], v[168:171], v[44:47]
    ds_read_b64_tr_b16 v[138:139], v201 offset:20928
    v_mfma_f32_16x16x32_bf16 v[48:51], v[184:187], v[156:159], v[48:51]
    ds_read_b64_tr_b16 v[140:141], v203 offset:18624
    v_mfma_f32_16x16x32_bf16 v[52:55], v[184:187], v[160:163], v[52:55]
    ds_read_b64_tr_b16 v[142:143], v203 offset:20928
    v_mfma_f32_16x16x32_bf16 v[56:59], v[184:187], v[164:167], v[56:59]
    ds_read_b64_tr_b16 v[144:145], v201 offset:18816
    v_mfma_f32_16x16x32_bf16 v[60:63], v[184:187], v[168:171], v[60:63]
    ds_read_b64_tr_b16 v[146:147], v201 offset:21120
    v_mfma_f32_16x16x32_bf16 v[64:67], v[156:159], v[188:191], v[64:67]
    ds_read_b64_tr_b16 v[148:149], v203 offset:18816
    v_mfma_f32_16x16x32_bf16 v[68:71], v[160:163], v[188:191], v[68:71]
    ds_read_b64_tr_b16 v[150:151], v203 offset:21120
    v_mfma_f32_16x16x32_bf16 v[72:75], v[164:167], v[188:191], v[72:75]
    ds_read_b64_tr_b16 v[152:153], v205 offset:18432
    v_mfma_f32_16x16x32_bf16 v[76:79], v[168:171], v[188:191], v[76:79]
    ds_read_b64_tr_b16 v[154:155], v205 offset:20736
    v_mfma_f32_16x16x32_bf16 v[80:83], v[156:159], v[192:195], v[80:83]
    v_mfma_f32_16x16x32_bf16 v[84:87], v[160:163], v[192:195], v[84:87]
    v_mfma_f32_16x16x32_bf16 v[88:91], v[164:167], v[192:195], v[88:91]
    v_mfma_f32_16x16x32_bf16 v[92:95], v[168:171], v[192:195], v[92:95]
    v_mfma_f32_16x16x32_bf16 v[96:99], v[196:199], v[156:159], v[96:99]
    v_mfma_f32_16x16x32_bf16 v[100:103], v[196:199], v[160:163], v[100:103]
    v_mfma_f32_16x16x32_bf16 v[104:107], v[196:199], v[164:167], v[104:107]
    v_mfma_f32_16x16x32_bf16 v[108:111], v[196:199], v[168:171], v[108:111]
    s_waitcnt lgkmcnt(0)
    v_mfma_f32_16x16x32_bf16 v[0:3], v[128:131], v[112:115], v[0:3]
    v_mfma_f32_16x16x32_bf16 v[4:7], v[128:131], v[116:119], v[4:7]
    s_barrier
    v_mfma_f32_16x16x32_bf16 v[8:11], v[128:131], v[120:123], v[8:11]
    ds_read_b128 v[156:159], v207 offset:32768
    v_mfma_f32_16x16x32_bf16 v[12:15], v[128:131], v[124:127], v[12:15]
    ds_read_b64_tr_b16 v[172:173], v201 offset:36864
    v_mfma_f32_16x16x32_bf16 v[16:19], v[132:135], v[112:115], v[16:19]
    ds_read_b64_tr_b16 v[174:175], v201 offset:39168
    v_mfma_f32_16x16x32_bf16 v[20:23], v[132:135], v[116:119], v[20:23]
    ds_read_b128 v[160:163], v207 offset:34816
    v_mfma_f32_16x16x32_bf16 v[24:27], v[132:135], v[120:123], v[24:27]
    ds_read_b128 v[164:167], v207 offset:36864
    v_mfma_f32_16x16x32_bf16 v[28:31], v[132:135], v[124:127], v[28:31]
    ds_read_b128 v[168:171], v207 offset:38912
    v_mfma_f32_16x16x32_bf16 v[32:35], v[136:139], v[112:115], v[32:35]
    ds_read_b64_tr_b16 v[176:177], v203 offset:36864
    v_mfma_f32_16x16x32_bf16 v[36:39], v[136:139], v[116:119], v[36:39]
    ds_read_b64_tr_b16 v[178:179], v203 offset:39168
    v_mfma_f32_16x16x32_bf16 v[40:43], v[136:139], v[120:123], v[40:43]
    ds_read_b64_tr_b16 v[180:181], v201 offset:37056
    v_mfma_f32_16x16x32_bf16 v[44:47], v[136:139], v[124:127], v[44:47]
    ds_read_b64_tr_b16 v[182:183], v201 offset:39360
    v_mfma_f32_16x16x32_bf16 v[48:51], v[140:143], v[112:115], v[48:51]
    ds_read_b64_tr_b16 v[184:185], v203 offset:37056
    v_mfma_f32_16x16x32_bf16 v[52:55], v[140:143], v[116:119], v[52:55]
    ds_read_b64_tr_b16 v[186:187], v203 offset:39360
    v_mfma_f32_16x16x32_bf16 v[56:59], v[140:143], v[120:123], v[56:59]
    ds_read_b64_tr_b16 v[188:189], v201 offset:37248
    v_mfma_f32_16x16x32_bf16 v[60:63], v[140:143], v[124:127], v[60:63]
    ds_read_b64_tr_b16 v[190:191], v201 offset:39552
    v_mfma_f32_16x16x32_bf16 v[64:67], v[112:115], v[144:147], v[64:67]
    ds_read_b64_tr_b16 v[192:193], v203 offset:37248
    v_mfma_f32_16x16x32_bf16 v[68:71], v[116:119], v[144:147], v[68:71]
    ds_read_b64_tr_b16 v[194:195], v203 offset:39552
    v_mfma_f32_16x16x32_bf16 v[72:75], v[120:123], v[144:147], v[72:75]
    ds_read_b64_tr_b16 v[196:197], v205 offset:36864
    v_mfma_f32_16x16x32_bf16 v[76:79], v[124:127], v[144:147], v[76:79]
    ds_read_b64_tr_b16 v[198:199], v205 offset:39168
    v_mfma_f32_16x16x32_bf16 v[80:83], v[112:115], v[148:151], v[80:83]
    v_mfma_f32_16x16x32_bf16 v[84:87], v[116:119], v[148:151], v[84:87]
    v_mfma_f32_16x16x32_bf16 v[88:91], v[120:123], v[148:151], v[88:91]
    v_mfma_f32_16x16x32_bf16 v[92:95], v[124:127], v[148:151], v[92:95]
    v_mfma_f32_16x16x32_bf16 v[96:99], v[152:155], v[112:115], v[96:99]
    v_mfma_f32_16x16x32_bf16 v[100:103], v[152:155], v[116:119], v[100:103]
    v_mfma_f32_16x16x32_bf16 v[104:107], v[152:155], v[120:123], v[104:107]
    v_mfma_f32_16x16x32_bf16 v[108:111], v[152:155], v[124:127], v[108:111]
    s_waitcnt lgkmcnt(0)
    v_mfma_f32_16x16x32_bf16 v[0:3], v[172:175], v[156:159], v[0:3]
    v_mfma_f32_16x16x32_bf16 v[4:7], v[172:175], v[160:163], v[4:7]
    v_mfma_f32_16x16x32_bf16 v[8:11], v[172:175], v[164:167], v[8:11]
    v_mfma_f32_16x16x32_bf16 v[12:15], v[172:175], v[168:171], v[12:15]
    v_mfma_f32_16x16x32_bf16 v[16:19], v[176:179], v[156:159], v[16:19]
    v_mfma_f32_16x16x32_bf16 v[20:23], v[176:179], v[160:163], v[20:23]
    v_mfma_f32_16x16x32_bf16 v[24:27], v[176:179], v[164:167], v[24:27]
    v_mfma_f32_16x16x32_bf16 v[28:31], v[176:179], v[168:171], v[28:31]
    v_mfma_f32_16x16x32_bf16 v[32:35], v[180:183], v[156:159], v[32:35]
    v_mfma_f32_16x16x32_bf16 v[36:39], v[180:183], v[160:163], v[36:39]
    v_mfma_f32_16x16x32_bf16 v[40:43], v[180:183], v[164:167], v[40:43]
    v_mfma_f32_16x16x32_bf16 v[44:47], v[180:183], v[168:171], v[44:47]
    v_mfma_f32_16x16x32_bf16 v[48:51], v[184:187], v[156:159], v[48:51]
    v_mfma_f32_16x16x32_bf16 v[52:55], v[184:187], v[160:163], v[52:55]
    v_mfma_f32_16x16x32_bf16 v[56:59], v[184:187], v[164:167], v[56:59]
    v_mfma_f32_16x16x32_bf16 v[60:63], v[184:187], v[168:171], v[60:63]
    v_mfma_f32_16x16x32_bf16 v[64:67], v[156:159], v[188:191], v[64:67]
    v_mfma_f32_16x16x32_bf16 v[68:71], v[160:163], v[188:191], v[68:71]
    v_mfma_f32_16x16x32_bf16 v[72:75], v[164:167], v[188:191], v[72:75]
    v_mfma_f32_16x16x32_bf16 v[76:79], v[168:171], v[188:191], v[76:79]
    v_mfma_f32_16x16x32_bf16 v[80:83], v[156:159], v[192:195], v[80:83]
    v_mfma_f32_16x16x32_bf16 v[84:87], v[160:163], v[192:195], v[84:87]
    v_mfma_f32_16x16x32_bf16 v[88:91], v[164:167], v[192:195], v[88:91]
    v_mfma_f32_16x16x32_bf16 v[92:95], v[168:171], v[192:195], v[92:95]
    v_mfma_f32_16x16x32_bf16 v[96:99], v[196:199], v[156:159], v[96:99]
    v_mfma_f32_16x16x32_bf16 v[100:103], v[196:199], v[160:163], v[100:103]
    v_mfma_f32_16x16x32_bf16 v[104:107], v[196:199], v[164:167], v[104:107]
    v_mfma_f32_16x16x32_bf16 v[108:111], v[196:199], v[168:171], v[108:111]
    s_waitcnt vmcnt(0)
    s_and_b32 s21, s21, 0xffff
    s_mov_b32 s22, 21397504
    s_mov_b32 s23, 0x00020000
    s_nop 5
    v_pk_mul_f32 v[0:1], v[0:1], s[52:53]
    v_pk_mul_f32 v[2:3], v[2:3], s[52:53]
    v_pk_mul_f32 v[4:5], v[4:5], s[52:53]
    v_pk_mul_f32 v[6:7], v[6:7], s[52:53]
    v_cvt_pk_bf16_f32 v220, v0, v1
    v_cvt_pk_bf16_f32 v221, v2, v3
    v_cvt_pk_bf16_f32 v222, v4, v5
    v_cvt_pk_bf16_f32 v223, v6, v7
    s_nop 1
    v_permlane16_swap_b32 v220, v222
    v_permlane16_swap_b32 v221, v223
    buffer_store_dwordx4 v[220:223], v212, s[20:23], s44 offen offset:0 sc1
    v_pk_mul_f32 v[8:9], v[8:9], s[52:53]
    v_pk_mul_f32 v[10:11], v[10:11], s[52:53]
    v_pk_mul_f32 v[12:13], v[12:13], s[52:53]
    v_pk_mul_f32 v[14:15], v[14:15], s[52:53]
    v_cvt_pk_bf16_f32 v224, v8, v9
    v_cvt_pk_bf16_f32 v225, v10, v11
    v_cvt_pk_bf16_f32 v226, v12, v13
    v_cvt_pk_bf16_f32 v227, v14, v15
    s_nop 1
    v_permlane16_swap_b32 v224, v226
    v_permlane16_swap_b32 v225, v227
    buffer_store_dwordx4 v[224:227], v212, s[20:23], s44 offen offset:1024 sc1
    v_pk_mul_f32 v[16:17], v[16:17], s[52:53]
    v_pk_mul_f32 v[18:19], v[18:19], s[52:53]
    v_pk_mul_f32 v[20:21], v[20:21], s[52:53]
    v_pk_mul_f32 v[22:23], v[22:23], s[52:53]
    v_cvt_pk_bf16_f32 v228, v16, v17
    v_cvt_pk_bf16_f32 v229, v18, v19
    v_cvt_pk_bf16_f32 v230, v20, v21
    v_cvt_pk_bf16_f32 v231, v22, v23
    s_nop 1
    v_permlane16_swap_b32 v228, v230
    v_permlane16_swap_b32 v229, v231
    buffer_store_dwordx4 v[228:231], v212, s[20:23], s49 offen offset:0 sc1
    v_pk_mul_f32 v[24:25], v[24:25], s[52:53]
    v_pk_mul_f32 v[26:27], v[26:27], s[52:53]
    v_pk_mul_f32 v[28:29], v[28:29], s[52:53]
    v_pk_mul_f32 v[30:31], v[30:31], s[52:53]
    v_cvt_pk_bf16_f32 v232, v24, v25
    v_cvt_pk_bf16_f32 v233, v26, v27
    v_cvt_pk_bf16_f32 v234, v28, v29
    v_cvt_pk_bf16_f32 v235, v30, v31
    s_nop 1
    v_permlane16_swap_b32 v232, v234
    v_permlane16_swap_b32 v233, v235
    buffer_store_dwordx4 v[232:235], v212, s[20:23], s49 offen offset:1024 sc1
    v_cvt_pk_bf16_f32 v220, v32, v33
    v_cvt_pk_bf16_f32 v221, v34, v35
    v_cvt_pk_bf16_f32 v222, v36, v37
    v_cvt_pk_bf16_f32 v223, v38, v39
    s_nop 1
    v_permlane16_swap_b32 v220, v222
    v_permlane16_swap_b32 v221, v223
    buffer_store_dwordx4 v[220:223], v213, s[20:23], s45 offen offset:0 sc1
    v_cvt_pk_bf16_f32 v224, v40, v41
    v_cvt_pk_bf16_f32 v225, v42, v43
    v_cvt_pk_bf16_f32 v226, v44, v45
    v_cvt_pk_bf16_f32 v227, v46, v47
    s_nop 1
    v_permlane16_swap_b32 v224, v226
    v_permlane16_swap_b32 v225, v227
    buffer_store_dwordx4 v[224:227], v213, s[20:23], s45 offen offset:1024 sc1
    v_cvt_pk_bf16_f32 v228, v48, v49
    v_cvt_pk_bf16_f32 v229, v50, v51
    v_cvt_pk_bf16_f32 v230, v52, v53
    v_cvt_pk_bf16_f32 v231, v54, v55
    s_nop 1
    v_permlane16_swap_b32 v228, v230
    v_permlane16_swap_b32 v229, v231
    buffer_store_dwordx4 v[228:231], v213, s[20:23], s50 offen offset:0 sc1
    v_cvt_pk_bf16_f32 v232, v56, v57
    v_cvt_pk_bf16_f32 v233, v58, v59
    v_cvt_pk_bf16_f32 v234, v60, v61
    v_cvt_pk_bf16_f32 v235, v62, v63
    s_nop 1
    v_permlane16_swap_b32 v232, v234
    v_permlane16_swap_b32 v233, v235
    buffer_store_dwordx4 v[232:235], v213, s[20:23], s50 offen offset:1024 sc1
    v_cvt_pk_bf16_f32 v220, v64, v65
    v_cvt_pk_bf16_f32 v221, v66, v67
    v_cvt_pk_bf16_f32 v222, v68, v69
    v_cvt_pk_bf16_f32 v223, v70, v71
    s_nop 1
    v_permlane16_swap_b32 v220, v222
    v_permlane16_swap_b32 v221, v223
    buffer_store_dwordx4 v[220:223], v214, s[20:23], s46 offen offset:0
    v_cvt_pk_bf16_f32 v224, v72, v73
    v_cvt_pk_bf16_f32 v225, v74, v75
    v_cvt_pk_bf16_f32 v226, v76, v77
    v_cvt_pk_bf16_f32 v227, v78, v79
    s_nop 1
    v_permlane16_swap_b32 v224, v226
    v_permlane16_swap_b32 v225, v227
    buffer_store_dwordx4 v[224:227], v214, s[20:23], s46 offen offset:1216
    v_cvt_pk_bf16_f32 v228, v80, v81
    v_cvt_pk_bf16_f32 v229, v82, v83
    v_cvt_pk_bf16_f32 v230, v84, v85
    v_cvt_pk_bf16_f32 v231, v86, v87
    s_nop 1
    v_permlane16_swap_b32 v228, v230
    v_permlane16_swap_b32 v229, v231
    buffer_store_dwordx4 v[228:231], v214, s[20:23], s51 offen offset:32
    v_cvt_pk_bf16_f32 v232, v88, v89
    v_cvt_pk_bf16_f32 v233, v90, v91
    v_cvt_pk_bf16_f32 v234, v92, v93
    v_cvt_pk_bf16_f32 v235, v94, v95
    s_nop 1
    v_permlane16_swap_b32 v232, v234
    v_permlane16_swap_b32 v233, v235
    buffer_store_dwordx4 v[232:235], v214, s[20:23], s51 offen offset:1248
    v_mul_f32 v96, v96, v216
    v_mul_f32 v97, v97, v216
    v_mul_f32 v98, v98, v216
    v_mul_f32 v99, v99, v216
    v_cvt_pk_bf16_f32 v220, v96, v97
    v_cvt_pk_bf16_f32 v221, v98, v99
    buffer_store_dword v220, v215, s[20:23], s47 offen offset:0
    buffer_store_dword v221, v215, s[20:23], s48 offen offset:0
    v_mul_f32 v100, v100, v216
    v_mul_f32 v101, v101, v216
    v_mul_f32 v102, v102, v216
    v_mul_f32 v103, v103, v216
    v_cvt_pk_bf16_f32 v224, v100, v101
    v_cvt_pk_bf16_f32 v225, v102, v103
    buffer_store_dword v224, v215, s[20:23], s47 offen offset:64
    buffer_store_dword v225, v215, s[20:23], s48 offen offset:64
    v_mul_f32 v104, v104, v216
    v_mul_f32 v105, v105, v216
    v_mul_f32 v106, v106, v216
    v_mul_f32 v107, v107, v216
    v_cvt_pk_bf16_f32 v228, v104, v105
    v_cvt_pk_bf16_f32 v229, v106, v107
    buffer_store_dword v228, v215, s[20:23], s47 offen offset:128
    buffer_store_dword v229, v215, s[20:23], s48 offen offset:128
    v_mul_f32 v108, v108, v216
    v_mul_f32 v109, v109, v216
    v_mul_f32 v110, v110, v216
    v_mul_f32 v111, v111, v216
    v_cvt_pk_bf16_f32 v232, v108, v109
    v_cvt_pk_bf16_f32 v233, v110, v111
    buffer_store_dword v232, v215, s[20:23], s47 offen offset:192
    buffer_store_dword v233, v215, s[20:23], s48 offen offset:192
    s_endpgm
K1_CONS1:
    v_and_b32 v217, 63, v0
    s_and_b32 s17, s3, 1
    v_lshrrev_b32 v220, 4, v217
    v_bfe_u32 v221, v217, 2, 2
    v_and_b32 v222, 3, v217
    v_lshl_add_u32 v223, v220, 3, v221
    v_mul_u32_u24 v223, 576, v223
    v_and_b32 v225, 1, v220
    v_lshlrev_b32 v225, 5, v225
    s_mul_i32 s15, s14, 144
    s_and_b32 s15, s15, 63
    s_add_u32 s16, s15, 72
    v_lshl_add_u32 v226, v222, 3, s16
    v_xor_b32 v226, v226, v225
    v_add_u32 v200, v226, v223
    s_add_u32 s16, s15, 112
    v_lshl_add_u32 v226, v222, 3, s16
    v_xor_b32 v226, v226, v225
    v_add_u32 v202, v226, v223
    v_and_b32 v227, 1, v222
    v_mul_u32_u24 v227, 72, v227
    s_add_u32 s16, s15, 32
    v_add_u32 v227, s16, v227
    v_xor_b32 v227, v227, v225
    v_add_u32 v227, 384, v227
    v_add_u32 v204, v227, v223
    v_and_b32 v226, 15, v217
    v_bfe_u32 v227, v217, 1, 3
    v_xor_b32 v227, v227, v220
    v_lshlrev_b32 v227, 4, v227
    v_lshl_add_u32 v227, v226, 7, v227
    s_lshl_b32 s15, s17, 13
    s_add_u32 s15, s15, 110592
    v_add_u32 v206, s15, v227
    v_xor_b32 v207, 64, v206
    v_add_u32 v201, 55296, v200
    v_add_u32 v203, 55296, v202
    v_add_u32 v205, 55296, v204
    v_lshlrev_b32 v212, 4, v217
    v_and_b32 v229, 4, v217
    v_and_b32 v228, 0xfffffff3, v217
    v_lshl_or_b32 v228, v229, 1, v228
    v_and_b32 v229, 8, v217
    v_lshrrev_b32 v229, 1, v229
    v_or_b32 v228, v228, v229
    v_lshlrev_b32 v213, 4, v228
    v_and_b32 v229, 1, v220
    v_lshrrev_b32 v230, 1, v220
    v_lshl_add_u32 v229, v229, 1, v230
    v_mul_u32_u24 v229, 304, v229
    v_lshl_add_u32 v214, v226, 4, v229
    v_lshrrev_b32 v230, 1, v226
    v_and_b32 v231, 1, v226
    v_and_b32 v232, 2, v226
    v_cmp_eq_u32 vcc, 0, v232
    v_add_u32 v232, 16, v231
    s_nop 0
    v_cndmask_b32 v231, v231, v232, vcc
    v_subrev_u32 v232, 8, v226
    v_cmp_gt_u32 vcc, 8, v226
    s_nop 1
    v_cndmask_b32 v230, v232, v230, vcc
    v_cndmask_b32 v231, 18, v231, vcc
    s_mov_b32 s15, 77824
    v_mul_lo_u32 v230, v230, s15
    v_lshl_add_u32 v230, v231, 4, v230
    v_add_u32 v230, v230, v229
    v_bfrev_b32 v231, 1
    v_cmp_gt_u32 s[40:41], 12, v226
    s_nop 1
    v_cndmask_b32 v215, v231, v230, s[40:41]
    s_mov_b64 s[42:43], vcc
    s_lshl_b32 s15, s14, 2
    s_add_u32 s15, s15, 2
    s_lshl_b32 s16, s13, 1
    s_add_u32 s16, s16, s17
    s_lshl_b32 s44, s15, 16
    s_lshl_b32 s45, s16, 11
    s_add_u32 s44, s44, s45
    s_lshl_b32 s45, s12, 21
    s_add_u32 s44, s44, s45
    s_add_u32 s45, s44, 4194304
    s_mul_i32 s46, s15, 77824
    s_mul_i32 s47, s16, 2432
    s_add_u32 s46, s46, s47
    s_mul_i32 s47, s12, 2490368
    s_add_u32 s46, s46, s47
    s_add_u32 s46, s46, 9437184
    s_sub_u32 s47, s46, 155648
    s_add_u32 s49, s44, 65536
    s_add_u32 s50, s45, 65536
    s_add_u32 s51, s46, 77824
    s_mov_b32 s52, 0x3eae1a93
    s_mov_b32 s53, 0x3eae1a93
    s_load_dwordx2 s[20:21], s[0:1], 64
    s_barrier
    ds_read_b128 v[112:115], v206 offset:0
    ds_read_b64_tr_b16 v[128:129], v200 offset:0
    ds_read_b64_tr_b16 v[130:131], v200 offset:2304
    ds_read_b128 v[116:119], v206 offset:2048
    ds_read_b128 v[120:123], v206 offset:4096
    ds_read_b128 v[124:127], v206 offset:6144
    ds_read_b64_tr_b16 v[132:133], v202 offset:0
    ds_read_b64_tr_b16 v[134:135], v202 offset:2304
    ds_read_b64_tr_b16 v[136:137], v200 offset:192
    ds_read_b64_tr_b16 v[138:139], v200 offset:2496
    ds_read_b64_tr_b16 v[140:141], v202 offset:192
    ds_read_b64_tr_b16 v[142:143], v202 offset:2496
    ds_read_b64_tr_b16 v[144:145], v200 offset:384
    ds_read_b64_tr_b16 v[146:147], v200 offset:2688
    ds_read_b64_tr_b16 v[148:149], v202 offset:384
    ds_read_b64_tr_b16 v[150:151], v202 offset:2688
    ds_read_b64_tr_b16 v[152:153], v204 offset:0
    ds_read_b64_tr_b16 v[154:155], v204 offset:2304
    s_waitcnt lgkmcnt(0)
    v_mfma_f32_16x16x32_bf16 v[0:3], v[128:131], v[112:115], 0
    v_mfma_f32_16x16x32_bf16 v[4:7], v[128:131], v[116:119], 0
    s_barrier
    v_mfma_f32_16x16x32_bf16 v[8:11], v[128:131], v[120:123], 0
    ds_read_b128 v[156:159], v207 offset:0
    v_mfma_f32_16x16x32_bf16 v[12:15], v[128:131], v[124:127], 0
    ds_read_b64_tr_b16 v[172:173], v200 offset:18432
    v_mfma_f32_16x16x32_bf16 v[16:19], v[132:135], v[112:115], 0
    ds_read_b64_tr_b16 v[174:175], v200 offset:20736
    v_mfma_f32_16x16x32_bf16 v[20:23], v[132:135], v[116:119], 0
    ds_read_b128 v[160:163], v207 offset:2048
    v_mfma_f32_16x16x32_bf16 v[24:27], v[132:135], v[120:123], 0
    ds_read_b128 v[164:167], v207 offset:4096
    v_mfma_f32_16x16x32_bf16 v[28:31], v[132:135], v[124:127], 0
    ds_read_b128 v[168:171], v207 offset:6144
    v_mfma_f32_16x16x32_bf16 v[32:35], v[136:139], v[112:115], 0
    ds_read_b64_tr_b16 v[176:177], v202 offset:18432
    v_mfma_f32_16x16x32_bf16 v[36:39], v[136:139], v[116:119], 0
    ds_read_b64_tr_b16 v[178:179], v202 offset:20736
    v_mfma_f32_16x16x32_bf16 v[40:43], v[136:139], v[120:123], 0
    ds_read_b64_tr_b16 v[180:181], v200 offset:18624
    v_mfma_f32_16x16x32_bf16 v[44:47], v[136:139], v[124:127], 0
    ds_read_b64_tr_b16 v[182:183], v200 offset:20928
    v_mfma_f32_16x16x32_bf16 v[48:51], v[140:143], v[112:115], 0
    ds_read_b64_tr_b16 v[184:185], v202 offset:18624
    v_mfma_f32_16x16x32_bf16 v[52:55], v[140:143], v[116:119], 0
    ds_read_b64_tr_b16 v[186:187], v202 offset:20928
    v_mfma_f32_16x16x32_bf16 v[56:59], v[140:143], v[120:123], 0
    ds_read_b64_tr_b16 v[188:189], v200 offset:18816
    v_mfma_f32_16x16x32_bf16 v[60:63], v[140:143], v[124:127], 0
    ds_read_b64_tr_b16 v[190:191], v200 offset:21120
    v_mfma_f32_16x16x32_bf16 v[64:67], v[112:115], v[144:147], 0
    ds_read_b64_tr_b16 v[192:193], v202 offset:18816
    v_mfma_f32_16x16x32_bf16 v[68:71], v[116:119], v[144:147], 0
    ds_read_b64_tr_b16 v[194:195], v202 offset:21120
    v_mfma_f32_16x16x32_bf16 v[72:75], v[120:123], v[144:147], 0
    ds_read_b64_tr_b16 v[196:197], v204 offset:18432
    v_mfma_f32_16x16x32_bf16 v[76:79], v[124:127], v[144:147], 0
    ds_read_b64_tr_b16 v[198:199], v204 offset:20736
    v_mfma_f32_16x16x32_bf16 v[80:83], v[112:115], v[148:151], 0
    v_mfma_f32_16x16x32_bf16 v[84:87], v[116:119], v[148:151], 0
    v_mfma_f32_16x16x32_bf16 v[88:91], v[120:123], v[148:151], 0
    v_mfma_f32_16x16x32_bf16 v[92:95], v[124:127], v[148:151], 0
    v_mfma_f32_16x16x32_bf16 v[96:99], v[112:115], v[152:155], 0
    v_mfma_f32_16x16x32_bf16 v[100:103], v[116:119], v[152:155], 0
    v_mfma_f32_16x16x32_bf16 v[104:107], v[120:123], v[152:155], 0
    v_mfma_f32_16x16x32_bf16 v[108:111], v[124:127], v[152:155], 0
    s_waitcnt lgkmcnt(0)
    v_mfma_f32_16x16x32_bf16 v[0:3], v[172:175], v[156:159], v[0:3]
    v_mfma_f32_16x16x32_bf16 v[4:7], v[172:175], v[160:163], v[4:7]
    s_barrier
    v_mfma_f32_16x16x32_bf16 v[8:11], v[172:175], v[164:167], v[8:11]
    ds_read_b128 v[112:115], v206 offset:16384
    v_mfma_f32_16x16x32_bf16 v[12:15], v[172:175], v[168:171], v[12:15]
    ds_read_b64_tr_b16 v[128:129], v200 offset:36864
    v_mfma_f32_16x16x32_bf16 v[16:19], v[176:179], v[156:159], v[16:19]
    ds_read_b64_tr_b16 v[130:131], v200 offset:39168
    v_mfma_f32_16x16x32_bf16 v[20:23], v[176:179], v[160:163], v[20:23]
    ds_read_b128 v[116:119], v206 offset:18432
    v_mfma_f32_16x16x32_bf16 v[24:27], v[176:179], v[164:167], v[24:27]
    ds_read_b128 v[120:123], v206 offset:20480
    v_mfma_f32_16x16x32_bf16 v[28:31], v[176:179], v[168:171], v[28:31]
    ds_read_b128 v[124:127], v206 offset:22528
    v_mfma_f32_16x16x32_bf16 v[32:35], v[180:183], v[156:159], v[32:35]
    ds_read_b64_tr_b16 v[132:133], v202 offset:36864
    v_mfma_f32_16x16x32_bf16 v[36:39], v[180:183], v[160:163], v[36:39]
    ds_read_b64_tr_b16 v[134:135], v202 offset:39168
    v_mfma_f32_16x16x32_bf16 v[40:43], v[180:183], v[164:167], v[40:43]
    ds_read_b64_tr_b16 v[136:137], v200 offset:37056
    v_mfma_f32_16x16x32_bf16 v[44:47], v[180:183], v[168:171], v[44:47]
    ds_read_b64_tr_b16 v[138:139], v200 offset:39360
    v_mfma_f32_16x16x32_bf16 v[48:51], v[184:187], v[156:159], v[48:51]
    ds_read_b64_tr_b16 v[140:141], v202 offset:37056
    v_mfma_f32_16x16x32_bf16 v[52:55], v[184:187], v[160:163], v[52:55]
    ds_read_b64_tr_b16 v[142:143], v202 offset:39360
    v_mfma_f32_16x16x32_bf16 v[56:59], v[184:187], v[164:167], v[56:59]
    ds_read_b64_tr_b16 v[144:145], v200 offset:37248
    v_mfma_f32_16x16x32_bf16 v[60:63], v[184:187], v[168:171], v[60:63]
    ds_read_b64_tr_b16 v[146:147], v200 offset:39552
    v_mfma_f32_16x16x32_bf16 v[64:67], v[156:159], v[188:191], v[64:67]
    ds_read_b64_tr_b16 v[148:149], v202 offset:37248
    v_mfma_f32_16x16x32_bf16 v[68:71], v[160:163], v[188:191], v[68:71]
    ds_read_b64_tr_b16 v[150:151], v202 offset:39552
    v_mfma_f32_16x16x32_bf16 v[72:75], v[164:167], v[188:191], v[72:75]
    ds_read_b64_tr_b16 v[152:153], v204 offset:36864
    v_mfma_f32_16x16x32_bf16 v[76:79], v[168:171], v[188:191], v[76:79]
    ds_read_b64_tr_b16 v[154:155], v204 offset:39168
    v_mfma_f32_16x16x32_bf16 v[80:83], v[156:159], v[192:195], v[80:83]
    v_mfma_f32_16x16x32_bf16 v[84:87], v[160:163], v[192:195], v[84:87]
    v_mfma_f32_16x16x32_bf16 v[88:91], v[164:167], v[192:195], v[88:91]
    v_mfma_f32_16x16x32_bf16 v[92:95], v[168:171], v[192:195], v[92:95]
    v_mfma_f32_16x16x32_bf16 v[96:99], v[156:159], v[196:199], v[96:99]
    v_mfma_f32_16x16x32_bf16 v[100:103], v[160:163], v[196:199], v[100:103]
    v_mfma_f32_16x16x32_bf16 v[104:107], v[164:167], v[196:199], v[104:107]
    v_mfma_f32_16x16x32_bf16 v[108:111], v[168:171], v[196:199], v[108:111]
    s_waitcnt lgkmcnt(0)
    v_mfma_f32_16x16x32_bf16 v[0:3], v[128:131], v[112:115], v[0:3]
    v_mfma_f32_16x16x32_bf16 v[4:7], v[128:131], v[116:119], v[4:7]
    s_barrier
    v_mfma_f32_16x16x32_bf16 v[8:11], v[128:131], v[120:123], v[8:11]
    ds_read_b128 v[156:159], v207 offset:16384
    v_mfma_f32_16x16x32_bf16 v[12:15], v[128:131], v[124:127], v[12:15]
    ds_read_b64_tr_b16 v[172:173], v201 offset:0
    v_mfma_f32_16x16x32_bf16 v[16:19], v[132:135], v[112:115], v[16:19]
    ds_read_b64_tr_b16 v[174:175], v201 offset:2304
    v_mfma_f32_16x16x32_bf16 v[20:23], v[132:135], v[116:119], v[20:23]
    ds_read_b128 v[160:163], v207 offset:18432
    v_mfma_f32_16x16x32_bf16 v[24:27], v[132:135], v[120:123], v[24:27]
    ds_read_b128 v[164:167], v207 offset:20480
    v_mfma_f32_16x16x32_bf16 v[28:31], v[132:135], v[124:127], v[28:31]
    ds_read_b128 v[168:171], v207 offset:22528
    v_mfma_f32_16x16x32_bf16 v[32:35], v[136:139], v[112:115], v[32:35]
    ds_read_b64_tr_b16 v[176:177], v203 offset:0
    v_mfma_f32_16x16x32_bf16 v[36:39], v[136:139], v[116:119], v[36:39]
    ds_read_b64_tr_b16 v[178:179], v203 offset:2304
    v_mfma_f32_16x16x32_bf16 v[40:43], v[136:139], v[120:123], v[40:43]
    ds_read_b64_tr_b16 v[180:181], v201 offset:192
    v_mfma_f32_16x16x32_bf16 v[44:47], v[136:139], v[124:127], v[44:47]
    ds_read_b64_tr_b16 v[182:183], v201 offset:2496
    v_mfma_f32_16x16x32_bf16 v[48:51], v[140:143], v[112:115], v[48:51]
    ds_read_b64_tr_b16 v[184:185], v203 offset:192
    v_mfma_f32_16x16x32_bf16 v[52:55], v[140:143], v[116:119], v[52:55]
    ds_read_b64_tr_b16 v[186:187], v203 offset:2496
    v_mfma_f32_16x16x32_bf16 v[56:59], v[140:143], v[120:123], v[56:59]
    ds_read_b64_tr_b16 v[188:189], v201 offset:384
    v_mfma_f32_16x16x32_bf16 v[60:63], v[140:143], v[124:127], v[60:63]
    ds_read_b64_tr_b16 v[190:191], v201 offset:2688
    v_mfma_f32_16x16x32_bf16 v[64:67], v[112:115], v[144:147], v[64:67]
    ds_read_b64_tr_b16 v[192:193], v203 offset:384
    v_mfma_f32_16x16x32_bf16 v[68:71], v[116:119], v[144:147], v[68:71]
    ds_read_b64_tr_b16 v[194:195], v203 offset:2688
    v_mfma_f32_16x16x32_bf16 v[72:75], v[120:123], v[144:147], v[72:75]
    ds_read_b64_tr_b16 v[196:197], v205 offset:0
    v_mfma_f32_16x16x32_bf16 v[76:79], v[124:127], v[144:147], v[76:79]
    ds_read_b64_tr_b16 v[198:199], v205 offset:2304
    v_mfma_f32_16x16x32_bf16 v[80:83], v[112:115], v[148:151], v[80:83]
    v_mfma_f32_16x16x32_bf16 v[84:87], v[116:119], v[148:151], v[84:87]
    v_mfma_f32_16x16x32_bf16 v[88:91], v[120:123], v[148:151], v[88:91]
    v_mfma_f32_16x16x32_bf16 v[92:95], v[124:127], v[148:151], v[92:95]
    v_mfma_f32_16x16x32_bf16 v[96:99], v[112:115], v[152:155], v[96:99]
    v_mfma_f32_16x16x32_bf16 v[100:103], v[116:119], v[152:155], v[100:103]
    v_mfma_f32_16x16x32_bf16 v[104:107], v[120:123], v[152:155], v[104:107]
    v_mfma_f32_16x16x32_bf16 v[108:111], v[124:127], v[152:155], v[108:111]
    s_waitcnt lgkmcnt(0)
    v_mfma_f32_16x16x32_bf16 v[0:3], v[172:175], v[156:159], v[0:3]
    v_mfma_f32_16x16x32_bf16 v[4:7], v[172:175], v[160:163], v[4:7]
    s_barrier
    v_mfma_f32_16x16x32_bf16 v[8:11], v[172:175], v[164:167], v[8:11]
    ds_read_b128 v[112:115], v206 offset:32768
    v_mfma_f32_16x16x32_bf16 v[12:15], v[172:175], v[168:171], v[12:15]
    ds_read_b64_tr_b16 v[128:129], v201 offset:18432
    v_mfma_f32_16x16x32_bf16 v[16:19], v[176:179], v[156:159], v[16:19]
    ds_read_b64_tr_b16 v[130:131], v201 offset:20736
    v_mfma_f32_16x16x32_bf16 v[20:23], v[176:179], v[160:163], v[20:23]
    ds_read_b128 v[116:119], v206 offset:34816
    v_mfma_f32_16x16x32_bf16 v[24:27], v[176:179], v[164:167], v[24:27]
    ds_read_b128 v[120:123], v206 offset:36864
    v_mfma_f32_16x16x32_bf16 v[28:31], v[176:179], v[168:171], v[28:31]
    ds_read_b128 v[124:127], v206 offset:38912
    v_mfma_f32_16x16x32_bf16 v[32:35], v[180:183], v[156:159], v[32:35]
    ds_read_b64_tr_b16 v[132:133], v203 offset:18432
    v_mfma_f32_16x16x32_bf16 v[36:39], v[180:183], v[160:163], v[36:39]
    ds_read_b64_tr_b16 v[134:135], v203 offset:20736
    v_mfma_f32_16x16x32_bf16 v[40:43], v[180:183], v[164:167], v[40:43]
    ds_read_b64_tr_b16 v[136:137], v201 offset:18624
    v_mfma_f32_16x16x32_bf16 v[44:47], v[180:183], v[168:171], v[44:47]
    ds_read_b64_tr_b16 v[138:139], v201 offset:20928
    v_mfma_f32_16x16x32_bf16 v[48:51], v[184:187], v[156:159], v[48:51]
    ds_read_b64_tr_b16 v[140:141], v203 offset:18624
    v_mfma_f32_16x16x32_bf16 v[52:55], v[184:187], v[160:163], v[52:55]
    ds_read_b64_tr_b16 v[142:143], v203 offset:20928
    v_mfma_f32_16x16x32_bf16 v[56:59], v[184:187], v[164:167], v[56:59]
    ds_read_b64_tr_b16 v[144:145], v201 offset:18816
    v_mfma_f32_16x16x32_bf16 v[60:63], v[184:187], v[168:171], v[60:63]
    ds_read_b64_tr_b16 v[146:147], v201 offset:21120
    v_mfma_f32_16x16x32_bf16 v[64:67], v[156:159], v[188:191], v[64:67]
    ds_read_b64_tr_b16 v[148:149], v203 offset:18816
    v_mfma_f32_16x16x32_bf16 v[68:71], v[160:163], v[188:191], v[68:71]
    ds_read_b64_tr_b16 v[150:151], v203 offset:21120
    v_mfma_f32_16x16x32_bf16 v[72:75], v[164:167], v[188:191], v[72:75]
    ds_read_b64_tr_b16 v[152:153], v205 offset:18432
    v_mfma_f32_16x16x32_bf16 v[76:79], v[168:171], v[188:191], v[76:79]
    ds_read_b64_tr_b16 v[154:155], v205 offset:20736
    v_mfma_f32_16x16x32_bf16 v[80:83], v[156:159], v[192:195], v[80:83]
    v_mfma_f32_16x16x32_bf16 v[84:87], v[160:163], v[192:195], v[84:87]
    v_mfma_f32_16x16x32_bf16 v[88:91], v[164:167], v[192:195], v[88:91]
    v_mfma_f32_16x16x32_bf16 v[92:95], v[168:171], v[192:195], v[92:95]
    v_mfma_f32_16x16x32_bf16 v[96:99], v[156:159], v[196:199], v[96:99]
    v_mfma_f32_16x16x32_bf16 v[100:103], v[160:163], v[196:199], v[100:103]
    v_mfma_f32_16x16x32_bf16 v[104:107], v[164:167], v[196:199], v[104:107]
    v_mfma_f32_16x16x32_bf16 v[108:111], v[168:171], v[196:199], v[108:111]
    s_waitcnt lgkmcnt(0)
    v_mfma_f32_16x16x32_bf16 v[0:3], v[128:131], v[112:115], v[0:3]
    v_mfma_f32_16x16x32_bf16 v[4:7], v[128:131], v[116:119], v[4:7]
    s_barrier
    v_mfma_f32_16x16x32_bf16 v[8:11], v[128:131], v[120:123], v[8:11]
    ds_read_b128 v[156:159], v207 offset:32768
    v_mfma_f32_16x16x32_bf16 v[12:15], v[128:131], v[124:127], v[12:15]
    ds_read_b64_tr_b16 v[172:173], v201 offset:36864
    v_mfma_f32_16x16x32_bf16 v[16:19], v[132:135], v[112:115], v[16:19]
    ds_read_b64_tr_b16 v[174:175], v201 offset:39168
    v_mfma_f32_16x16x32_bf16 v[20:23], v[132:135], v[116:119], v[20:23]
    ds_read_b128 v[160:163], v207 offset:34816
    v_mfma_f32_16x16x32_bf16 v[24:27], v[132:135], v[120:123], v[24:27]
    ds_read_b128 v[164:167], v207 offset:36864
    v_mfma_f32_16x16x32_bf16 v[28:31], v[132:135], v[124:127], v[28:31]
    ds_read_b128 v[168:171], v207 offset:38912
    v_mfma_f32_16x16x32_bf16 v[32:35], v[136:139], v[112:115], v[32:35]
    ds_read_b64_tr_b16 v[176:177], v203 offset:36864
    v_mfma_f32_16x16x32_bf16 v[36:39], v[136:139], v[116:119], v[36:39]
    ds_read_b64_tr_b16 v[178:179], v203 offset:39168
    v_mfma_f32_16x16x32_bf16 v[40:43], v[136:139], v[120:123], v[40:43]
    ds_read_b64_tr_b16 v[180:181], v201 offset:37056
    v_mfma_f32_16x16x32_bf16 v[44:47], v[136:139], v[124:127], v[44:47]
    ds_read_b64_tr_b16 v[182:183], v201 offset:39360
    v_mfma_f32_16x16x32_bf16 v[48:51], v[140:143], v[112:115], v[48:51]
    ds_read_b64_tr_b16 v[184:185], v203 offset:37056
    v_mfma_f32_16x16x32_bf16 v[52:55], v[140:143], v[116:119], v[52:55]
    ds_read_b64_tr_b16 v[186:187], v203 offset:39360
    v_mfma_f32_16x16x32_bf16 v[56:59], v[140:143], v[120:123], v[56:59]
    ds_read_b64_tr_b16 v[188:189], v201 offset:37248
    v_mfma_f32_16x16x32_bf16 v[60:63], v[140:143], v[124:127], v[60:63]
    ds_read_b64_tr_b16 v[190:191], v201 offset:39552
    v_mfma_f32_16x16x32_bf16 v[64:67], v[112:115], v[144:147], v[64:67]
    ds_read_b64_tr_b16 v[192:193], v203 offset:37248
    v_mfma_f32_16x16x32_bf16 v[68:71], v[116:119], v[144:147], v[68:71]
    ds_read_b64_tr_b16 v[194:195], v203 offset:39552
    v_mfma_f32_16x16x32_bf16 v[72:75], v[120:123], v[144:147], v[72:75]
    ds_read_b64_tr_b16 v[196:197], v205 offset:36864
    v_mfma_f32_16x16x32_bf16 v[76:79], v[124:127], v[144:147], v[76:79]
    ds_read_b64_tr_b16 v[198:199], v205 offset:39168
    v_mfma_f32_16x16x32_bf16 v[80:83], v[112:115], v[148:151], v[80:83]
    v_mfma_f32_16x16x32_bf16 v[84:87], v[116:119], v[148:151], v[84:87]
    v_mfma_f32_16x16x32_bf16 v[88:91], v[120:123], v[148:151], v[88:91]
    v_mfma_f32_16x16x32_bf16 v[92:95], v[124:127], v[148:151], v[92:95]
    v_mfma_f32_16x16x32_bf16 v[96:99], v[112:115], v[152:155], v[96:99]
    v_mfma_f32_16x16x32_bf16 v[100:103], v[116:119], v[152:155], v[100:103]
    v_mfma_f32_16x16x32_bf16 v[104:107], v[120:123], v[152:155], v[104:107]
    v_mfma_f32_16x16x32_bf16 v[108:111], v[124:127], v[152:155], v[108:111]
    s_waitcnt lgkmcnt(0)
    v_mfma_f32_16x16x32_bf16 v[0:3], v[172:175], v[156:159], v[0:3]
    v_mfma_f32_16x16x32_bf16 v[4:7], v[172:175], v[160:163], v[4:7]
    s_barrier
    v_mfma_f32_16x16x32_bf16 v[8:11], v[172:175], v[164:167], v[8:11]
    ds_read_b128 v[112:115], v206 offset:0
    v_mfma_f32_16x16x32_bf16 v[12:15], v[172:175], v[168:171], v[12:15]
    ds_read_b64_tr_b16 v[128:129], v200 offset:0
    v_mfma_f32_16x16x32_bf16 v[16:19], v[176:179], v[156:159], v[16:19]
    ds_read_b64_tr_b16 v[130:131], v200 offset:2304
    v_mfma_f32_16x16x32_bf16 v[20:23], v[176:179], v[160:163], v[20:23]
    ds_read_b128 v[116:119], v206 offset:2048
    v_mfma_f32_16x16x32_bf16 v[24:27], v[176:179], v[164:167], v[24:27]
    ds_read_b128 v[120:123], v206 offset:4096
    v_mfma_f32_16x16x32_bf16 v[28:31], v[176:179], v[168:171], v[28:31]
    ds_read_b128 v[124:127], v206 offset:6144
    v_mfma_f32_16x16x32_bf16 v[32:35], v[180:183], v[156:159], v[32:35]
    ds_read_b64_tr_b16 v[132:133], v202 offset:0
    v_mfma_f32_16x16x32_bf16 v[36:39], v[180:183], v[160:163], v[36:39]
    ds_read_b64_tr_b16 v[134:135], v202 offset:2304
    v_mfma_f32_16x16x32_bf16 v[40:43], v[180:183], v[164:167], v[40:43]
    ds_read_b64_tr_b16 v[136:137], v200 offset:192
    v_mfma_f32_16x16x32_bf16 v[44:47], v[180:183], v[168:171], v[44:47]
    ds_read_b64_tr_b16 v[138:139], v200 offset:2496
    v_mfma_f32_16x16x32_bf16 v[48:51], v[184:187], v[156:159], v[48:51]
    ds_read_b64_tr_b16 v[140:141], v202 offset:192
    v_mfma_f32_16x16x32_bf16 v[52:55], v[184:187], v[160:163], v[52:55]
    ds_read_b64_tr_b16 v[142:143], v202 offset:2496
    v_mfma_f32_16x16x32_bf16 v[56:59], v[184:187], v[164:167], v[56:59]
    ds_read_b64_tr_b16 v[144:145], v200 offset:384
    v_mfma_f32_16x16x32_bf16 v[60:63], v[184:187], v[168:171], v[60:63]
    ds_read_b64_tr_b16 v[146:147], v200 offset:2688
    v_mfma_f32_16x16x32_bf16 v[64:67], v[156:159], v[188:191], v[64:67]
    ds_read_b64_tr_b16 v[148:149], v202 offset:384
    v_mfma_f32_16x16x32_bf16 v[68:71], v[160:163], v[188:191], v[68:71]
    ds_read_b64_tr_b16 v[150:151], v202 offset:2688
    v_mfma_f32_16x16x32_bf16 v[72:75], v[164:167], v[188:191], v[72:75]
    ds_read_b64_tr_b16 v[152:153], v204 offset:0
    v_mfma_f32_16x16x32_bf16 v[76:79], v[168:171], v[188:191], v[76:79]
    ds_read_b64_tr_b16 v[154:155], v204 offset:2304
    v_mfma_f32_16x16x32_bf16 v[80:83], v[156:159], v[192:195], v[80:83]
    v_mfma_f32_16x16x32_bf16 v[84:87], v[160:163], v[192:195], v[84:87]
    v_mfma_f32_16x16x32_bf16 v[88:91], v[164:167], v[192:195], v[88:91]
    v_mfma_f32_16x16x32_bf16 v[92:95], v[168:171], v[192:195], v[92:95]
    v_mfma_f32_16x16x32_bf16 v[96:99], v[156:159], v[196:199], v[96:99]
    v_mfma_f32_16x16x32_bf16 v[100:103], v[160:163], v[196:199], v[100:103]
    v_mfma_f32_16x16x32_bf16 v[104:107], v[164:167], v[196:199], v[104:107]
    v_mfma_f32_16x16x32_bf16 v[108:111], v[168:171], v[196:199], v[108:111]
    s_waitcnt lgkmcnt(0)
    v_mfma_f32_16x16x32_bf16 v[0:3], v[128:131], v[112:115], v[0:3]
    v_mfma_f32_16x16x32_bf16 v[4:7], v[128:131], v[116:119], v[4:7]
    s_barrier
    v_mfma_f32_16x16x32_bf16 v[8:11], v[128:131], v[120:123], v[8:11]
    ds_read_b128 v[156:159], v207 offset:0
    v_mfma_f32_16x16x32_bf16 v[12:15], v[128:131], v[124:127], v[12:15]
    ds_read_b64_tr_b16 v[172:173], v200 offset:18432
    v_mfma_f32_16x16x32_bf16 v[16:19], v[132:135], v[112:115], v[16:19]
    ds_read_b64_tr_b16 v[174:175], v200 offset:20736
    v_mfma_f32_16x16x32_bf16 v[20:23], v[132:135], v[116:119], v[20:23]
    ds_read_b128 v[160:163], v207 offset:2048
    v_mfma_f32_16x16x32_bf16 v[24:27], v[132:135], v[120:123], v[24:27]
    ds_read_b128 v[164:167], v207 offset:4096
    v_mfma_f32_16x16x32_bf16 v[28:31], v[132:135], v[124:127], v[28:31]
    ds_read_b128 v[168:171], v207 offset:6144
    v_mfma_f32_16x16x32_bf16 v[32:35], v[136:139], v[112:115], v[32:35]
    ds_read_b64_tr_b16 v[176:177], v202 offset:18432
    v_mfma_f32_16x16x32_bf16 v[36:39], v[136:139], v[116:119], v[36:39]
    ds_read_b64_tr_b16 v[178:179], v202 offset:20736
    v_mfma_f32_16x16x32_bf16 v[40:43], v[136:139], v[120:123], v[40:43]
    ds_read_b64_tr_b16 v[180:181], v200 offset:18624
    v_mfma_f32_16x16x32_bf16 v[44:47], v[136:139], v[124:127], v[44:47]
    ds_read_b64_tr_b16 v[182:183], v200 offset:20928
    v_mfma_f32_16x16x32_bf16 v[48:51], v[140:143], v[112:115], v[48:51]
    ds_read_b64_tr_b16 v[184:185], v202 offset:18624
    v_mfma_f32_16x16x32_bf16 v[52:55], v[140:143], v[116:119], v[52:55]
    ds_read_b64_tr_b16 v[186:187], v202 offset:20928
    v_mfma_f32_16x16x32_bf16 v[56:59], v[140:143], v[120:123], v[56:59]
    ds_read_b64_tr_b16 v[188:189], v200 offset:18816
    v_mfma_f32_16x16x32_bf16 v[60:63], v[140:143], v[124:127], v[60:63]
    ds_read_b64_tr_b16 v[190:191], v200 offset:21120
    v_mfma_f32_16x16x32_bf16 v[64:67], v[112:115], v[144:147], v[64:67]
    ds_read_b64_tr_b16 v[192:193], v202 offset:18816
    v_mfma_f32_16x16x32_bf16 v[68:71], v[116:119], v[144:147], v[68:71]
    ds_read_b64_tr_b16 v[194:195], v202 offset:21120
    v_mfma_f32_16x16x32_bf16 v[72:75], v[120:123], v[144:147], v[72:75]
    ds_read_b64_tr_b16 v[196:197], v204 offset:18432
    v_mfma_f32_16x16x32_bf16 v[76:79], v[124:127], v[144:147], v[76:79]
    ds_read_b64_tr_b16 v[198:199], v204 offset:20736
    v_mfma_f32_16x16x32_bf16 v[80:83], v[112:115], v[148:151], v[80:83]
    v_mfma_f32_16x16x32_bf16 v[84:87], v[116:119], v[148:151], v[84:87]
    v_mfma_f32_16x16x32_bf16 v[88:91], v[120:123], v[148:151], v[88:91]
    v_mfma_f32_16x16x32_bf16 v[92:95], v[124:127], v[148:151], v[92:95]
    v_mfma_f32_16x16x32_bf16 v[96:99], v[112:115], v[152:155], v[96:99]
    v_mfma_f32_16x16x32_bf16 v[100:103], v[116:119], v[152:155], v[100:103]
    v_mfma_f32_16x16x32_bf16 v[104:107], v[120:123], v[152:155], v[104:107]
    v_mfma_f32_16x16x32_bf16 v[108:111], v[124:127], v[152:155], v[108:111]
    s_waitcnt lgkmcnt(0)
    v_mfma_f32_16x16x32_bf16 v[0:3], v[172:175], v[156:159], v[0:3]
    v_mfma_f32_16x16x32_bf16 v[4:7], v[172:175], v[160:163], v[4:7]
    s_barrier
    v_mfma_f32_16x16x32_bf16 v[8:11], v[172:175], v[164:167], v[8:11]
    ds_read_b128 v[112:115], v206 offset:16384
    v_mfma_f32_16x16x32_bf16 v[12:15], v[172:175], v[168:171], v[12:15]
    ds_read_b64_tr_b16 v[128:129], v200 offset:36864
    v_mfma_f32_16x16x32_bf16 v[16:19], v[176:179], v[156:159], v[16:19]
    ds_read_b64_tr_b16 v[130:131], v200 offset:39168
    v_mfma_f32_16x16x32_bf16 v[20:23], v[176:179], v[160:163], v[20:23]
    ds_read_b128 v[116:119], v206 offset:18432
    v_mfma_f32_16x16x32_bf16 v[24:27], v[176:179], v[164:167], v[24:27]
    ds_read_b128 v[120:123], v206 offset:20480
    v_mfma_f32_16x16x32_bf16 v[28:31], v[176:179], v[168:171], v[28:31]
    ds_read_b128 v[124:127], v206 offset:22528
    v_mfma_f32_16x16x32_bf16 v[32:35], v[180:183], v[156:159], v[32:35]
    ds_read_b64_tr_b16 v[132:133], v202 offset:36864
    v_mfma_f32_16x16x32_bf16 v[36:39], v[180:183], v[160:163], v[36:39]
    ds_read_b64_tr_b16 v[134:135], v202 offset:39168
    v_mfma_f32_16x16x32_bf16 v[40:43], v[180:183], v[164:167], v[40:43]
    ds_read_b64_tr_b16 v[136:137], v200 offset:37056
    v_mfma_f32_16x16x32_bf16 v[44:47], v[180:183], v[168:171], v[44:47]
    ds_read_b64_tr_b16 v[138:139], v200 offset:39360
    v_mfma_f32_16x16x32_bf16 v[48:51], v[184:187], v[156:159], v[48:51]
    ds_read_b64_tr_b16 v[140:141], v202 offset:37056
    v_mfma_f32_16x16x32_bf16 v[52:55], v[184:187], v[160:163], v[52:55]
    ds_read_b64_tr_b16 v[142:143], v202 offset:39360
    v_mfma_f32_16x16x32_bf16 v[56:59], v[184:187], v[164:167], v[56:59]
    ds_read_b64_tr_b16 v[144:145], v200 offset:37248
    v_mfma_f32_16x16x32_bf16 v[60:63], v[184:187], v[168:171], v[60:63]
    ds_read_b64_tr_b16 v[146:147], v200 offset:39552
    v_mfma_f32_16x16x32_bf16 v[64:67], v[156:159], v[188:191], v[64:67]
    ds_read_b64_tr_b16 v[148:149], v202 offset:37248
    v_mfma_f32_16x16x32_bf16 v[68:71], v[160:163], v[188:191], v[68:71]
    ds_read_b64_tr_b16 v[150:151], v202 offset:39552
    v_mfma_f32_16x16x32_bf16 v[72:75], v[164:167], v[188:191], v[72:75]
    ds_read_b64_tr_b16 v[152:153], v204 offset:36864
    v_mfma_f32_16x16x32_bf16 v[76:79], v[168:171], v[188:191], v[76:79]
    ds_read_b64_tr_b16 v[154:155], v204 offset:39168
    v_mfma_f32_16x16x32_bf16 v[80:83], v[156:159], v[192:195], v[80:83]
    v_mfma_f32_16x16x32_bf16 v[84:87], v[160:163], v[192:195], v[84:87]
    v_mfma_f32_16x16x32_bf16 v[88:91], v[164:167], v[192:195], v[88:91]
    v_mfma_f32_16x16x32_bf16 v[92:95], v[168:171], v[192:195], v[92:95]
    v_mfma_f32_16x16x32_bf16 v[96:99], v[156:159], v[196:199], v[96:99]
    v_mfma_f32_16x16x32_bf16 v[100:103], v[160:163], v[196:199], v[100:103]
    v_mfma_f32_16x16x32_bf16 v[104:107], v[164:167], v[196:199], v[104:107]
    v_mfma_f32_16x16x32_bf16 v[108:111], v[168:171], v[196:199], v[108:111]
    s_waitcnt lgkmcnt(0)
    v_mfma_f32_16x16x32_bf16 v[0:3], v[128:131], v[112:115], v[0:3]
    v_mfma_f32_16x16x32_bf16 v[4:7], v[128:131], v[116:119], v[4:7]
    s_barrier
    v_mfma_f32_16x16x32_bf16 v[8:11], v[128:131], v[120:123], v[8:11]
    ds_read_b128 v[156:159], v207 offset:16384
    v_mfma_f32_16x16x32_bf16 v[12:15], v[128:131], v[124:127], v[12:15]
    ds_read_b64_tr_b16 v[172:173], v201 offset:0
    v_mfma_f32_16x16x32_bf16 v[16:19], v[132:135], v[112:115], v[16:19]
    ds_read_b64_tr_b16 v[174:175], v201 offset:2304
    v_mfma_f32_16x16x32_bf16 v[20:23], v[132:135], v[116:119], v[20:23]
    ds_read_b128 v[160:163], v207 offset:18432
    v_mfma_f32_16x16x32_bf16 v[24:27], v[132:135], v[120:123], v[24:27]
    ds_read_b128 v[164:167], v207 offset:20480
    v_mfma_f32_16x16x32_bf16 v[28:31], v[132:135], v[124:127], v[28:31]
    ds_read_b128 v[168:171], v207 offset:22528
    v_mfma_f32_16x16x32_bf16 v[32:35], v[136:139], v[112:115], v[32:35]
    ds_read_b64_tr_b16 v[176:177], v203 offset:0
    v_mfma_f32_16x16x32_bf16 v[36:39], v[136:139], v[116:119], v[36:39]
    ds_read_b64_tr_b16 v[178:179], v203 offset:2304
    v_mfma_f32_16x16x32_bf16 v[40:43], v[136:139], v[120:123], v[40:43]
    ds_read_b64_tr_b16 v[180:181], v201 offset:192
    v_mfma_f32_16x16x32_bf16 v[44:47], v[136:139], v[124:127], v[44:47]
    ds_read_b64_tr_b16 v[182:183], v201 offset:2496
    v_mfma_f32_16x16x32_bf16 v[48:51], v[140:143], v[112:115], v[48:51]
    ds_read_b64_tr_b16 v[184:185], v203 offset:192
    v_mfma_f32_16x16x32_bf16 v[52:55], v[140:143], v[116:119], v[52:55]
    ds_read_b64_tr_b16 v[186:187], v203 offset:2496
    v_mfma_f32_16x16x32_bf16 v[56:59], v[140:143], v[120:123], v[56:59]
    ds_read_b64_tr_b16 v[188:189], v201 offset:384
    v_mfma_f32_16x16x32_bf16 v[60:63], v[140:143], v[124:127], v[60:63]
    ds_read_b64_tr_b16 v[190:191], v201 offset:2688
    v_mfma_f32_16x16x32_bf16 v[64:67], v[112:115], v[144:147], v[64:67]
    ds_read_b64_tr_b16 v[192:193], v203 offset:384
    v_mfma_f32_16x16x32_bf16 v[68:71], v[116:119], v[144:147], v[68:71]
    ds_read_b64_tr_b16 v[194:195], v203 offset:2688
    v_mfma_f32_16x16x32_bf16 v[72:75], v[120:123], v[144:147], v[72:75]
    ds_read_b64_tr_b16 v[196:197], v205 offset:0
    v_mfma_f32_16x16x32_bf16 v[76:79], v[124:127], v[144:147], v[76:79]
    ds_read_b64_tr_b16 v[198:199], v205 offset:2304
    v_mfma_f32_16x16x32_bf16 v[80:83], v[112:115], v[148:151], v[80:83]
    v_mfma_f32_16x16x32_bf16 v[84:87], v[116:119], v[148:151], v[84:87]
    v_mfma_f32_16x16x32_bf16 v[88:91], v[120:123], v[148:151], v[88:91]
    v_mfma_f32_16x16x32_bf16 v[92:95], v[124:127], v[148:151], v[92:95]
    v_mfma_f32_16x16x32_bf16 v[96:99], v[112:115], v[152:155], v[96:99]
    v_mfma_f32_16x16x32_bf16 v[100:103], v[116:119], v[152:155], v[100:103]
    v_mfma_f32_16x16x32_bf16 v[104:107], v[120:123], v[152:155], v[104:107]
    v_mfma_f32_16x16x32_bf16 v[108:111], v[124:127], v[152:155], v[108:111]
    s_waitcnt lgkmcnt(0)
    v_mfma_f32_16x16x32_bf16 v[0:3], v[172:175], v[156:159], v[0:3]
    v_mfma_f32_16x16x32_bf16 v[4:7], v[172:175], v[160:163], v[4:7]
    s_barrier
    v_mfma_f32_16x16x32_bf16 v[8:11], v[172:175], v[164:167], v[8:11]
    ds_read_b128 v[112:115], v206 offset:32768
    v_mfma_f32_16x16x32_bf16 v[12:15], v[172:175], v[168:171], v[12:15]
    ds_read_b64_tr_b16 v[128:129], v201 offset:18432
    v_mfma_f32_16x16x32_bf16 v[16:19], v[176:179], v[156:159], v[16:19]
    ds_read_b64_tr_b16 v[130:131], v201 offset:20736
    v_mfma_f32_16x16x32_bf16 v[20:23], v[176:179], v[160:163], v[20:23]
    ds_read_b128 v[116:119], v206 offset:34816
    v_mfma_f32_16x16x32_bf16 v[24:27], v[176:179], v[164:167], v[24:27]
    ds_read_b128 v[120:123], v206 offset:36864
    v_mfma_f32_16x16x32_bf16 v[28:31], v[176:179], v[168:171], v[28:31]
    ds_read_b128 v[124:127], v206 offset:38912
    v_mfma_f32_16x16x32_bf16 v[32:35], v[180:183], v[156:159], v[32:35]
    ds_read_b64_tr_b16 v[132:133], v203 offset:18432
    v_mfma_f32_16x16x32_bf16 v[36:39], v[180:183], v[160:163], v[36:39]
    ds_read_b64_tr_b16 v[134:135], v203 offset:20736
    v_mfma_f32_16x16x32_bf16 v[40:43], v[180:183], v[164:167], v[40:43]
    ds_read_b64_tr_b16 v[136:137], v201 offset:18624
    v_mfma_f32_16x16x32_bf16 v[44:47], v[180:183], v[168:171], v[44:47]
    ds_read_b64_tr_b16 v[138:139], v201 offset:20928
    v_mfma_f32_16x16x32_bf16 v[48:51], v[184:187], v[156:159], v[48:51]
    ds_read_b64_tr_b16 v[140:141], v203 offset:18624
    v_mfma_f32_16x16x32_bf16 v[52:55], v[184:187], v[160:163], v[52:55]
    ds_read_b64_tr_b16 v[142:143], v203 offset:20928
    v_mfma_f32_16x16x32_bf16 v[56:59], v[184:187], v[164:167], v[56:59]
    ds_read_b64_tr_b16 v[144:145], v201 offset:18816
    v_mfma_f32_16x16x32_bf16 v[60:63], v[184:187], v[168:171], v[60:63]
    ds_read_b64_tr_b16 v[146:147], v201 offset:21120
    v_mfma_f32_16x16x32_bf16 v[64:67], v[156:159], v[188:191], v[64:67]
    ds_read_b64_tr_b16 v[148:149], v203 offset:18816
    v_mfma_f32_16x16x32_bf16 v[68:71], v[160:163], v[188:191], v[68:71]
    ds_read_b64_tr_b16 v[150:151], v203 offset:21120
    v_mfma_f32_16x16x32_bf16 v[72:75], v[164:167], v[188:191], v[72:75]
    ds_read_b64_tr_b16 v[152:153], v205 offset:18432
    v_mfma_f32_16x16x32_bf16 v[76:79], v[168:171], v[188:191], v[76:79]
    ds_read_b64_tr_b16 v[154:155], v205 offset:20736
    v_mfma_f32_16x16x32_bf16 v[80:83], v[156:159], v[192:195], v[80:83]
    v_mfma_f32_16x16x32_bf16 v[84:87], v[160:163], v[192:195], v[84:87]
    v_mfma_f32_16x16x32_bf16 v[88:91], v[164:167], v[192:195], v[88:91]
    v_mfma_f32_16x16x32_bf16 v[92:95], v[168:171], v[192:195], v[92:95]
    v_mfma_f32_16x16x32_bf16 v[96:99], v[156:159], v[196:199], v[96:99]
    v_mfma_f32_16x16x32_bf16 v[100:103], v[160:163], v[196:199], v[100:103]
    v_mfma_f32_16x16x32_bf16 v[104:107], v[164:167], v[196:199], v[104:107]
    v_mfma_f32_16x16x32_bf16 v[108:111], v[168:171], v[196:199], v[108:111]
    s_waitcnt lgkmcnt(0)
    v_mfma_f32_16x16x32_bf16 v[0:3], v[128:131], v[112:115], v[0:3]
    v_mfma_f32_16x16x32_bf16 v[4:7], v[128:131], v[116:119], v[4:7]
    s_barrier
    v_mfma_f32_16x16x32_bf16 v[8:11], v[128:131], v[120:123], v[8:11]
    ds_read_b128 v[156:159], v207 offset:32768
    v_mfma_f32_16x16x32_bf16 v[12:15], v[128:131], v[124:127], v[12:15]
    ds_read_b64_tr_b16 v[172:173], v201 offset:36864
    v_mfma_f32_16x16x32_bf16 v[16:19], v[132:135], v[112:115], v[16:19]
    ds_read_b64_tr_b16 v[174:175], v201 offset:39168
    v_mfma_f32_16x16x32_bf16 v[20:23], v[132:135], v[116:119], v[20:23]
    ds_read_b128 v[160:163], v207 offset:34816
    v_mfma_f32_16x16x32_bf16 v[24:27], v[132:135], v[120:123], v[24:27]
    ds_read_b128 v[164:167], v207 offset:36864
    v_mfma_f32_16x16x32_bf16 v[28:31], v[132:135], v[124:127], v[28:31]
    ds_read_b128 v[168:171], v207 offset:38912
    v_mfma_f32_16x16x32_bf16 v[32:35], v[136:139], v[112:115], v[32:35]
    ds_read_b64_tr_b16 v[176:177], v203 offset:36864
    v_mfma_f32_16x16x32_bf16 v[36:39], v[136:139], v[116:119], v[36:39]
    ds_read_b64_tr_b16 v[178:179], v203 offset:39168
    v_mfma_f32_16x16x32_bf16 v[40:43], v[136:139], v[120:123], v[40:43]
    ds_read_b64_tr_b16 v[180:181], v201 offset:37056
    v_mfma_f32_16x16x32_bf16 v[44:47], v[136:139], v[124:127], v[44:47]
    ds_read_b64_tr_b16 v[182:183], v201 offset:39360
    v_mfma_f32_16x16x32_bf16 v[48:51], v[140:143], v[112:115], v[48:51]
    ds_read_b64_tr_b16 v[184:185], v203 offset:37056
    v_mfma_f32_16x16x32_bf16 v[52:55], v[140:143], v[116:119], v[52:55]
    ds_read_b64_tr_b16 v[186:187], v203 offset:39360
    v_mfma_f32_16x16x32_bf16 v[56:59], v[140:143], v[120:123], v[56:59]
    ds_read_b64_tr_b16 v[188:189], v201 offset:37248
    v_mfma_f32_16x16x32_bf16 v[60:63], v[140:143], v[124:127], v[60:63]
    ds_read_b64_tr_b16 v[190:191], v201 offset:39552
    v_mfma_f32_16x16x32_bf16 v[64:67], v[112:115], v[144:147], v[64:67]
    ds_read_b64_tr_b16 v[192:193], v203 offset:37248
    v_mfma_f32_16x16x32_bf16 v[68:71], v[116:119], v[144:147], v[68:71]
    ds_read_b64_tr_b16 v[194:195], v203 offset:39552
    v_mfma_f32_16x16x32_bf16 v[72:75], v[120:123], v[144:147], v[72:75]
    ds_read_b64_tr_b16 v[196:197], v205 offset:36864
    v_mfma_f32_16x16x32_bf16 v[76:79], v[124:127], v[144:147], v[76:79]
    ds_read_b64_tr_b16 v[198:199], v205 offset:39168
    v_mfma_f32_16x16x32_bf16 v[80:83], v[112:115], v[148:151], v[80:83]
    v_mfma_f32_16x16x32_bf16 v[84:87], v[116:119], v[148:151], v[84:87]
    v_mfma_f32_16x16x32_bf16 v[88:91], v[120:123], v[148:151], v[88:91]
    v_mfma_f32_16x16x32_bf16 v[92:95], v[124:127], v[148:151], v[92:95]
    v_mfma_f32_16x16x32_bf16 v[96:99], v[112:115], v[152:155], v[96:99]
    v_mfma_f32_16x16x32_bf16 v[100:103], v[116:119], v[152:155], v[100:103]
    v_mfma_f32_16x16x32_bf16 v[104:107], v[120:123], v[152:155], v[104:107]
    v_mfma_f32_16x16x32_bf16 v[108:111], v[124:127], v[152:155], v[108:111]
    s_waitcnt lgkmcnt(0)
    v_mfma_f32_16x16x32_bf16 v[0:3], v[172:175], v[156:159], v[0:3]
    v_mfma_f32_16x16x32_bf16 v[4:7], v[172:175], v[160:163], v[4:7]
    s_barrier
    v_mfma_f32_16x16x32_bf16 v[8:11], v[172:175], v[164:167], v[8:11]
    ds_read_b128 v[112:115], v206 offset:0
    v_mfma_f32_16x16x32_bf16 v[12:15], v[172:175], v[168:171], v[12:15]
    ds_read_b64_tr_b16 v[128:129], v200 offset:0
    v_mfma_f32_16x16x32_bf16 v[16:19], v[176:179], v[156:159], v[16:19]
    ds_read_b64_tr_b16 v[130:131], v200 offset:2304
    v_mfma_f32_16x16x32_bf16 v[20:23], v[176:179], v[160:163], v[20:23]
    ds_read_b128 v[116:119], v206 offset:2048
    v_mfma_f32_16x16x32_bf16 v[24:27], v[176:179], v[164:167], v[24:27]
    ds_read_b128 v[120:123], v206 offset:4096
    v_mfma_f32_16x16x32_bf16 v[28:31], v[176:179], v[168:171], v[28:31]
    ds_read_b128 v[124:127], v206 offset:6144
    v_mfma_f32_16x16x32_bf16 v[32:35], v[180:183], v[156:159], v[32:35]
    ds_read_b64_tr_b16 v[132:133], v202 offset:0
    v_mfma_f32_16x16x32_bf16 v[36:39], v[180:183], v[160:163], v[36:39]
    ds_read_b64_tr_b16 v[134:135], v202 offset:2304
    v_mfma_f32_16x16x32_bf16 v[40:43], v[180:183], v[164:167], v[40:43]
    ds_read_b64_tr_b16 v[136:137], v200 offset:192
    v_mfma_f32_16x16x32_bf16 v[44:47], v[180:183], v[168:171], v[44:47]
    ds_read_b64_tr_b16 v[138:139], v200 offset:2496
    v_mfma_f32_16x16x32_bf16 v[48:51], v[184:187], v[156:159], v[48:51]
    ds_read_b64_tr_b16 v[140:141], v202 offset:192
    v_mfma_f32_16x16x32_bf16 v[52:55], v[184:187], v[160:163], v[52:55]
    ds_read_b64_tr_b16 v[142:143], v202 offset:2496
    v_mfma_f32_16x16x32_bf16 v[56:59], v[184:187], v[164:167], v[56:59]
    ds_read_b64_tr_b16 v[144:145], v200 offset:384
    v_mfma_f32_16x16x32_bf16 v[60:63], v[184:187], v[168:171], v[60:63]
    ds_read_b64_tr_b16 v[146:147], v200 offset:2688
    v_mfma_f32_16x16x32_bf16 v[64:67], v[156:159], v[188:191], v[64:67]
    ds_read_b64_tr_b16 v[148:149], v202 offset:384
    v_mfma_f32_16x16x32_bf16 v[68:71], v[160:163], v[188:191], v[68:71]
    ds_read_b64_tr_b16 v[150:151], v202 offset:2688
    v_mfma_f32_16x16x32_bf16 v[72:75], v[164:167], v[188:191], v[72:75]
    ds_read_b64_tr_b16 v[152:153], v204 offset:0
    v_mfma_f32_16x16x32_bf16 v[76:79], v[168:171], v[188:191], v[76:79]
    ds_read_b64_tr_b16 v[154:155], v204 offset:2304
    v_mfma_f32_16x16x32_bf16 v[80:83], v[156:159], v[192:195], v[80:83]
    v_mfma_f32_16x16x32_bf16 v[84:87], v[160:163], v[192:195], v[84:87]
    v_mfma_f32_16x16x32_bf16 v[88:91], v[164:167], v[192:195], v[88:91]
    v_mfma_f32_16x16x32_bf16 v[92:95], v[168:171], v[192:195], v[92:95]
    v_mfma_f32_16x16x32_bf16 v[96:99], v[156:159], v[196:199], v[96:99]
    v_mfma_f32_16x16x32_bf16 v[100:103], v[160:163], v[196:199], v[100:103]
    v_mfma_f32_16x16x32_bf16 v[104:107], v[164:167], v[196:199], v[104:107]
    v_mfma_f32_16x16x32_bf16 v[108:111], v[168:171], v[196:199], v[108:111]
    s_waitcnt lgkmcnt(0)
    v_mfma_f32_16x16x32_bf16 v[0:3], v[128:131], v[112:115], v[0:3]
    v_mfma_f32_16x16x32_bf16 v[4:7], v[128:131], v[116:119], v[4:7]
    s_barrier
    v_mfma_f32_16x16x32_bf16 v[8:11], v[128:131], v[120:123], v[8:11]
    ds_read_b128 v[156:159], v207 offset:0
    v_mfma_f32_16x16x32_bf16 v[12:15], v[128:131], v[124:127], v[12:15]
    ds_read_b64_tr_b16 v[172:173], v200 offset:18432
    v_mfma_f32_16x16x32_bf16 v[16:19], v[132:135], v[112:115], v[16:19]
    ds_read_b64_tr_b16 v[174:175], v200 offset:20736
    v_mfma_f32_16x16x32_bf16 v[20:23], v[132:135], v[116:119], v[20:23]
    ds_read_b128 v[160:163], v207 offset:2048
    v_mfma_f32_16x16x32_bf16 v[24:27], v[132:135], v[120:123], v[24:27]
    ds_read_b128 v[164:167], v207 offset:4096
    v_mfma_f32_16x16x32_bf16 v[28:31], v[132:135], v[124:127], v[28:31]
    ds_read_b128 v[168:171], v207 offset:6144
    v_mfma_f32_16x16x32_bf16 v[32:35], v[136:139], v[112:115], v[32:35]
    ds_read_b64_tr_b16 v[176:177], v202 offset:18432
    v_mfma_f32_16x16x32_bf16 v[36:39], v[136:139], v[116:119], v[36:39]
    ds_read_b64_tr_b16 v[178:179], v202 offset:20736
    v_mfma_f32_16x16x32_bf16 v[40:43], v[136:139], v[120:123], v[40:43]
    ds_read_b64_tr_b16 v[180:181], v200 offset:18624
    v_mfma_f32_16x16x32_bf16 v[44:47], v[136:139], v[124:127], v[44:47]
    ds_read_b64_tr_b16 v[182:183], v200 offset:20928
    v_mfma_f32_16x16x32_bf16 v[48:51], v[140:143], v[112:115], v[48:51]
    ds_read_b64_tr_b16 v[184:185], v202 offset:18624
    v_mfma_f32_16x16x32_bf16 v[52:55], v[140:143], v[116:119], v[52:55]
    ds_read_b64_tr_b16 v[186:187], v202 offset:20928
    v_mfma_f32_16x16x32_bf16 v[56:59], v[140:143], v[120:123], v[56:59]
    ds_read_b64_tr_b16 v[188:189], v200 offset:18816
    v_mfma_f32_16x16x32_bf16 v[60:63], v[140:143], v[124:127], v[60:63]
    ds_read_b64_tr_b16 v[190:191], v200 offset:21120
    v_mfma_f32_16x16x32_bf16 v[64:67], v[112:115], v[144:147], v[64:67]
    ds_read_b64_tr_b16 v[192:193], v202 offset:18816
    v_mfma_f32_16x16x32_bf16 v[68:71], v[116:119], v[144:147], v[68:71]
    ds_read_b64_tr_b16 v[194:195], v202 offset:21120
    v_mfma_f32_16x16x32_bf16 v[72:75], v[120:123], v[144:147], v[72:75]
    ds_read_b64_tr_b16 v[196:197], v204 offset:18432
    v_mfma_f32_16x16x32_bf16 v[76:79], v[124:127], v[144:147], v[76:79]
    ds_read_b64_tr_b16 v[198:199], v204 offset:20736
    v_mfma_f32_16x16x32_bf16 v[80:83], v[112:115], v[148:151], v[80:83]
    v_mfma_f32_16x16x32_bf16 v[84:87], v[116:119], v[148:151], v[84:87]
    v_mfma_f32_16x16x32_bf16 v[88:91], v[120:123], v[148:151], v[88:91]
    v_mfma_f32_16x16x32_bf16 v[92:95], v[124:127], v[148:151], v[92:95]
    v_mfma_f32_16x16x32_bf16 v[96:99], v[112:115], v[152:155], v[96:99]
    v_mfma_f32_16x16x32_bf16 v[100:103], v[116:119], v[152:155], v[100:103]
    v_mfma_f32_16x16x32_bf16 v[104:107], v[120:123], v[152:155], v[104:107]
    v_mfma_f32_16x16x32_bf16 v[108:111], v[124:127], v[152:155], v[108:111]
    s_waitcnt lgkmcnt(0)
    v_mfma_f32_16x16x32_bf16 v[0:3], v[172:175], v[156:159], v[0:3]
    v_mfma_f32_16x16x32_bf16 v[4:7], v[172:175], v[160:163], v[4:7]
    s_barrier
    v_mfma_f32_16x16x32_bf16 v[8:11], v[172:175], v[164:167], v[8:11]
    ds_read_b128 v[112:115], v206 offset:16384
    v_mfma_f32_16x16x32_bf16 v[12:15], v[172:175], v[168:171], v[12:15]
    ds_read_b64_tr_b16 v[128:129], v200 offset:36864
    v_mfma_f32_16x16x32_bf16 v[16:19], v[176:179], v[156:159], v[16:19]
    ds_read_b64_tr_b16 v[130:131], v200 offset:39168
    v_mfma_f32_16x16x32_bf16 v[20:23], v[176:179], v[160:163], v[20:23]
    ds_read_b128 v[116:119], v206 offset:18432
    v_mfma_f32_16x16x32_bf16 v[24:27], v[176:179], v[164:167], v[24:27]
    ds_read_b128 v[120:123], v206 offset:20480
    v_mfma_f32_16x16x32_bf16 v[28:31], v[176:179], v[168:171], v[28:31]
    ds_read_b128 v[124:127], v206 offset:22528
    v_mfma_f32_16x16x32_bf16 v[32:35], v[180:183], v[156:159], v[32:35]
    ds_read_b64_tr_b16 v[132:133], v202 offset:36864
    v_mfma_f32_16x16x32_bf16 v[36:39], v[180:183], v[160:163], v[36:39]
    ds_read_b64_tr_b16 v[134:135], v202 offset:39168
    v_mfma_f32_16x16x32_bf16 v[40:43], v[180:183], v[164:167], v[40:43]
    ds_read_b64_tr_b16 v[136:137], v200 offset:37056
    v_mfma_f32_16x16x32_bf16 v[44:47], v[180:183], v[168:171], v[44:47]
    ds_read_b64_tr_b16 v[138:139], v200 offset:39360
    v_mfma_f32_16x16x32_bf16 v[48:51], v[184:187], v[156:159], v[48:51]
    ds_read_b64_tr_b16 v[140:141], v202 offset:37056
    v_mfma_f32_16x16x32_bf16 v[52:55], v[184:187], v[160:163], v[52:55]
    ds_read_b64_tr_b16 v[142:143], v202 offset:39360
    v_mfma_f32_16x16x32_bf16 v[56:59], v[184:187], v[164:167], v[56:59]
    ds_read_b64_tr_b16 v[144:145], v200 offset:37248
    v_mfma_f32_16x16x32_bf16 v[60:63], v[184:187], v[168:171], v[60:63]
    ds_read_b64_tr_b16 v[146:147], v200 offset:39552
    v_mfma_f32_16x16x32_bf16 v[64:67], v[156:159], v[188:191], v[64:67]
    ds_read_b64_tr_b16 v[148:149], v202 offset:37248
    v_mfma_f32_16x16x32_bf16 v[68:71], v[160:163], v[188:191], v[68:71]
    ds_read_b64_tr_b16 v[150:151], v202 offset:39552
    v_mfma_f32_16x16x32_bf16 v[72:75], v[164:167], v[188:191], v[72:75]
    ds_read_b64_tr_b16 v[152:153], v204 offset:36864
    v_mfma_f32_16x16x32_bf16 v[76:79], v[168:171], v[188:191], v[76:79]
    ds_read_b64_tr_b16 v[154:155], v204 offset:39168
    v_mfma_f32_16x16x32_bf16 v[80:83], v[156:159], v[192:195], v[80:83]
    v_mfma_f32_16x16x32_bf16 v[84:87], v[160:163], v[192:195], v[84:87]
    v_mfma_f32_16x16x32_bf16 v[88:91], v[164:167], v[192:195], v[88:91]
    v_mfma_f32_16x16x32_bf16 v[92:95], v[168:171], v[192:195], v[92:95]
    v_mfma_f32_16x16x32_bf16 v[96:99], v[156:159], v[196:199], v[96:99]
    v_mfma_f32_16x16x32_bf16 v[100:103], v[160:163], v[196:199], v[100:103]
    v_mfma_f32_16x16x32_bf16 v[104:107], v[164:167], v[196:199], v[104:107]
    v_mfma_f32_16x16x32_bf16 v[108:111], v[168:171], v[196:199], v[108:111]
    s_waitcnt lgkmcnt(0)
    v_mfma_f32_16x16x32_bf16 v[0:3], v[128:131], v[112:115], v[0:3]
    v_mfma_f32_16x16x32_bf16 v[4:7], v[128:131], v[116:119], v[4:7]
    s_barrier
    v_mfma_f32_16x16x32_bf16 v[8:11], v[128:131], v[120:123], v[8:11]
    ds_read_b128 v[156:159], v207 offset:16384
    v_mfma_f32_16x16x32_bf16 v[12:15], v[128:131], v[124:127], v[12:15]
    ds_read_b64_tr_b16 v[172:173], v201 offset:0
    v_mfma_f32_16x16x32_bf16 v[16:19], v[132:135], v[112:115], v[16:19]
    ds_read_b64_tr_b16 v[174:175], v201 offset:2304
    v_mfma_f32_16x16x32_bf16 v[20:23], v[132:135], v[116:119], v[20:23]
    ds_read_b128 v[160:163], v207 offset:18432
    v_mfma_f32_16x16x32_bf16 v[24:27], v[132:135], v[120:123], v[24:27]
    ds_read_b128 v[164:167], v207 offset:20480
    v_mfma_f32_16x16x32_bf16 v[28:31], v[132:135], v[124:127], v[28:31]
    ds_read_b128 v[168:171], v207 offset:22528
    v_mfma_f32_16x16x32_bf16 v[32:35], v[136:139], v[112:115], v[32:35]
    ds_read_b64_tr_b16 v[176:177], v203 offset:0
    v_mfma_f32_16x16x32_bf16 v[36:39], v[136:139], v[116:119], v[36:39]
    ds_read_b64_tr_b16 v[178:179], v203 offset:2304
    v_mfma_f32_16x16x32_bf16 v[40:43], v[136:139], v[120:123], v[40:43]
    ds_read_b64_tr_b16 v[180:181], v201 offset:192
    v_mfma_f32_16x16x32_bf16 v[44:47], v[136:139], v[124:127], v[44:47]
    ds_read_b64_tr_b16 v[182:183], v201 offset:2496
    v_mfma_f32_16x16x32_bf16 v[48:51], v[140:143], v[112:115], v[48:51]
    ds_read_b64_tr_b16 v[184:185], v203 offset:192
    v_mfma_f32_16x16x32_bf16 v[52:55], v[140:143], v[116:119], v[52:55]
    ds_read_b64_tr_b16 v[186:187], v203 offset:2496
    v_mfma_f32_16x16x32_bf16 v[56:59], v[140:143], v[120:123], v[56:59]
    ds_read_b64_tr_b16 v[188:189], v201 offset:384
    v_mfma_f32_16x16x32_bf16 v[60:63], v[140:143], v[124:127], v[60:63]
    ds_read_b64_tr_b16 v[190:191], v201 offset:2688
    v_mfma_f32_16x16x32_bf16 v[64:67], v[112:115], v[144:147], v[64:67]
    ds_read_b64_tr_b16 v[192:193], v203 offset:384
    v_mfma_f32_16x16x32_bf16 v[68:71], v[116:119], v[144:147], v[68:71]
    ds_read_b64_tr_b16 v[194:195], v203 offset:2688
    v_mfma_f32_16x16x32_bf16 v[72:75], v[120:123], v[144:147], v[72:75]
    ds_read_b64_tr_b16 v[196:197], v205 offset:0
    v_mfma_f32_16x16x32_bf16 v[76:79], v[124:127], v[144:147], v[76:79]
    ds_read_b64_tr_b16 v[198:199], v205 offset:2304
    v_mfma_f32_16x16x32_bf16 v[80:83], v[112:115], v[148:151], v[80:83]
    v_mfma_f32_16x16x32_bf16 v[84:87], v[116:119], v[148:151], v[84:87]
    v_mfma_f32_16x16x32_bf16 v[88:91], v[120:123], v[148:151], v[88:91]
    v_mfma_f32_16x16x32_bf16 v[92:95], v[124:127], v[148:151], v[92:95]
    v_mfma_f32_16x16x32_bf16 v[96:99], v[112:115], v[152:155], v[96:99]
    v_mfma_f32_16x16x32_bf16 v[100:103], v[116:119], v[152:155], v[100:103]
    v_mfma_f32_16x16x32_bf16 v[104:107], v[120:123], v[152:155], v[104:107]
    v_mfma_f32_16x16x32_bf16 v[108:111], v[124:127], v[152:155], v[108:111]
    s_waitcnt lgkmcnt(0)
    v_mfma_f32_16x16x32_bf16 v[0:3], v[172:175], v[156:159], v[0:3]
    v_mfma_f32_16x16x32_bf16 v[4:7], v[172:175], v[160:163], v[4:7]
    s_barrier
    v_mfma_f32_16x16x32_bf16 v[8:11], v[172:175], v[164:167], v[8:11]
    ds_read_b128 v[112:115], v206 offset:32768
    v_mfma_f32_16x16x32_bf16 v[12:15], v[172:175], v[168:171], v[12:15]
    ds_read_b64_tr_b16 v[128:129], v201 offset:18432
    v_mfma_f32_16x16x32_bf16 v[16:19], v[176:179], v[156:159], v[16:19]
    ds_read_b64_tr_b16 v[130:131], v201 offset:20736
    v_mfma_f32_16x16x32_bf16 v[20:23], v[176:179], v[160:163], v[20:23]
    ds_read_b128 v[116:119], v206 offset:34816
    v_mfma_f32_16x16x32_bf16 v[24:27], v[176:179], v[164:167], v[24:27]
    ds_read_b128 v[120:123], v206 offset:36864
    v_mfma_f32_16x16x32_bf16 v[28:31], v[176:179], v[168:171], v[28:31]
    ds_read_b128 v[124:127], v206 offset:38912
    v_mfma_f32_16x16x32_bf16 v[32:35], v[180:183], v[156:159], v[32:35]
    ds_read_b64_tr_b16 v[132:133], v203 offset:18432
    v_mfma_f32_16x16x32_bf16 v[36:39], v[180:183], v[160:163], v[36:39]
    ds_read_b64_tr_b16 v[134:135], v203 offset:20736
    v_mfma_f32_16x16x32_bf16 v[40:43], v[180:183], v[164:167], v[40:43]
    ds_read_b64_tr_b16 v[136:137], v201 offset:18624
    v_mfma_f32_16x16x32_bf16 v[44:47], v[180:183], v[168:171], v[44:47]
    ds_read_b64_tr_b16 v[138:139], v201 offset:20928
    v_mfma_f32_16x16x32_bf16 v[48:51], v[184:187], v[156:159], v[48:51]
    ds_read_b64_tr_b16 v[140:141], v203 offset:18624
    v_mfma_f32_16x16x32_bf16 v[52:55], v[184:187], v[160:163], v[52:55]
    ds_read_b64_tr_b16 v[142:143], v203 offset:20928
    v_mfma_f32_16x16x32_bf16 v[56:59], v[184:187], v[164:167], v[56:59]
    ds_read_b64_tr_b16 v[144:145], v201 offset:18816
    v_mfma_f32_16x16x32_bf16 v[60:63], v[184:187], v[168:171], v[60:63]
    ds_read_b64_tr_b16 v[146:147], v201 offset:21120
    v_mfma_f32_16x16x32_bf16 v[64:67], v[156:159], v[188:191], v[64:67]
    ds_read_b64_tr_b16 v[148:149], v203 offset:18816
    v_mfma_f32_16x16x32_bf16 v[68:71], v[160:163], v[188:191], v[68:71]
    ds_read_b64_tr_b16 v[150:151], v203 offset:21120
    v_mfma_f32_16x16x32_bf16 v[72:75], v[164:167], v[188:191], v[72:75]
    ds_read_b64_tr_b16 v[152:153], v205 offset:18432
    v_mfma_f32_16x16x32_bf16 v[76:79], v[168:171], v[188:191], v[76:79]
    ds_read_b64_tr_b16 v[154:155], v205 offset:20736
    v_mfma_f32_16x16x32_bf16 v[80:83], v[156:159], v[192:195], v[80:83]
    v_mfma_f32_16x16x32_bf16 v[84:87], v[160:163], v[192:195], v[84:87]
    v_mfma_f32_16x16x32_bf16 v[88:91], v[164:167], v[192:195], v[88:91]
    v_mfma_f32_16x16x32_bf16 v[92:95], v[168:171], v[192:195], v[92:95]
    v_mfma_f32_16x16x32_bf16 v[96:99], v[156:159], v[196:199], v[96:99]
    v_mfma_f32_16x16x32_bf16 v[100:103], v[160:163], v[196:199], v[100:103]
    v_mfma_f32_16x16x32_bf16 v[104:107], v[164:167], v[196:199], v[104:107]
    v_mfma_f32_16x16x32_bf16 v[108:111], v[168:171], v[196:199], v[108:111]
    s_waitcnt lgkmcnt(0)
    v_mfma_f32_16x16x32_bf16 v[0:3], v[128:131], v[112:115], v[0:3]
    v_mfma_f32_16x16x32_bf16 v[4:7], v[128:131], v[116:119], v[4:7]
    s_barrier
    v_mfma_f32_16x16x32_bf16 v[8:11], v[128:131], v[120:123], v[8:11]
    ds_read_b128 v[156:159], v207 offset:32768
    v_mfma_f32_16x16x32_bf16 v[12:15], v[128:131], v[124:127], v[12:15]
    ds_read_b64_tr_b16 v[172:173], v201 offset:36864
    v_mfma_f32_16x16x32_bf16 v[16:19], v[132:135], v[112:115], v[16:19]
    ds_read_b64_tr_b16 v[174:175], v201 offset:39168
    v_mfma_f32_16x16x32_bf16 v[20:23], v[132:135], v[116:119], v[20:23]
    ds_read_b128 v[160:163], v207 offset:34816
    v_mfma_f32_16x16x32_bf16 v[24:27], v[132:135], v[120:123], v[24:27]
    ds_read_b128 v[164:167], v207 offset:36864
    v_mfma_f32_16x16x32_bf16 v[28:31], v[132:135], v[124:127], v[28:31]
    ds_read_b128 v[168:171], v207 offset:38912
    v_mfma_f32_16x16x32_bf16 v[32:35], v[136:139], v[112:115], v[32:35]
    ds_read_b64_tr_b16 v[176:177], v203 offset:36864
    v_mfma_f32_16x16x32_bf16 v[36:39], v[136:139], v[116:119], v[36:39]
    ds_read_b64_tr_b16 v[178:179], v203 offset:39168
    v_mfma_f32_16x16x32_bf16 v[40:43], v[136:139], v[120:123], v[40:43]
    ds_read_b64_tr_b16 v[180:181], v201 offset:37056
    v_mfma_f32_16x16x32_bf16 v[44:47], v[136:139], v[124:127], v[44:47]
    ds_read_b64_tr_b16 v[182:183], v201 offset:39360
    v_mfma_f32_16x16x32_bf16 v[48:51], v[140:143], v[112:115], v[48:51]
    ds_read_b64_tr_b16 v[184:185], v203 offset:37056
    v_mfma_f32_16x16x32_bf16 v[52:55], v[140:143], v[116:119], v[52:55]
    ds_read_b64_tr_b16 v[186:187], v203 offset:39360
    v_mfma_f32_16x16x32_bf16 v[56:59], v[140:143], v[120:123], v[56:59]
    ds_read_b64_tr_b16 v[188:189], v201 offset:37248
    v_mfma_f32_16x16x32_bf16 v[60:63], v[140:143], v[124:127], v[60:63]
    ds_read_b64_tr_b16 v[190:191], v201 offset:39552
    v_mfma_f32_16x16x32_bf16 v[64:67], v[112:115], v[144:147], v[64:67]
    ds_read_b64_tr_b16 v[192:193], v203 offset:37248
    v_mfma_f32_16x16x32_bf16 v[68:71], v[116:119], v[144:147], v[68:71]
    ds_read_b64_tr_b16 v[194:195], v203 offset:39552
    v_mfma_f32_16x16x32_bf16 v[72:75], v[120:123], v[144:147], v[72:75]
    ds_read_b64_tr_b16 v[196:197], v205 offset:36864
    v_mfma_f32_16x16x32_bf16 v[76:79], v[124:127], v[144:147], v[76:79]
    ds_read_b64_tr_b16 v[198:199], v205 offset:39168
    v_mfma_f32_16x16x32_bf16 v[80:83], v[112:115], v[148:151], v[80:83]
    v_mfma_f32_16x16x32_bf16 v[84:87], v[116:119], v[148:151], v[84:87]
    v_mfma_f32_16x16x32_bf16 v[88:91], v[120:123], v[148:151], v[88:91]
    v_mfma_f32_16x16x32_bf16 v[92:95], v[124:127], v[148:151], v[92:95]
    v_mfma_f32_16x16x32_bf16 v[96:99], v[112:115], v[152:155], v[96:99]
    v_mfma_f32_16x16x32_bf16 v[100:103], v[116:119], v[152:155], v[100:103]
    v_mfma_f32_16x16x32_bf16 v[104:107], v[120:123], v[152:155], v[104:107]
    v_mfma_f32_16x16x32_bf16 v[108:111], v[124:127], v[152:155], v[108:111]
    s_waitcnt lgkmcnt(0)
    v_mfma_f32_16x16x32_bf16 v[0:3], v[172:175], v[156:159], v[0:3]
    v_mfma_f32_16x16x32_bf16 v[4:7], v[172:175], v[160:163], v[4:7]
    v_mfma_f32_16x16x32_bf16 v[8:11], v[172:175], v[164:167], v[8:11]
    v_mfma_f32_16x16x32_bf16 v[12:15], v[172:175], v[168:171], v[12:15]
    v_mfma_f32_16x16x32_bf16 v[16:19], v[176:179], v[156:159], v[16:19]
    v_mfma_f32_16x16x32_bf16 v[20:23], v[176:179], v[160:163], v[20:23]
    v_mfma_f32_16x16x32_bf16 v[24:27], v[176:179], v[164:167], v[24:27]
    v_mfma_f32_16x16x32_bf16 v[28:31], v[176:179], v[168:171], v[28:31]
    v_mfma_f32_16x16x32_bf16 v[32:35], v[180:183], v[156:159], v[32:35]
    v_mfma_f32_16x16x32_bf16 v[36:39], v[180:183], v[160:163], v[36:39]
    v_mfma_f32_16x16x32_bf16 v[40:43], v[180:183], v[164:167], v[40:43]
    v_mfma_f32_16x16x32_bf16 v[44:47], v[180:183], v[168:171], v[44:47]
    v_mfma_f32_16x16x32_bf16 v[48:51], v[184:187], v[156:159], v[48:51]
    v_mfma_f32_16x16x32_bf16 v[52:55], v[184:187], v[160:163], v[52:55]
    v_mfma_f32_16x16x32_bf16 v[56:59], v[184:187], v[164:167], v[56:59]
    v_mfma_f32_16x16x32_bf16 v[60:63], v[184:187], v[168:171], v[60:63]
    v_mfma_f32_16x16x32_bf16 v[64:67], v[156:159], v[188:191], v[64:67]
    v_mfma_f32_16x16x32_bf16 v[68:71], v[160:163], v[188:191], v[68:71]
    v_mfma_f32_16x16x32_bf16 v[72:75], v[164:167], v[188:191], v[72:75]
    v_mfma_f32_16x16x32_bf16 v[76:79], v[168:171], v[188:191], v[76:79]
    v_mfma_f32_16x16x32_bf16 v[80:83], v[156:159], v[192:195], v[80:83]
    v_mfma_f32_16x16x32_bf16 v[84:87], v[160:163], v[192:195], v[84:87]
    v_mfma_f32_16x16x32_bf16 v[88:91], v[164:167], v[192:195], v[88:91]
    v_mfma_f32_16x16x32_bf16 v[92:95], v[168:171], v[192:195], v[92:95]
    v_mfma_f32_16x16x32_bf16 v[96:99], v[156:159], v[196:199], v[96:99]
    v_mfma_f32_16x16x32_bf16 v[100:103], v[160:163], v[196:199], v[100:103]
    v_mfma_f32_16x16x32_bf16 v[104:107], v[164:167], v[196:199], v[104:107]
    v_mfma_f32_16x16x32_bf16 v[108:111], v[168:171], v[196:199], v[108:111]
    s_waitcnt vmcnt(0)
    s_and_b32 s21, s21, 0xffff
    s_mov_b32 s22, 21397504
    s_mov_b32 s23, 0x00020000
    s_nop 5
    v_pk_mul_f32 v[0:1], v[0:1], s[52:53]
    v_pk_mul_f32 v[2:3], v[2:3], s[52:53]
    v_pk_mul_f32 v[4:5], v[4:5], s[52:53]
    v_pk_mul_f32 v[6:7], v[6:7], s[52:53]
    v_cvt_pk_bf16_f32 v220, v0, v1
    v_cvt_pk_bf16_f32 v221, v2, v3
    v_cvt_pk_bf16_f32 v222, v4, v5
    v_cvt_pk_bf16_f32 v223, v6, v7
    s_nop 1
    v_permlane16_swap_b32 v220, v222
    v_permlane16_swap_b32 v221, v223
    buffer_store_dwordx4 v[220:223], v212, s[20:23], s44 offen offset:0 sc1
    v_pk_mul_f32 v[8:9], v[8:9], s[52:53]
    v_pk_mul_f32 v[10:11], v[10:11], s[52:53]
    v_pk_mul_f32 v[12:13], v[12:13], s[52:53]
    v_pk_mul_f32 v[14:15], v[14:15], s[52:53]
    v_cvt_pk_bf16_f32 v224, v8, v9
    v_cvt_pk_bf16_f32 v225, v10, v11
    v_cvt_pk_bf16_f32 v226, v12, v13
    v_cvt_pk_bf16_f32 v227, v14, v15
    s_nop 1
    v_permlane16_swap_b32 v224, v226
    v_permlane16_swap_b32 v225, v227
    buffer_store_dwordx4 v[224:227], v212, s[20:23], s44 offen offset:1024 sc1
    v_pk_mul_f32 v[16:17], v[16:17], s[52:53]
    v_pk_mul_f32 v[18:19], v[18:19], s[52:53]
    v_pk_mul_f32 v[20:21], v[20:21], s[52:53]
    v_pk_mul_f32 v[22:23], v[22:23], s[52:53]
    v_cvt_pk_bf16_f32 v228, v16, v17
    v_cvt_pk_bf16_f32 v229, v18, v19
    v_cvt_pk_bf16_f32 v230, v20, v21
    v_cvt_pk_bf16_f32 v231, v22, v23
    s_nop 1
    v_permlane16_swap_b32 v228, v230
    v_permlane16_swap_b32 v229, v231
    buffer_store_dwordx4 v[228:231], v212, s[20:23], s49 offen offset:0 sc1
    v_pk_mul_f32 v[24:25], v[24:25], s[52:53]
    v_pk_mul_f32 v[26:27], v[26:27], s[52:53]
    v_pk_mul_f32 v[28:29], v[28:29], s[52:53]
    v_pk_mul_f32 v[30:31], v[30:31], s[52:53]
    v_cvt_pk_bf16_f32 v232, v24, v25
    v_cvt_pk_bf16_f32 v233, v26, v27
    v_cvt_pk_bf16_f32 v234, v28, v29
    v_cvt_pk_bf16_f32 v235, v30, v31
    s_nop 1
    v_permlane16_swap_b32 v232, v234
    v_permlane16_swap_b32 v233, v235
    buffer_store_dwordx4 v[232:235], v212, s[20:23], s49 offen offset:1024 sc1
    v_cvt_pk_bf16_f32 v220, v32, v33
    v_cvt_pk_bf16_f32 v221, v34, v35
    v_cvt_pk_bf16_f32 v222, v36, v37
    v_cvt_pk_bf16_f32 v223, v38, v39
    s_nop 1
    v_permlane16_swap_b32 v220, v222
    v_permlane16_swap_b32 v221, v223
    buffer_store_dwordx4 v[220:223], v213, s[20:23], s45 offen offset:0 sc1
    v_cvt_pk_bf16_f32 v224, v40, v41
    v_cvt_pk_bf16_f32 v225, v42, v43
    v_cvt_pk_bf16_f32 v226, v44, v45
    v_cvt_pk_bf16_f32 v227, v46, v47
    s_nop 1
    v_permlane16_swap_b32 v224, v226
    v_permlane16_swap_b32 v225, v227
    buffer_store_dwordx4 v[224:227], v213, s[20:23], s45 offen offset:1024 sc1
    v_cvt_pk_bf16_f32 v228, v48, v49
    v_cvt_pk_bf16_f32 v229, v50, v51
    v_cvt_pk_bf16_f32 v230, v52, v53
    v_cvt_pk_bf16_f32 v231, v54, v55
    s_nop 1
    v_permlane16_swap_b32 v228, v230
    v_permlane16_swap_b32 v229, v231
    buffer_store_dwordx4 v[228:231], v213, s[20:23], s50 offen offset:0 sc1
    v_cvt_pk_bf16_f32 v232, v56, v57
    v_cvt_pk_bf16_f32 v233, v58, v59
    v_cvt_pk_bf16_f32 v234, v60, v61
    v_cvt_pk_bf16_f32 v235, v62, v63
    s_nop 1
    v_permlane16_swap_b32 v232, v234
    v_permlane16_swap_b32 v233, v235
    buffer_store_dwordx4 v[232:235], v213, s[20:23], s50 offen offset:1024 sc1
    v_cvt_pk_bf16_f32 v220, v64, v65
    v_cvt_pk_bf16_f32 v221, v66, v67
    v_cvt_pk_bf16_f32 v222, v68, v69
    v_cvt_pk_bf16_f32 v223, v70, v71
    s_nop 1
    v_permlane16_swap_b32 v220, v222
    v_permlane16_swap_b32 v221, v223
    buffer_store_dwordx4 v[220:223], v214, s[20:23], s46 offen offset:0
    v_cvt_pk_bf16_f32 v224, v72, v73
    v_cvt_pk_bf16_f32 v225, v74, v75
    v_cvt_pk_bf16_f32 v226, v76, v77
    v_cvt_pk_bf16_f32 v227, v78, v79
    s_nop 1
    v_permlane16_swap_b32 v224, v226
    v_permlane16_swap_b32 v225, v227
    buffer_store_dwordx4 v[224:227], v214, s[20:23], s46 offen offset:1216
    v_cvt_pk_bf16_f32 v228, v80, v81
    v_cvt_pk_bf16_f32 v229, v82, v83
    v_cvt_pk_bf16_f32 v230, v84, v85
    v_cvt_pk_bf16_f32 v231, v86, v87
    s_nop 1
    v_permlane16_swap_b32 v228, v230
    v_permlane16_swap_b32 v229, v231
    buffer_store_dwordx4 v[228:231], v214, s[20:23], s51 offen offset:32
    v_cvt_pk_bf16_f32 v232, v88, v89
    v_cvt_pk_bf16_f32 v233, v90, v91
    v_cvt_pk_bf16_f32 v234, v92, v93
    v_cvt_pk_bf16_f32 v235, v94, v95
    s_nop 1
    v_permlane16_swap_b32 v232, v234
    v_permlane16_swap_b32 v233, v235
    buffer_store_dwordx4 v[232:235], v214, s[20:23], s51 offen offset:1248
    v_mov_b32 v112, 0x3f803f80
    v_cvt_pk_bf16_f32 v220, v96, v97
    v_cvt_pk_bf16_f32 v221, v98, v99
    v_cvt_pk_bf16_f32 v222, v100, v101
    v_cvt_pk_bf16_f32 v223, v102, v103
    v_cndmask_b32 v220, v112, v220, s[42:43]
    v_cndmask_b32 v221, v112, v221, s[42:43]
    v_cndmask_b32 v222, v112, v222, s[42:43]
    v_cndmask_b32 v223, v112, v223, s[42:43]
    s_nop 1
    v_permlane16_swap_b32 v220, v222
    v_permlane16_swap_b32 v221, v223
    buffer_store_dwordx4 v[220:223], v215, s[20:23], s47 offen offset:0
    v_cvt_pk_bf16_f32 v224, v104, v105
    v_cvt_pk_bf16_f32 v225, v106, v107
    v_cvt_pk_bf16_f32 v226, v108, v109
    v_cvt_pk_bf16_f32 v227, v110, v111
    v_cndmask_b32 v224, v112, v224, s[42:43]
    v_cndmask_b32 v225, v112, v225, s[42:43]
    v_cndmask_b32 v226, v112, v226, s[42:43]
    v_cndmask_b32 v227, v112, v227, s[42:43]
    s_nop 1
    v_permlane16_swap_b32 v224, v226
    v_permlane16_swap_b32 v225, v227
    buffer_store_dwordx4 v[224:227], v215, s[20:23], s47 offen offset:1216
    s_endpgm
K1_END:
    s_endpgm

.globl attn_kernel
    .p2align 8
    .type attn_kernel,@function
attn_kernel:
    s_cmp_ge_u32 s2, 512
    s_cbranch_scc1 K2_END
    s_load_dwordx2 s[4:5], s[0:1], 64
    v_lshrrev_b32 v9, 6, v0
    v_and_b32 v0, 63, v0
    v_readfirstlane_b32 s14, v9
    s_and_b32 s3, s2, 7
    s_lshl_b32 s3, s3, 2
    s_bfe_u32 s12, s2, 0x20003
    s_or_b32 s12, s12, s3
    s_lshr_b32 s13, s2, 5
    s_mov_b32 s15, 0
    s_mov_b32 s72, -1
    s_mov_b32 s73, 0
    s_lshl_b32 s37, s12, 16
    s_lshl_b32 s38, s14, 14
    s_add_u32 s16, s37, s38
    s_add_u32 s16, s16, 4194304
    s_lshl_b32 s38, s13, 12
    s_add_u32 s27, s37, s38
    s_lshl_b32 s37, s12, 13
    s_lshl_b32 s38, s14, 11
    s_add_u32 s20, s37, s38
    s_add_u32 s20, s20, 8912896
    s_lshl_b32 s38, s13, 9
    s_add_u32 s28, s37, s38
    s_add_u32 s28, s28, 8388608
    s_mul_i32 s37, s12, 77824
    s_mul_i32 s38, s14, 19456
    s_add_u32 s21, s37, s38
    s_add_u32 s21, s21, 9437184
    v_lshlrev_b32 v1, 4, v0
    v_and_b32 v9, 31, v0
    v_lshlrev_b32 v2, 2, v9
    v_lshrrev_b32 v10, 5, v0
    v_bfrev_b32 v11, 1
    v_cmp_gt_u32 s[40:41], 32, v0
    v_mul_u32_u24 v12, 304, v10
    v_cmp_gt_u32 vcc, 19, v9
    v_lshl_add_u32 v12, v9, 4, v12
    v_cndmask_b32 v4, v11, v2, s[40:41]
    v_cndmask_b32 v3, v11, v12, vcc
    s_waitcnt lgkmcnt(0)
    s_mov_b32 s8, s4
    s_and_b32 s9, s5, 0xffff
    s_mov_b32 s10, 21397504
    s_mov_b32 s11, 0x00020000
    v_mov_b32 v125, 0
    v_mov_b32 v131, 0
    v_mov_b32 v137, 0
    v_mov_b32 v143, 0
K2_A_START:
    buffer_load_dwordx4 v[144:147], v1, s[8:11], s16 offen offset:0
    buffer_load_dword v148, v2, s[8:11], s20 offen offset:0
    buffer_load_dwordx4 v[120:123], v1, s[8:11], s27 offen offset:0
    buffer_load_dword v124, v4, s[8:11], s28 offen offset:0
    buffer_load_dwordx4 v[126:129], v1, s[8:11], s27 offen offset:1024
    buffer_load_dword v130, v4, s[8:11], s28 offen offset:128
    buffer_load_dwordx4 v[150:153], v3, s[8:11], s21 offen offset:0
    buffer_load_dwordx4 v[154:157], v3, s[8:11], s21 offen offset:608
    buffer_load_dwordx4 v[132:135], v1, s[8:11], s27 offen offset:2048
    buffer_load_dword v136, v4, s[8:11], s28 offen offset:256
    buffer_load_dwordx4 v[138:141], v1, s[8:11], s27 offen offset:3072
    buffer_load_dword v142, v4, s[8:11], s28 offen offset:384
    v_mov_b32 v149, 0x3f803f80
    v_mov_b32 v163, 0x3f803f80
    v_mov_b32 v177, 0x3f803f80
    v_and_b32 v9, 31, v0
    v_lshrrev_b32 v10, 5, v0
    v_bfrev_b32 v11, 1
    v_cmp_gt_u32 s[40:41], 32, v0
    v_lshrrev_b32 v13, 4, v9
    v_mul_u32_u24 v13, 18432, v13
    v_and_b32 v14, 15, v9
    v_lshl_add_u32 v13, v14, 4, v13
    v_lshl_add_u32 v5, v10, 8, v13
    s_lshr_b32 s37, s12, 2
    s_lshl_b32 s37, s37, 8
    s_and_b32 s38, s12, 3
    s_lshl_b32 s38, s38, 2
    s_add_u32 s37, s37, s38
    s_lshl_b32 s38, s12, 9
    s_sub_u32 s37, s37, s38
    s_add_u32 s37, s37, 16384
    v_add_u32 v13, s37, v13
    v_cndmask_b32 v6, v11, v13, s[40:41]
    s_add_u32 s17, s16, 4096
    s_add_u32 s18, s16, 8192
    s_add_u32 s19, s16, 12288
    s_lshl_b32 s37, s12, 16
    s_add_u32 s32, s37, 6291456
    s_lshl_b32 s38, s14, 10
    s_add_u32 s35, s27, s38
    s_add_u32 s35, s35, 2097152
    s_lshl_b32 s37, s12, 13
    s_add_u32 s33, s37, 9175040
    s_lshl_b32 s38, s14, 7
    s_add_u32 s36, s28, s38
    s_add_u32 s36, s36, 262144
    s_mul_i32 s37, s12, 77824
    s_add_u32 s34, s37, 11927552
    s_add_u32 s22, s21, 3648
    s_add_u32 s23, s21, 7296
    s_add_u32 s24, s21, 10944
    s_add_u32 s25, s21, 14592
    s_add_u32 s26, s21, 18240
    s_lshl_b32 s37, s13, 2
    s_add_u32 s37, s37, s14
    s_sub_i32 s31, s37, 8
    s_mul_i32 s37, s37, 36864
    s_lshl_b32 s38, s12, 9
    s_add_u32 s29, s37, s38
    s_add_u32 s29, s29, 14680064
    s_add_u32 s30, s29, 2359296
    s_lshl_b32 s74, s13, 2
    s_sub_i32 s74, s74, 8
    s_max_i32 s74, s74, 0
    s_mul_i32 s75, s74, 1216
    s_add_u32 s75, s75, s34
    s_lshl_b32 s76, s14, 10
    s_add_u32 s75, s75, s76
    s_add_u32 s76, s76, 49280
    s_mul_i32 s38, s14, 7680
    v_add_u32 v8, s38, v1
    s_load_dwordx2 s[48:49], s[0:1], 16
    s_load_dwordx2 s[50:51], s[0:1], 40
    s_lshl_b32 s62, s2, 2
    s_add_u32 s62, s62, s14
    s_mul_i32 s63, s62, 52429
    s_lshr_b32 s63, s63, 18
    s_mul_i32 s64, s63, 5
    s_sub_u32 s64, s62, s64
    s_mul_i32 s66, s63, 3641
    s_lshr_b32 s66, s66, 16
    s_mul_i32 s65, s66, 18
    s_sub_u32 s65, s63, s65
    s_mul_i32 s60, s63, 4608
    s_lshl_b32 s67, s64, 10
    s_add_u32 s60, s60, s67
    s_add_u32 s60, s60, 19922944
    v_and_b32 v9, 15, v0
    v_lshrrev_b32 v10, 4, v0
    s_lshl_b32 s67, s64, 4
    v_add_u32 v9, s67, v9
    v_cmp_gt_u32 vcc, 72, v9
    s_and_b32 s67, s66, 7
    s_mul_i32 s67, s67, 144
    v_lshl_add_u32 v9, v9, 1, s67
    v_lshrrev_b32 v11, 1, v10
    v_mul_u32_u24 v11, 18, v11
    v_and_b32 v12, 1, v10
    v_lshl_add_u32 v11, v12, 2, v11
    v_mul_u32_u24 v12, 72, v10
    s_cmp_lt_u32 s65, 16
    s_cselect_b64 s[68:69], -1, 0
    v_cndmask_b32 v11, v12, v11, s[68:69]
    s_mul_i32 s67, s65, 36
    s_sub_u32 s63, s65, 16
    s_mul_i32 s63, s63, 288
    s_add_u32 s63, s63, 16
    s_cmp_lt_u32 s65, 16
    s_cselect_b32 s67, s67, s63
    v_add_u32 v11, s67, v11
    v_mul_u32_u24 v11, 1152, v11
    v_add_u32 v9, v9, v11
    v_bfrev_b32 v10, 1
    s_cmp_lt_u32 s62, 1440
    s_cselect_b64 s[70:71], -1, 0
    s_and_b64 vcc, vcc, s[70:71]
    s_cmp_eq_u32 s64, 4
    s_cselect_b32 s67, 7, 8
    v_lshrrev_b32 v11, 4, v0
    v_lshlrev_b32 v11, s67, v11
    v_and_b32 v12, 15, v0
    v_lshl_add_u32 v11, v12, 4, v11
    v_cndmask_b32 v246, v10, v9, vcc
    v_cndmask_b32 v247, v10, v11, vcc
    s_mov_b32 s67, 0
    s_cmp_lt_u32 s65, 16
    s_cselect_b32 s52, 0, s67
    s_mov_b32 s67, 1152
    s_cmp_lt_u32 s65, 16
    s_cselect_b32 s53, 1152, s67
    s_mov_b32 s67, 20736
    s_cmp_lt_u32 s65, 16
    s_cselect_b32 s54, 2304, s67
    s_mov_b32 s67, 21888
    s_cmp_lt_u32 s65, 16
    s_cselect_b32 s55, 3456, s67
    s_mov_b32 s67, 41472
    s_cmp_lt_u32 s65, 16
    s_cselect_b32 s56, 9216, s67
    s_mov_b32 s67, 42624
    s_cmp_lt_u32 s65, 16
    s_cselect_b32 s57, 10368, s67
    s_mov_b32 s67, 62208
    s_cmp_lt_u32 s65, 16
    s_cselect_b32 s58, 11520, s67
    s_mov_b32 s67, 63360
    s_cmp_lt_u32 s65, 16
    s_cselect_b32 s59, 12672, s67
    s_waitcnt lgkmcnt(0)
    s_cmp_ge_u32 s66, 8
    s_cselect_b32 s48, s50, s48
    s_cselect_b32 s49, s51, s49
    s_and_b32 s49, s49, 0xffff
    s_mov_b32 s50, 663552
    s_mov_b32 s51, 0x00020000
    s_waitcnt vmcnt(8)
    v_mfma_f32_32x32x16_bf16 v[80:95], v[144:147], v[120:123], 0
    v_mfma_f32_32x32x8_bf16 v[80:95], v[148:149], v[124:125], v[80:95]
    s_nop 11
    s_setprio 3
    buffer_load_dwordx4 v[158:161], v1, s[8:11], s16 offen offset:1024
    buffer_load_dword v162, v2, s[8:11], s20 offen offset:128
    s_waitcnt vmcnt(8)
    v_mfma_f32_32x32x16_bf16 v[96:111], v[144:147], v[126:129], 0
    v_exp_f32 v80, v80
    v_exp_f32 v81, v81
    v_exp_f32 v82, v82
    v_exp_f32 v83, v83
    v_cvt_pk_bf16_f32 v112, v80, v81
    v_cvt_pk_bf16_f32 v113, v82, v83
    v_mfma_f32_32x32x8_bf16 v[96:111], v[148:149], v[130:131], v[96:111]
    v_exp_f32 v84, v84
    v_exp_f32 v85, v85
    v_exp_f32 v86, v86
    v_exp_f32 v87, v87
    v_cvt_pk_bf16_f32 v114, v84, v85
    v_cvt_pk_bf16_f32 v115, v86, v87
    v_exp_f32 v88, v88
    v_exp_f32 v89, v89
    v_exp_f32 v90, v90
    v_exp_f32 v91, v91
    v_cvt_pk_bf16_f32 v116, v88, v89
    v_cvt_pk_bf16_f32 v117, v90, v91
    s_waitcnt vmcnt(6)
    v_mfma_f32_32x32x16_bf16 v[16:31], v[150:153], v[112:115], 0
    v_exp_f32 v92, v92
    v_exp_f32 v93, v93
    v_exp_f32 v94, v94
    v_exp_f32 v95, v95
    v_cvt_pk_bf16_f32 v118, v92, v93
    v_cvt_pk_bf16_f32 v119, v94, v95
    buffer_load_dwordx4 v[164:167], v3, s[8:11], s21 offen offset:1216
    buffer_load_dwordx4 v[168:171], v3, s[8:11], s21 offen offset:1824
    s_waitcnt vmcnt(6)
    v_mfma_f32_32x32x16_bf16 v[80:95], v[144:147], v[132:135], 0
    v_exp_f32 v96, v96
    v_exp_f32 v97, v97
    v_exp_f32 v98, v98
    v_exp_f32 v99, v99
    v_cvt_pk_bf16_f32 v112, v96, v97
    v_cvt_pk_bf16_f32 v113, v98, v99
    v_mfma_f32_32x32x8_bf16 v[80:95], v[148:149], v[136:137], v[80:95]
    v_exp_f32 v100, v100
    v_exp_f32 v101, v101
    v_exp_f32 v102, v102
    v_exp_f32 v103, v103
    v_cvt_pk_bf16_f32 v114, v100, v101
    v_cvt_pk_bf16_f32 v115, v102, v103
    v_mfma_f32_32x32x16_bf16 v[16:31], v[154:157], v[116:119], v[16:31]
    v_exp_f32 v104, v104
    v_exp_f32 v105, v105
    v_exp_f32 v106, v106
    v_exp_f32 v107, v107
    v_cvt_pk_bf16_f32 v116, v104, v105
    v_cvt_pk_bf16_f32 v117, v106, v107
    v_mfma_f32_32x32x16_bf16 v[32:47], v[150:153], v[112:115], 0
    v_exp_f32 v108, v108
    v_exp_f32 v109, v109
    v_exp_f32 v110, v110
    v_exp_f32 v111, v111
    v_cvt_pk_bf16_f32 v118, v108, v109
    v_cvt_pk_bf16_f32 v119, v110, v111
    buffer_load_dwordx4 v[172:175], v1, s[8:11], s16 offen offset:2048
    buffer_load_dword v176, v2, s[8:11], s20 offen offset:256
    s_waitcnt vmcnt(6)
    v_mfma_f32_32x32x16_bf16 v[96:111], v[144:147], v[138:141], 0
    v_exp_f32 v80, v80
    v_exp_f32 v81, v81
    v_exp_f32 v82, v82
    v_exp_f32 v83, v83
    v_cvt_pk_bf16_f32 v112, v80, v81
    v_cvt_pk_bf16_f32 v113, v82, v83
    v_mfma_f32_32x32x8_bf16 v[96:111], v[148:149], v[142:143], v[96:111]
    v_exp_f32 v84, v84
    v_exp_f32 v85, v85
    v_exp_f32 v86, v86
    v_exp_f32 v87, v87
    v_cvt_pk_bf16_f32 v114, v84, v85
    v_cvt_pk_bf16_f32 v115, v86, v87
    v_mfma_f32_32x32x16_bf16 v[32:47], v[154:157], v[116:119], v[32:47]
    v_exp_f32 v88, v88
    v_exp_f32 v89, v89
    v_exp_f32 v90, v90
    v_exp_f32 v91, v91
    v_cvt_pk_bf16_f32 v116, v88, v89
    v_cvt_pk_bf16_f32 v117, v90, v91
    v_mfma_f32_32x32x16_bf16 v[48:63], v[150:153], v[112:115], 0
    v_exp_f32 v92, v92
    v_exp_f32 v93, v93
    v_exp_f32 v94, v94
    v_exp_f32 v95, v95
    v_cvt_pk_bf16_f32 v118, v92, v93
    v_cvt_pk_bf16_f32 v119, v94, v95
    buffer_load_dwordx4 v[178:181], v3, s[8:11], s21 offen offset:2432
    buffer_load_dwordx4 v[182:185], v3, s[8:11], s21 offen offset:3040
    buffer_load_dwordx4 v[144:147], v1, s[8:11], s16 offen offset:3072
    buffer_load_dword v148, v2, s[8:11], s20 offen offset:384
    s_waitcnt vmcnt(8)
    v_mfma_f32_32x32x16_bf16 v[80:95], v[158:161], v[120:123], 0
    v_exp_f32 v96, v96
    v_exp_f32 v97, v97
    v_exp_f32 v98, v98
    v_exp_f32 v99, v99
    v_cvt_pk_bf16_f32 v112, v96, v97
    v_cvt_pk_bf16_f32 v113, v98, v99
    v_mfma_f32_32x32x8_bf16 v[80:95], v[162:163], v[124:125], v[80:95]
    v_exp_f32 v100, v100
    v_exp_f32 v101, v101
    v_exp_f32 v102, v102
    v_exp_f32 v103, v103
    v_cvt_pk_bf16_f32 v114, v100, v101
    v_cvt_pk_bf16_f32 v115, v102, v103
    v_mfma_f32_32x32x16_bf16 v[48:63], v[154:157], v[116:119], v[48:63]
    v_exp_f32 v104, v104
    v_exp_f32 v105, v105
    v_exp_f32 v106, v106
    v_exp_f32 v107, v107
    v_cvt_pk_bf16_f32 v116, v104, v105
    v_cvt_pk_bf16_f32 v117, v106, v107
    v_mfma_f32_32x32x16_bf16 v[64:79], v[150:153], v[112:115], 0
    v_exp_f32 v108, v108
    v_exp_f32 v109, v109
    v_exp_f32 v110, v110
    v_exp_f32 v111, v111
    v_cvt_pk_bf16_f32 v118, v108, v109
    v_cvt_pk_bf16_f32 v119, v110, v111
    buffer_load_ushort v234, v246, s[48:51], s52 offen
    buffer_load_ushort v235, v246, s[48:51], s53 offen
    buffer_load_ushort v236, v246, s[48:51], s54 offen
    buffer_load_ushort v237, v246, s[48:51], s55 offen
    buffer_load_ushort v238, v246, s[48:51], s56 offen
    buffer_load_ushort v239, v246, s[48:51], s57 offen
    buffer_load_ushort v240, v246, s[48:51], s58 offen
    buffer_load_ushort v241, v246, s[48:51], s59 offen
    v_mfma_f32_32x32x16_bf16 v[96:111], v[158:161], v[126:129], 0
    v_exp_f32 v80, v80
    v_exp_f32 v81, v81
    v_exp_f32 v82, v82
    v_exp_f32 v83, v83
    v_cvt_pk_bf16_f32 v112, v80, v81
    v_cvt_pk_bf16_f32 v113, v82, v83
    v_mfma_f32_32x32x8_bf16 v[96:111], v[162:163], v[130:131], v[96:111]
    v_exp_f32 v84, v84
    v_exp_f32 v85, v85
    v_exp_f32 v86, v86
    v_exp_f32 v87, v87
    v_cvt_pk_bf16_f32 v114, v84, v85
    v_cvt_pk_bf16_f32 v115, v86, v87
    v_mfma_f32_32x32x16_bf16 v[64:79], v[154:157], v[116:119], v[64:79]
    v_exp_f32 v88, v88
    v_exp_f32 v89, v89
    v_exp_f32 v90, v90
    v_exp_f32 v91, v91
    v_cvt_pk_bf16_f32 v116, v88, v89
    v_cvt_pk_bf16_f32 v117, v90, v91
    s_waitcnt vmcnt(14)
    v_mfma_f32_32x32x16_bf16 v[16:31], v[164:167], v[112:115], v[16:31]
    v_exp_f32 v92, v92
    v_exp_f32 v93, v93
    v_exp_f32 v94, v94
    v_exp_f32 v95, v95
    v_cvt_pk_bf16_f32 v118, v92, v93
    v_cvt_pk_bf16_f32 v119, v94, v95
    buffer_load_dwordx4 v[150:153], v3, s[8:11], s22 offen offset:0
    buffer_load_dwordx4 v[154:157], v3, s[8:11], s22 offen offset:608
    v_mfma_f32_32x32x16_bf16 v[80:95], v[158:161], v[132:135], 0
    v_exp_f32 v96, v96
    v_exp_f32 v97, v97
    v_exp_f32 v98, v98
    v_exp_f32 v99, v99
    v_cvt_pk_bf16_f32 v112, v96, v97
    v_cvt_pk_bf16_f32 v113, v98, v99
    v_mfma_f32_32x32x8_bf16 v[80:95], v[162:163], v[136:137], v[80:95]
    v_exp_f32 v100, v100
    v_exp_f32 v101, v101
    v_exp_f32 v102, v102
    v_exp_f32 v103, v103
    v_cvt_pk_bf16_f32 v114, v100, v101
    v_cvt_pk_bf16_f32 v115, v102, v103
    v_mfma_f32_32x32x16_bf16 v[16:31], v[168:171], v[116:119], v[16:31]
    v_exp_f32 v104, v104
    v_exp_f32 v105, v105
    v_exp_f32 v106, v106
    v_exp_f32 v107, v107
    v_cvt_pk_bf16_f32 v116, v104, v105
    v_cvt_pk_bf16_f32 v117, v106, v107
    v_mfma_f32_32x32x16_bf16 v[32:47], v[164:167], v[112:115], v[32:47]
    v_exp_f32 v108, v108
    v_exp_f32 v109, v109
    v_exp_f32 v110, v110
    v_exp_f32 v111, v111
    v_cvt_pk_bf16_f32 v118, v108, v109
    v_cvt_pk_bf16_f32 v119, v110, v111
    v_mfma_f32_32x32x16_bf16 v[96:111], v[158:161], v[138:141], 0
    v_exp_f32 v80, v80
    v_exp_f32 v81, v81
    v_exp_f32 v82, v82
    v_exp_f32 v83, v83
    v_cvt_pk_bf16_f32 v112, v80, v81
    v_cvt_pk_bf16_f32 v113, v82, v83
    v_mfma_f32_32x32x8_bf16 v[96:111], v[162:163], v[142:143], v[96:111]
    v_exp_f32 v84, v84
    v_exp_f32 v85, v85
    v_exp_f32 v86, v86
    v_exp_f32 v87, v87
    v_cvt_pk_bf16_f32 v114, v84, v85
    v_cvt_pk_bf16_f32 v115, v86, v87
    v_mfma_f32_32x32x16_bf16 v[32:47], v[168:171], v[116:119], v[32:47]
    v_exp_f32 v88, v88
    v_exp_f32 v89, v89
    v_exp_f32 v90, v90
    v_exp_f32 v91, v91
    v_cvt_pk_bf16_f32 v116, v88, v89
    v_cvt_pk_bf16_f32 v117, v90, v91
    v_mfma_f32_32x32x16_bf16 v[48:63], v[164:167], v[112:115], v[48:63]
    v_exp_f32 v92, v92
    v_exp_f32 v93, v93
    v_exp_f32 v94, v94
    v_exp_f32 v95, v95
    v_cvt_pk_bf16_f32 v118, v92, v93
    v_cvt_pk_bf16_f32 v119, v94, v95
    buffer_load_dwordx4 v[158:161], v1, s[8:11], s17 offen offset:0
    buffer_load_dword v162, v2, s[8:11], s20 offen offset:512
    s_waitcnt vmcnt(16)
    v_mfma_f32_32x32x16_bf16 v[80:95], v[172:175], v[120:123], 0
    v_exp_f32 v96, v96
    v_exp_f32 v97, v97
    v_exp_f32 v98, v98
    v_exp_f32 v99, v99
    v_cvt_pk_bf16_f32 v112, v96, v97
    v_cvt_pk_bf16_f32 v113, v98, v99
    v_mfma_f32_32x32x8_bf16 v[80:95], v[176:177], v[124:125], v[80:95]
    v_exp_f32 v100, v100
    v_exp_f32 v101, v101
    v_exp_f32 v102, v102
    v_exp_f32 v103, v103
    v_cvt_pk_bf16_f32 v114, v100, v101
    v_cvt_pk_bf16_f32 v115, v102, v103
    v_mfma_f32_32x32x16_bf16 v[48:63], v[168:171], v[116:119], v[48:63]
    v_exp_f32 v104, v104
    v_exp_f32 v105, v105
    v_exp_f32 v106, v106
    v_exp_f32 v107, v107
    v_cvt_pk_bf16_f32 v116, v104, v105
    v_cvt_pk_bf16_f32 v117, v106, v107
    v_mfma_f32_32x32x16_bf16 v[64:79], v[164:167], v[112:115], v[64:79]
    v_exp_f32 v108, v108
    v_exp_f32 v109, v109
    v_exp_f32 v110, v110
    v_exp_f32 v111, v111
    v_cvt_pk_bf16_f32 v118, v108, v109
    v_cvt_pk_bf16_f32 v119, v110, v111
    v_mfma_f32_32x32x16_bf16 v[96:111], v[172:175], v[126:129], 0
    v_exp_f32 v80, v80
    v_exp_f32 v81, v81
    v_exp_f32 v82, v82
    v_exp_f32 v83, v83
    v_cvt_pk_bf16_f32 v112, v80, v81
    v_cvt_pk_bf16_f32 v113, v82, v83
    v_mfma_f32_32x32x8_bf16 v[96:111], v[176:177], v[130:131], v[96:111]
    v_exp_f32 v84, v84
    v_exp_f32 v85, v85
    v_exp_f32 v86, v86
    v_exp_f32 v87, v87
    v_cvt_pk_bf16_f32 v114, v84, v85
    v_cvt_pk_bf16_f32 v115, v86, v87
    v_mfma_f32_32x32x16_bf16 v[64:79], v[168:171], v[116:119], v[64:79]
    v_exp_f32 v88, v88
    v_exp_f32 v89, v89
    v_exp_f32 v90, v90
    v_exp_f32 v91, v91
    v_cvt_pk_bf16_f32 v116, v88, v89
    v_cvt_pk_bf16_f32 v117, v90, v91
    s_waitcnt vmcnt(14)
    v_mfma_f32_32x32x16_bf16 v[16:31], v[178:181], v[112:115], v[16:31]
    v_exp_f32 v92, v92
    v_exp_f32 v93, v93
    v_exp_f32 v94, v94
    v_exp_f32 v95, v95
    v_cvt_pk_bf16_f32 v118, v92, v93
    v_cvt_pk_bf16_f32 v119, v94, v95
    buffer_load_dwordx4 v[164:167], v3, s[8:11], s22 offen offset:1216
    buffer_load_dwordx4 v[168:171], v3, s[8:11], s22 offen offset:1824
    v_mfma_f32_32x32x16_bf16 v[80:95], v[172:175], v[132:135], 0
    v_exp_f32 v96, v96
    v_exp_f32 v97, v97
    v_exp_f32 v98, v98
    v_exp_f32 v99, v99
    v_cvt_pk_bf16_f32 v112, v96, v97
    v_cvt_pk_bf16_f32 v113, v98, v99
    v_mfma_f32_32x32x8_bf16 v[80:95], v[176:177], v[136:137], v[80:95]
    v_exp_f32 v100, v100
    v_exp_f32 v101, v101
    v_exp_f32 v102, v102
    v_exp_f32 v103, v103
    v_cvt_pk_bf16_f32 v114, v100, v101
    v_cvt_pk_bf16_f32 v115, v102, v103
    v_mfma_f32_32x32x16_bf16 v[16:31], v[182:185], v[116:119], v[16:31]
    v_exp_f32 v104, v104
    v_exp_f32 v105, v105
    v_exp_f32 v106, v106
    v_exp_f32 v107, v107
    v_cvt_pk_bf16_f32 v116, v104, v105
    v_cvt_pk_bf16_f32 v117, v106, v107
    v_mfma_f32_32x32x16_bf16 v[32:47], v[178:181], v[112:115], v[32:47]
    v_exp_f32 v108, v108
    v_exp_f32 v109, v109
    v_exp_f32 v110, v110
    v_exp_f32 v111, v111
    v_cvt_pk_bf16_f32 v118, v108, v109
    v_cvt_pk_bf16_f32 v119, v110, v111
    v_mfma_f32_32x32x16_bf16 v[96:111], v[172:175], v[138:141], 0
    v_exp_f32 v80, v80
    v_exp_f32 v81, v81
    v_exp_f32 v82, v82
    v_exp_f32 v83, v83
    v_cvt_pk_bf16_f32 v112, v80, v81
    v_cvt_pk_bf16_f32 v113, v82, v83
    v_mfma_f32_32x32x8_bf16 v[96:111], v[176:177], v[142:143], v[96:111]
    v_exp_f32 v84, v84
    v_exp_f32 v85, v85
    v_exp_f32 v86, v86
    v_exp_f32 v87, v87
    v_cvt_pk_bf16_f32 v114, v84, v85
    v_cvt_pk_bf16_f32 v115, v86, v87
    v_mfma_f32_32x32x16_bf16 v[32:47], v[182:185], v[116:119], v[32:47]
    v_exp_f32 v88, v88
    v_exp_f32 v89, v89
    v_exp_f32 v90, v90
    v_exp_f32 v91, v91
    v_cvt_pk_bf16_f32 v116, v88, v89
    v_cvt_pk_bf16_f32 v117, v90, v91
    v_mfma_f32_32x32x16_bf16 v[48:63], v[178:181], v[112:115], v[48:63]
    v_exp_f32 v92, v92
    v_exp_f32 v93, v93
    v_exp_f32 v94, v94
    v_exp_f32 v95, v95
    v_cvt_pk_bf16_f32 v118, v92, v93
    v_cvt_pk_bf16_f32 v119, v94, v95
    buffer_load_dwordx4 v[172:175], v1, s[8:11], s17 offen offset:1024
    buffer_load_dword v176, v2, s[8:11], s20 offen offset:640
    s_waitcnt vmcnt(16)
    v_mfma_f32_32x32x16_bf16 v[80:95], v[144:147], v[120:123], 0
    v_exp_f32 v96, v96
    v_exp_f32 v97, v97
    v_exp_f32 v98, v98
    v_exp_f32 v99, v99
    v_cvt_pk_bf16_f32 v112, v96, v97
    v_cvt_pk_bf16_f32 v113, v98, v99
    v_mfma_f32_32x32x8_bf16 v[80:95], v[148:149], v[124:125], v[80:95]
    v_exp_f32 v100, v100
    v_exp_f32 v101, v101
    v_exp_f32 v102, v102
    v_exp_f32 v103, v103
    v_cvt_pk_bf16_f32 v114, v100, v101
    v_cvt_pk_bf16_f32 v115, v102, v103
    v_mfma_f32_32x32x16_bf16 v[48:63], v[182:185], v[116:119], v[48:63]
    v_exp_f32 v104, v104
    v_exp_f32 v105, v105
    v_exp_f32 v106, v106
    v_exp_f32 v107, v107
    v_cvt_pk_bf16_f32 v116, v104, v105
    v_cvt_pk_bf16_f32 v117, v106, v107
    v_mfma_f32_32x32x16_bf16 v[64:79], v[178:181], v[112:115], v[64:79]
    v_exp_f32 v108, v108
    v_exp_f32 v109, v109
    v_exp_f32 v110, v110
    v_exp_f32 v111, v111
    v_cvt_pk_bf16_f32 v118, v108, v109
    v_cvt_pk_bf16_f32 v119, v110, v111
    v_mfma_f32_32x32x16_bf16 v[96:111], v[144:147], v[126:129], 0
    v_exp_f32 v80, v80
    v_exp_f32 v81, v81
    v_exp_f32 v82, v82
    v_exp_f32 v83, v83
    v_cvt_pk_bf16_f32 v112, v80, v81
    v_cvt_pk_bf16_f32 v113, v82, v83
    v_mfma_f32_32x32x8_bf16 v[96:111], v[148:149], v[130:131], v[96:111]
    v_exp_f32 v84, v84
    v_exp_f32 v85, v85
    v_exp_f32 v86, v86
    v_exp_f32 v87, v87
    v_cvt_pk_bf16_f32 v114, v84, v85
    v_cvt_pk_bf16_f32 v115, v86, v87
    v_mfma_f32_32x32x16_bf16 v[64:79], v[182:185], v[116:119], v[64:79]
    v_exp_f32 v88, v88
    v_exp_f32 v89, v89
    v_exp_f32 v90, v90
    v_exp_f32 v91, v91
    v_cvt_pk_bf16_f32 v116, v88, v89
    v_cvt_pk_bf16_f32 v117, v90, v91
    s_waitcnt vmcnt(6)
    v_mfma_f32_32x32x16_bf16 v[16:31], v[150:153], v[112:115], v[16:31]
    v_exp_f32 v92, v92
    v_exp_f32 v93, v93
    v_exp_f32 v94, v94
    v_exp_f32 v95, v95
    v_cvt_pk_bf16_f32 v118, v92, v93
    v_cvt_pk_bf16_f32 v119, v94, v95
    buffer_load_dwordx4 v[178:181], v3, s[8:11], s22 offen offset:2432
    buffer_load_dwordx4 v[182:185], v3, s[8:11], s22 offen offset:3040
    v_mfma_f32_32x32x16_bf16 v[80:95], v[144:147], v[132:135], 0
    v_exp_f32 v96, v96
    v_exp_f32 v97, v97
    v_exp_f32 v98, v98
    v_exp_f32 v99, v99
    v_cvt_pk_bf16_f32 v112, v96, v97
    v_cvt_pk_bf16_f32 v113, v98, v99
    v_mfma_f32_32x32x8_bf16 v[80:95], v[148:149], v[136:137], v[80:95]
    v_exp_f32 v100, v100
    v_exp_f32 v101, v101
    v_exp_f32 v102, v102
    v_exp_f32 v103, v103
    v_cvt_pk_bf16_f32 v114, v100, v101
    v_cvt_pk_bf16_f32 v115, v102, v103
    v_mfma_f32_32x32x16_bf16 v[16:31], v[154:157], v[116:119], v[16:31]
    v_exp_f32 v104, v104
    v_exp_f32 v105, v105
    v_exp_f32 v106, v106
    v_exp_f32 v107, v107
    v_cvt_pk_bf16_f32 v116, v104, v105
    v_cvt_pk_bf16_f32 v117, v106, v107
    v_mfma_f32_32x32x16_bf16 v[32:47], v[150:153], v[112:115], v[32:47]
    v_exp_f32 v108, v108
    v_exp_f32 v109, v109
    v_exp_f32 v110, v110
    v_exp_f32 v111, v111
    v_cvt_pk_bf16_f32 v118, v108, v109
    v_cvt_pk_bf16_f32 v119, v110, v111
    v_mfma_f32_32x32x16_bf16 v[96:111], v[144:147], v[138:141], 0
    v_exp_f32 v80, v80
    v_exp_f32 v81, v81
    v_exp_f32 v82, v82
    v_exp_f32 v83, v83
    v_cvt_pk_bf16_f32 v112, v80, v81
    v_cvt_pk_bf16_f32 v113, v82, v83
    v_mfma_f32_32x32x8_bf16 v[96:111], v[148:149], v[142:143], v[96:111]
    v_exp_f32 v84, v84
    v_exp_f32 v85, v85
    v_exp_f32 v86, v86
    v_exp_f32 v87, v87
    v_cvt_pk_bf16_f32 v114, v84, v85
    v_cvt_pk_bf16_f32 v115, v86, v87
    v_mfma_f32_32x32x16_bf16 v[32:47], v[154:157], v[116:119], v[32:47]
    v_exp_f32 v88, v88
    v_exp_f32 v89, v89
    v_exp_f32 v90, v90
    v_exp_f32 v91, v91
    v_cvt_pk_bf16_f32 v116, v88, v89
    v_cvt_pk_bf16_f32 v117, v90, v91
    v_mfma_f32_32x32x16_bf16 v[48:63], v[150:153], v[112:115], v[48:63]
    v_exp_f32 v92, v92
    v_exp_f32 v93, v93
    v_exp_f32 v94, v94
    v_exp_f32 v95, v95
    v_cvt_pk_bf16_f32 v118, v92, v93
    v_cvt_pk_bf16_f32 v119, v94, v95
    buffer_load_dwordx4 v[144:147], v1, s[8:11], s17 offen offset:2048
    buffer_load_dword v148, v2, s[8:11], s20 offen offset:768
    s_waitcnt vmcnt(8)
    v_mfma_f32_32x32x16_bf16 v[80:95], v[158:161], v[120:123], 0
    v_exp_f32 v96, v96
    v_exp_f32 v97, v97
    v_exp_f32 v98, v98
    v_exp_f32 v99, v99
    v_cvt_pk_bf16_f32 v112, v96, v97
    v_cvt_pk_bf16_f32 v113, v98, v99
    v_mfma_f32_32x32x8_bf16 v[80:95], v[162:163], v[124:125], v[80:95]
    v_exp_f32 v100, v100
    v_exp_f32 v101, v101
    v_exp_f32 v102, v102
    v_exp_f32 v103, v103
    v_cvt_pk_bf16_f32 v114, v100, v101
    v_cvt_pk_bf16_f32 v115, v102, v103
    v_mfma_f32_32x32x16_bf16 v[48:63], v[154:157], v[116:119], v[48:63]
    v_exp_f32 v104, v104
    v_exp_f32 v105, v105
    v_exp_f32 v106, v106
    v_exp_f32 v107, v107
    v_cvt_pk_bf16_f32 v116, v104, v105
    v_cvt_pk_bf16_f32 v117, v106, v107
    v_mfma_f32_32x32x16_bf16 v[64:79], v[150:153], v[112:115], v[64:79]
    v_exp_f32 v108, v108
    v_exp_f32 v109, v109
    v_exp_f32 v110, v110
    v_exp_f32 v111, v111
    v_cvt_pk_bf16_f32 v118, v108, v109
    v_cvt_pk_bf16_f32 v119, v110, v111
    v_mfma_f32_32x32x16_bf16 v[96:111], v[158:161], v[126:129], 0
    v_exp_f32 v80, v80
    v_exp_f32 v81, v81
    v_exp_f32 v82, v82
    v_exp_f32 v83, v83
    v_cvt_pk_bf16_f32 v112, v80, v81
    v_cvt_pk_bf16_f32 v113, v82, v83
    v_mfma_f32_32x32x8_bf16 v[96:111], v[162:163], v[130:131], v[96:111]
    v_exp_f32 v84, v84
    v_exp_f32 v85, v85
    v_exp_f32 v86, v86
    v_exp_f32 v87, v87
    v_cvt_pk_bf16_f32 v114, v84, v85
    v_cvt_pk_bf16_f32 v115, v86, v87
    v_mfma_f32_32x32x16_bf16 v[64:79], v[154:157], v[116:119], v[64:79]
    v_exp_f32 v88, v88
    v_exp_f32 v89, v89
    v_exp_f32 v90, v90
    v_exp_f32 v91, v91
    v_cvt_pk_bf16_f32 v116, v88, v89
    v_cvt_pk_bf16_f32 v117, v90, v91
    s_waitcnt vmcnt(6)
    v_mfma_f32_32x32x16_bf16 v[16:31], v[164:167], v[112:115], v[16:31]
    v_exp_f32 v92, v92
    v_exp_f32 v93, v93
    v_exp_f32 v94, v94
    v_exp_f32 v95, v95
    v_cvt_pk_bf16_f32 v118, v92, v93
    v_cvt_pk_bf16_f32 v119, v94, v95
    s_waitcnt vmcnt(12)
    v_lshl_or_b32 v242, v235, 16, v234
    v_lshl_or_b32 v243, v237, 16, v236
    v_lshl_or_b32 v244, v239, 16, v238
    v_lshl_or_b32 v245, v241, 16, v240
    buffer_store_dwordx4 v[242:245], v247, s[8:11], s60 offen sc1
    buffer_load_dwordx4 v[150:153], v3, s[8:11], s23 offen offset:0
    buffer_load_dwordx4 v[154:157], v3, s[8:11], s23 offen offset:608
    v_mfma_f32_32x32x16_bf16 v[80:95], v[158:161], v[132:135], 0
    v_exp_f32 v96, v96
    v_exp_f32 v97, v97
    v_exp_f32 v98, v98
    v_exp_f32 v99, v99
    v_cvt_pk_bf16_f32 v112, v96, v97
    v_cvt_pk_bf16_f32 v113, v98, v99
    v_mfma_f32_32x32x8_bf16 v[80:95], v[162:163], v[136:137], v[80:95]
    v_exp_f32 v100, v100
    v_exp_f32 v101, v101
    v_exp_f32 v102, v102
    v_exp_f32 v103, v103
    v_cvt_pk_bf16_f32 v114, v100, v101
    v_cvt_pk_bf16_f32 v115, v102, v103
    v_mfma_f32_32x32x16_bf16 v[16:31], v[168:171], v[116:119], v[16:31]
    v_exp_f32 v104, v104
    v_exp_f32 v105, v105
    v_exp_f32 v106, v106
    v_exp_f32 v107, v107
    v_cvt_pk_bf16_f32 v116, v104, v105
    v_cvt_pk_bf16_f32 v117, v106, v107
    v_mfma_f32_32x32x16_bf16 v[32:47], v[164:167], v[112:115], v[32:47]
    v_exp_f32 v108, v108
    v_exp_f32 v109, v109
    v_exp_f32 v110, v110
    v_exp_f32 v111, v111
    v_cvt_pk_bf16_f32 v118, v108, v109
    v_cvt_pk_bf16_f32 v119, v110, v111
    s_add_i32 s37, s31, 0
    s_max_i32 s37, s37, 0
    s_lshl_b32 s38, s37, 10
    s_add_u32 s38, s38, s32
    buffer_load_dwordx4 v[192:195], v1, s[8:11], s38 offen
    s_lshl_b32 s38, s37, 7
    s_add_u32 s38, s38, s33
    buffer_load_dword v196, v2, s[8:11], s38 offen
    v_mfma_f32_32x32x16_bf16 v[96:111], v[158:161], v[138:141], 0
    v_exp_f32 v80, v80
    v_exp_f32 v81, v81
    v_exp_f32 v82, v82
    v_exp_f32 v83, v83
    v_cvt_pk_bf16_f32 v112, v80, v81
    v_cvt_pk_bf16_f32 v113, v82, v83
    v_mfma_f32_32x32x8_bf16 v[96:111], v[162:163], v[142:143], v[96:111]
    v_exp_f32 v84, v84
    v_exp_f32 v85, v85
    v_exp_f32 v86, v86
    v_exp_f32 v87, v87
    v_cvt_pk_bf16_f32 v114, v84, v85
    v_cvt_pk_bf16_f32 v115, v86, v87
    v_mfma_f32_32x32x16_bf16 v[32:47], v[168:171], v[116:119], v[32:47]
    v_exp_f32 v88, v88
    v_exp_f32 v89, v89
    v_exp_f32 v90, v90
    v_exp_f32 v91, v91
    v_cvt_pk_bf16_f32 v116, v88, v89
    v_cvt_pk_bf16_f32 v117, v90, v91
    v_mfma_f32_32x32x16_bf16 v[48:63], v[164:167], v[112:115], v[48:63]
    v_exp_f32 v92, v92
    v_exp_f32 v93, v93
    v_exp_f32 v94, v94
    v_exp_f32 v95, v95
    v_cvt_pk_bf16_f32 v118, v92, v93
    v_cvt_pk_bf16_f32 v119, v94, v95
    buffer_load_dwordx4 v[158:161], v1, s[8:11], s17 offen offset:3072
    buffer_load_dword v162, v2, s[8:11], s20 offen offset:896
    s_waitcnt vmcnt(11)
    v_mfma_f32_32x32x16_bf16 v[80:95], v[172:175], v[120:123], 0
    v_exp_f32 v96, v96
    v_exp_f32 v97, v97
    v_exp_f32 v98, v98
    v_exp_f32 v99, v99
    v_cvt_pk_bf16_f32 v112, v96, v97
    v_cvt_pk_bf16_f32 v113, v98, v99
    v_mfma_f32_32x32x8_bf16 v[80:95], v[176:177], v[124:125], v[80:95]
    v_exp_f32 v100, v100
    v_exp_f32 v101, v101
    v_exp_f32 v102, v102
    v_exp_f32 v103, v103
    v_cvt_pk_bf16_f32 v114, v100, v101
    v_cvt_pk_bf16_f32 v115, v102, v103
    v_mfma_f32_32x32x16_bf16 v[48:63], v[168:171], v[116:119], v[48:63]
    v_exp_f32 v104, v104
    v_exp_f32 v105, v105
    v_exp_f32 v106, v106
    v_exp_f32 v107, v107
    v_cvt_pk_bf16_f32 v116, v104, v105
    v_cvt_pk_bf16_f32 v117, v106, v107
    v_mfma_f32_32x32x16_bf16 v[64:79], v[164:167], v[112:115], v[64:79]
    v_exp_f32 v108, v108
    v_exp_f32 v109, v109
    v_exp_f32 v110, v110
    v_exp_f32 v111, v111
    v_cvt_pk_bf16_f32 v118, v108, v109
    v_cvt_pk_bf16_f32 v119, v110, v111
    s_mov_b32 s40, 0xffffffff
    s_mov_b32 s41, 0xffffff00
    v_mfma_f32_32x32x16_bf16 v[96:111], v[172:175], v[126:129], 0
    v_exp_f32 v80, v80
    v_exp_f32 v81, v81
    v_exp_f32 v82, v82
    v_exp_f32 v83, v83
    v_cvt_pk_bf16_f32 v112, v80, v81
    v_cvt_pk_bf16_f32 v113, v82, v83
    v_mfma_f32_32x32x8_bf16 v[96:111], v[176:177], v[130:131], v[96:111]
    v_exp_f32 v84, v84
    v_exp_f32 v85, v85
    v_exp_f32 v86, v86
    v_exp_f32 v87, v87
    v_cvt_pk_bf16_f32 v114, v84, v85
    v_cvt_pk_bf16_f32 v115, v86, v87
    v_mfma_f32_32x32x16_bf16 v[64:79], v[168:171], v[116:119], v[64:79]
    v_exp_f32 v88, v88
    v_exp_f32 v89, v89
    v_exp_f32 v90, v90
    v_exp_f32 v91, v91
    v_cvt_pk_bf16_f32 v116, v88, v89
    v_cvt_pk_bf16_f32 v117, v90, v91
    s_waitcnt vmcnt(9)
    v_mfma_f32_32x32x16_bf16 v[16:31], v[178:181], v[112:115], v[16:31]
    v_exp_f32 v92, v92
    v_exp_f32 v93, v93
    v_exp_f32 v94, v94
    v_exp_f32 v95, v95
    v_cvt_pk_bf16_f32 v118, v92, v93
    v_cvt_pk_bf16_f32 v119, v94, v95
    buffer_load_dwordx4 v[164:167], v3, s[8:11], s23 offen offset:1216
    buffer_load_dwordx4 v[168:171], v3, s[8:11], s23 offen offset:1824
    s_mov_b32 s42, 0xfffffffe
    s_mov_b32 s43, 0xfffffe00
    v_mfma_f32_32x32x16_bf16 v[80:95], v[172:175], v[132:135], 0
    v_exp_f32 v96, v96
    v_exp_f32 v97, v97
    v_exp_f32 v98, v98
    v_exp_f32 v99, v99
    v_cvt_pk_bf16_f32 v112, v96, v97
    v_cvt_pk_bf16_f32 v113, v98, v99
    v_mfma_f32_32x32x8_bf16 v[80:95], v[176:177], v[136:137], v[80:95]
    v_exp_f32 v100, v100
    v_exp_f32 v101, v101
    v_exp_f32 v102, v102
    v_exp_f32 v103, v103
    v_cvt_pk_bf16_f32 v114, v100, v101
    v_cvt_pk_bf16_f32 v115, v102, v103
    v_mfma_f32_32x32x16_bf16 v[16:31], v[182:185], v[116:119], v[16:31]
    v_exp_f32 v104, v104
    v_exp_f32 v105, v105
    v_exp_f32 v106, v106
    v_exp_f32 v107, v107
    v_cvt_pk_bf16_f32 v116, v104, v105
    v_cvt_pk_bf16_f32 v117, v106, v107
    v_mfma_f32_32x32x16_bf16 v[32:47], v[178:181], v[112:115], v[32:47]
    v_exp_f32 v108, v108
    v_exp_f32 v109, v109
    v_exp_f32 v110, v110
    v_exp_f32 v111, v111
    v_cvt_pk_bf16_f32 v118, v108, v109
    v_cvt_pk_bf16_f32 v119, v110, v111
    s_add_i32 s37, s31, 1
    s_max_i32 s37, s37, 0
    s_lshl_b32 s38, s37, 10
    s_add_u32 s38, s38, s32
    buffer_load_dwordx4 v[198:201], v1, s[8:11], s38 offen
    s_lshl_b32 s38, s37, 7
    s_add_u32 s38, s38, s33
    buffer_load_dword v202, v2, s[8:11], s38 offen
    s_mov_b32 s44, 0xfffffffc
    s_mov_b32 s45, 0xfffffc00
    v_mfma_f32_32x32x16_bf16 v[96:111], v[172:175], v[138:141], 0
    v_exp_f32 v80, v80
    v_exp_f32 v81, v81
    v_exp_f32 v82, v82
    v_exp_f32 v83, v83
    v_cvt_pk_bf16_f32 v112, v80, v81
    v_cvt_pk_bf16_f32 v113, v82, v83
    v_mfma_f32_32x32x8_bf16 v[96:111], v[176:177], v[142:143], v[96:111]
    v_exp_f32 v84, v84
    v_exp_f32 v85, v85
    v_exp_f32 v86, v86
    v_exp_f32 v87, v87
    v_cvt_pk_bf16_f32 v114, v84, v85
    v_cvt_pk_bf16_f32 v115, v86, v87
    v_mfma_f32_32x32x16_bf16 v[32:47], v[182:185], v[116:119], v[32:47]
    v_exp_f32 v88, v88
    v_exp_f32 v89, v89
    v_exp_f32 v90, v90
    v_exp_f32 v91, v91
    v_cvt_pk_bf16_f32 v116, v88, v89
    v_cvt_pk_bf16_f32 v117, v90, v91
    v_mfma_f32_32x32x16_bf16 v[48:63], v[178:181], v[112:115], v[48:63]
    v_exp_f32 v92, v92
    v_exp_f32 v93, v93
    v_exp_f32 v94, v94
    v_exp_f32 v95, v95
    v_cvt_pk_bf16_f32 v118, v92, v93
    v_cvt_pk_bf16_f32 v119, v94, v95
    buffer_load_dwordx4 v[172:175], v1, s[8:11], s18 offen offset:0
    buffer_load_dword v176, v2, s[8:11], s20 offen offset:1024
    s_mov_b32 s46, 0xfffffff8
    s_mov_b32 s47, 0xfffff800
    s_waitcnt vmcnt(13)
    v_mfma_f32_32x32x16_bf16 v[80:95], v[144:147], v[120:123], 0
    v_exp_f32 v96, v96
    v_exp_f32 v97, v97
    v_exp_f32 v98, v98
    v_exp_f32 v99, v99
    v_cvt_pk_bf16_f32 v112, v96, v97
    v_cvt_pk_bf16_f32 v113, v98, v99
    v_mfma_f32_32x32x8_bf16 v[80:95], v[148:149], v[124:125], v[80:95]
    v_exp_f32 v100, v100
    v_exp_f32 v101, v101
    v_exp_f32 v102, v102
    v_exp_f32 v103, v103
    v_cvt_pk_bf16_f32 v114, v100, v101
    v_cvt_pk_bf16_f32 v115, v102, v103
    v_mfma_f32_32x32x16_bf16 v[48:63], v[182:185], v[116:119], v[48:63]
    v_exp_f32 v104, v104
    v_exp_f32 v105, v105
    v_exp_f32 v106, v106
    v_exp_f32 v107, v107
    v_cvt_pk_bf16_f32 v116, v104, v105
    v_cvt_pk_bf16_f32 v117, v106, v107
    v_mfma_f32_32x32x16_bf16 v[64:79], v[178:181], v[112:115], v[64:79]
    v_exp_f32 v108, v108
    v_exp_f32 v109, v109
    v_exp_f32 v110, v110
    v_exp_f32 v111, v111
    v_cvt_pk_bf16_f32 v118, v108, v109
    v_cvt_pk_bf16_f32 v119, v110, v111
    s_mov_b32 s48, 0xfffffff0
    s_mov_b32 s49, 0xfffff000
    v_mfma_f32_32x32x16_bf16 v[96:111], v[144:147], v[126:129], 0
    v_exp_f32 v80, v80
    v_exp_f32 v81, v81
    v_exp_f32 v82, v82
    v_exp_f32 v83, v83
    v_cvt_pk_bf16_f32 v112, v80, v81
    v_cvt_pk_bf16_f32 v113, v82, v83
    v_mfma_f32_32x32x8_bf16 v[96:111], v[148:149], v[130:131], v[96:111]
    v_exp_f32 v84, v84
    v_exp_f32 v85, v85
    v_exp_f32 v86, v86
    v_exp_f32 v87, v87
    v_cvt_pk_bf16_f32 v114, v84, v85
    v_cvt_pk_bf16_f32 v115, v86, v87
    v_mfma_f32_32x32x16_bf16 v[64:79], v[182:185], v[116:119], v[64:79]
    v_exp_f32 v88, v88
    v_exp_f32 v89, v89
    v_exp_f32 v90, v90
    v_exp_f32 v91, v91
    v_cvt_pk_bf16_f32 v116, v88, v89
    v_cvt_pk_bf16_f32 v117, v90, v91
    s_waitcnt vmcnt(10)
    v_mfma_f32_32x32x16_bf16 v[16:31], v[150:153], v[112:115], v[16:31]
    v_exp_f32 v92, v92
    v_exp_f32 v93, v93
    v_exp_f32 v94, v94
    v_exp_f32 v95, v95
    v_cvt_pk_bf16_f32 v118, v92, v93
    v_cvt_pk_bf16_f32 v119, v94, v95
    buffer_load_dwordx4 v[178:181], v3, s[8:11], s23 offen offset:2432
    buffer_load_dwordx4 v[182:185], v3, s[8:11], s23 offen offset:3040
    s_mov_b32 s50, 0xffffffe0
    s_mov_b32 s51, 0xffffe000
    v_mfma_f32_32x32x16_bf16 v[80:95], v[144:147], v[132:135], 0
    v_exp_f32 v96, v96
    v_exp_f32 v97, v97
    v_exp_f32 v98, v98
    v_exp_f32 v99, v99
    v_cvt_pk_bf16_f32 v112, v96, v97
    v_cvt_pk_bf16_f32 v113, v98, v99
    v_mfma_f32_32x32x8_bf16 v[80:95], v[148:149], v[136:137], v[80:95]
    v_exp_f32 v100, v100
    v_exp_f32 v101, v101
    v_exp_f32 v102, v102
    v_exp_f32 v103, v103
    v_cvt_pk_bf16_f32 v114, v100, v101
    v_cvt_pk_bf16_f32 v115, v102, v103
    v_mfma_f32_32x32x16_bf16 v[16:31], v[154:157], v[116:119], v[16:31]
    v_exp_f32 v104, v104
    v_exp_f32 v105, v105
    v_exp_f32 v106, v106
    v_exp_f32 v107, v107
    v_cvt_pk_bf16_f32 v116, v104, v105
    v_cvt_pk_bf16_f32 v117, v106, v107
    v_mfma_f32_32x32x16_bf16 v[32:47], v[150:153], v[112:115], v[32:47]
    v_exp_f32 v108, v108
    v_exp_f32 v109, v109
    v_exp_f32 v110, v110
    v_exp_f32 v111, v111
    v_cvt_pk_bf16_f32 v118, v108, v109
    v_cvt_pk_bf16_f32 v119, v110, v111
    s_add_i32 s37, s31, 2
    s_max_i32 s37, s37, 0
    s_lshl_b32 s38, s37, 10
    s_add_u32 s38, s38, s32
    buffer_load_dwordx4 v[204:207], v1, s[8:11], s38 offen
    s_lshl_b32 s38, s37, 7
    s_add_u32 s38, s38, s33
    buffer_load_dword v208, v2, s[8:11], s38 offen
    s_mov_b32 s52, 0xffffffc0
    s_mov_b32 s53, 0xffffc000
    v_mfma_f32_32x32x16_bf16 v[96:111], v[144:147], v[138:141], 0
    v_exp_f32 v80, v80
    v_exp_f32 v81, v81
    v_exp_f32 v82, v82
    v_exp_f32 v83, v83
    v_cvt_pk_bf16_f32 v112, v80, v81
    v_cvt_pk_bf16_f32 v113, v82, v83
    v_mfma_f32_32x32x8_bf16 v[96:111], v[148:149], v[142:143], v[96:111]
    v_exp_f32 v84, v84
    v_exp_f32 v85, v85
    v_exp_f32 v86, v86
    v_exp_f32 v87, v87
    v_cvt_pk_bf16_f32 v114, v84, v85
    v_cvt_pk_bf16_f32 v115, v86, v87
    v_mfma_f32_32x32x16_bf16 v[32:47], v[154:157], v[116:119], v[32:47]
    v_exp_f32 v88, v88
    v_exp_f32 v89, v89
    v_exp_f32 v90, v90
    v_exp_f32 v91, v91
    v_cvt_pk_bf16_f32 v116, v88, v89
    v_cvt_pk_bf16_f32 v117, v90, v91
    v_mfma_f32_32x32x16_bf16 v[48:63], v[150:153], v[112:115], v[48:63]
    v_exp_f32 v92, v92
    v_exp_f32 v93, v93
    v_exp_f32 v94, v94
    v_exp_f32 v95, v95
    v_cvt_pk_bf16_f32 v118, v92, v93
    v_cvt_pk_bf16_f32 v119, v94, v95
    buffer_load_dwordx4 v[144:147], v1, s[8:11], s18 offen offset:1024
    buffer_load_dword v148, v2, s[8:11], s20 offen offset:1152
    s_mov_b32 s54, 0xffffff80
    s_mov_b32 s55, 0xffff8000
    s_waitcnt vmcnt(12)
    v_mfma_f32_32x32x16_bf16 v[80:95], v[158:161], v[120:123], 0
    v_exp_f32 v96, v96
    v_exp_f32 v97, v97
    v_exp_f32 v98, v98
    v_exp_f32 v99, v99
    v_cvt_pk_bf16_f32 v112, v96, v97
    v_cvt_pk_bf16_f32 v113, v98, v99
    v_mfma_f32_32x32x8_bf16 v[80:95], v[162:163], v[124:125], v[80:95]
    v_exp_f32 v100, v100
    v_exp_f32 v101, v101
    v_exp_f32 v102, v102
    v_exp_f32 v103, v103
    v_cvt_pk_bf16_f32 v114, v100, v101
    v_cvt_pk_bf16_f32 v115, v102, v103
    v_mfma_f32_32x32x16_bf16 v[48:63], v[154:157], v[116:119], v[48:63]
    v_exp_f32 v104, v104
    v_exp_f32 v105, v105
    v_exp_f32 v106, v106
    v_exp_f32 v107, v107
    v_cvt_pk_bf16_f32 v116, v104, v105
    v_cvt_pk_bf16_f32 v117, v106, v107
    v_mfma_f32_32x32x16_bf16 v[64:79], v[150:153], v[112:115], v[64:79]
    v_exp_f32 v108, v108
    v_exp_f32 v109, v109
    v_exp_f32 v110, v110
    v_exp_f32 v111, v111
    v_cvt_pk_bf16_f32 v118, v108, v109
    v_cvt_pk_bf16_f32 v119, v110, v111
    s_mov_b32 s56, 0xffff0000
    s_mov_b32 s57, 0xff000000
    v_mfma_f32_32x32x16_bf16 v[96:111], v[158:161], v[126:129], 0
    v_exp_f32 v80, v80
    v_exp_f32 v81, v81
    v_exp_f32 v82, v82
    v_exp_f32 v83, v83
    v_cvt_pk_bf16_f32 v112, v80, v81
    v_cvt_pk_bf16_f32 v113, v82, v83
    v_mfma_f32_32x32x8_bf16 v[96:111], v[162:163], v[130:131], v[96:111]
    v_exp_f32 v84, v84
    v_exp_f32 v85, v85
    v_exp_f32 v86, v86
    v_exp_f32 v87, v87
    v_cvt_pk_bf16_f32 v114, v84, v85
    v_cvt_pk_bf16_f32 v115, v86, v87
    v_mfma_f32_32x32x16_bf16 v[64:79], v[154:157], v[116:119], v[64:79]
    v_exp_f32 v88, v88
    v_exp_f32 v89, v89
    v_exp_f32 v90, v90
    v_exp_f32 v91, v91
    v_cvt_pk_bf16_f32 v116, v88, v89
    v_cvt_pk_bf16_f32 v117, v90, v91
    s_waitcnt vmcnt(10)
    v_mfma_f32_32x32x16_bf16 v[16:31], v[164:167], v[112:115], v[16:31]
    v_exp_f32 v92, v92
    v_exp_f32 v93, v93
    v_exp_f32 v94, v94
    v_exp_f32 v95, v95
    v_cvt_pk_bf16_f32 v118, v92, v93
    v_cvt_pk_bf16_f32 v119, v94, v95
    buffer_load_dwordx4 v[150:153], v3, s[8:11], s24 offen offset:0
    buffer_load_dwordx4 v[154:157], v3, s[8:11], s24 offen offset:608
    s_mov_b32 s58, 0xfffe0000
    s_mov_b32 s59, 0xfe000000
    v_mfma_f32_32x32x16_bf16 v[80:95], v[158:161], v[132:135], 0
    v_exp_f32 v96, v96
    v_exp_f32 v97, v97
    v_exp_f32 v98, v98
    v_exp_f32 v99, v99
    v_cvt_pk_bf16_f32 v112, v96, v97
    v_cvt_pk_bf16_f32 v113, v98, v99
    v_mfma_f32_32x32x8_bf16 v[80:95], v[162:163], v[136:137], v[80:95]
    v_exp_f32 v100, v100
    v_exp_f32 v101, v101
    v_exp_f32 v102, v102
    v_exp_f32 v103, v103
    v_cvt_pk_bf16_f32 v114, v100, v101
    v_cvt_pk_bf16_f32 v115, v102, v103
    v_mfma_f32_32x32x16_bf16 v[16:31], v[168:171], v[116:119], v[16:31]
    v_exp_f32 v104, v104
    v_exp_f32 v105, v105
    v_exp_f32 v106, v106
    v_exp_f32 v107, v107
    v_cvt_pk_bf16_f32 v116, v104, v105
    v_cvt_pk_bf16_f32 v117, v106, v107
    v_mfma_f32_32x32x16_bf16 v[32:47], v[164:167], v[112:115], v[32:47]
    v_exp_f32 v108, v108
    v_exp_f32 v109, v109
    v_exp_f32 v110, v110
    v_exp_f32 v111, v111
    v_cvt_pk_bf16_f32 v118, v108, v109
    v_cvt_pk_bf16_f32 v119, v110, v111
    s_setprio 2
    s_add_i32 s37, s31, 3
    s_max_i32 s37, s37, 0
    s_lshl_b32 s38, s37, 10
    s_add_u32 s38, s38, s32
    buffer_load_dwordx4 v[210:213], v1, s[8:11], s38 offen
    s_lshl_b32 s38, s37, 7
    s_add_u32 s38, s38, s33
    buffer_load_dword v214, v2, s[8:11], s38 offen
    s_mov_b32 s60, 0xfffc0000
    s_mov_b32 s61, 0xfc000000
    v_mfma_f32_32x32x16_bf16 v[96:111], v[158:161], v[138:141], 0
    v_exp_f32 v80, v80
    v_exp_f32 v81, v81
    v_exp_f32 v82, v82
    v_exp_f32 v83, v83
    v_cvt_pk_bf16_f32 v112, v80, v81
    v_cvt_pk_bf16_f32 v113, v82, v83
    v_mfma_f32_32x32x8_bf16 v[96:111], v[162:163], v[142:143], v[96:111]
    v_exp_f32 v84, v84
    v_exp_f32 v85, v85
    v_exp_f32 v86, v86
    v_exp_f32 v87, v87
    v_cvt_pk_bf16_f32 v114, v84, v85
    v_cvt_pk_bf16_f32 v115, v86, v87
    v_mfma_f32_32x32x16_bf16 v[32:47], v[168:171], v[116:119], v[32:47]
    v_exp_f32 v88, v88
    v_exp_f32 v89, v89
    v_exp_f32 v90, v90
    v_exp_f32 v91, v91
    v_cvt_pk_bf16_f32 v116, v88, v89
    v_cvt_pk_bf16_f32 v117, v90, v91
    v_mfma_f32_32x32x16_bf16 v[48:63], v[164:167], v[112:115], v[48:63]
    v_exp_f32 v92, v92
    v_exp_f32 v93, v93
    v_exp_f32 v94, v94
    v_exp_f32 v95, v95
    v_cvt_pk_bf16_f32 v118, v92, v93
    v_cvt_pk_bf16_f32 v119, v94, v95
    buffer_load_dwordx4 v[158:161], v1, s[8:11], s18 offen offset:2048
    buffer_load_dword v162, v2, s[8:11], s20 offen offset:1280
    s_mov_b32 s62, 0xfff80000
    s_mov_b32 s63, 0xf8000000
    s_waitcnt vmcnt(12)
    v_mfma_f32_32x32x16_bf16 v[80:95], v[172:175], v[120:123], 0
    v_exp_f32 v96, v96
    v_exp_f32 v97, v97
    v_exp_f32 v98, v98
    v_exp_f32 v99, v99
    v_cvt_pk_bf16_f32 v112, v96, v97
    v_cvt_pk_bf16_f32 v113, v98, v99
    v_mfma_f32_32x32x8_bf16 v[80:95], v[176:177], v[124:125], v[80:95]
    v_exp_f32 v100, v100
    v_exp_f32 v101, v101
    v_exp_f32 v102, v102
    v_exp_f32 v103, v103
    v_cvt_pk_bf16_f32 v114, v100, v101
    v_cvt_pk_bf16_f32 v115, v102, v103
    v_mfma_f32_32x32x16_bf16 v[48:63], v[168:171], v[116:119], v[48:63]
    v_exp_f32 v104, v104
    v_exp_f32 v105, v105
    v_exp_f32 v106, v106
    v_exp_f32 v107, v107
    v_cvt_pk_bf16_f32 v116, v104, v105
    v_cvt_pk_bf16_f32 v117, v106, v107
    v_mfma_f32_32x32x16_bf16 v[64:79], v[164:167], v[112:115], v[64:79]
    v_exp_f32 v108, v108
    v_exp_f32 v109, v109
    v_exp_f32 v110, v110
    v_exp_f32 v111, v111
    v_cvt_pk_bf16_f32 v118, v108, v109
    v_cvt_pk_bf16_f32 v119, v110, v111
    s_mov_b32 s64, 0xfff00000
    s_mov_b32 s65, 0xf0000000
    v_mfma_f32_32x32x16_bf16 v[96:111], v[172:175], v[126:129], 0
    v_exp_f32 v80, v80
    v_exp_f32 v81, v81
    v_exp_f32 v82, v82
    v_exp_f32 v83, v83
    v_cvt_pk_bf16_f32 v112, v80, v81
    v_cvt_pk_bf16_f32 v113, v82, v83
    v_mfma_f32_32x32x8_bf16 v[96:111], v[176:177], v[130:131], v[96:111]
    v_exp_f32 v84, v84
    v_exp_f32 v85, v85
    v_exp_f32 v86, v86
    v_exp_f32 v87, v87
    v_cvt_pk_bf16_f32 v114, v84, v85
    v_cvt_pk_bf16_f32 v115, v86, v87
    v_mfma_f32_32x32x16_bf16 v[64:79], v[168:171], v[116:119], v[64:79]
    v_exp_f32 v88, v88
    v_exp_f32 v89, v89
    v_exp_f32 v90, v90
    v_exp_f32 v91, v91
    v_cvt_pk_bf16_f32 v116, v88, v89
    v_cvt_pk_bf16_f32 v117, v90, v91
    s_waitcnt vmcnt(10)
    v_mfma_f32_32x32x16_bf16 v[16:31], v[178:181], v[112:115], v[16:31]
    v_exp_f32 v92, v92
    v_exp_f32 v93, v93
    v_exp_f32 v94, v94
    v_exp_f32 v95, v95
    v_cvt_pk_bf16_f32 v118, v92, v93
    v_cvt_pk_bf16_f32 v119, v94, v95
    buffer_load_dwordx4 v[164:167], v3, s[8:11], s24 offen offset:1216
    buffer_load_dwordx4 v[168:171], v3, s[8:11], s24 offen offset:1824
    s_mov_b32 s66, 0xffe00000
    s_mov_b32 s67, 0xe0000000
    s_add_u32 m0, s76, 0
    s_add_u32 s37, s75, 0
    buffer_load_dwordx4 v1, s[8:11], s37 offen lds
    s_add_u32 m0, s76, 4096
    s_add_u32 s37, s75, 4096
    buffer_load_dwordx4 v1, s[8:11], s37 offen lds
    s_add_u32 m0, s76, 8192
    s_add_u32 s37, s75, 8192
    buffer_load_dwordx4 v1, s[8:11], s37 offen lds
    s_add_u32 m0, s76, 12288
    s_add_u32 s37, s75, 12288
    buffer_load_dwordx4 v1, s[8:11], s37 offen lds
    v_mfma_f32_32x32x16_bf16 v[80:95], v[172:175], v[132:135], 0
    v_exp_f32 v96, v96
    v_exp_f32 v97, v97
    v_exp_f32 v98, v98
    v_exp_f32 v99, v99
    v_cvt_pk_bf16_f32 v112, v96, v97
    v_cvt_pk_bf16_f32 v113, v98, v99
    v_mfma_f32_32x32x8_bf16 v[80:95], v[176:177], v[136:137], v[80:95]
    v_exp_f32 v100, v100
    v_exp_f32 v101, v101
    v_exp_f32 v102, v102
    v_exp_f32 v103, v103
    v_cvt_pk_bf16_f32 v114, v100, v101
    v_cvt_pk_bf16_f32 v115, v102, v103
    v_mfma_f32_32x32x16_bf16 v[16:31], v[182:185], v[116:119], v[16:31]
    v_exp_f32 v104, v104
    v_exp_f32 v105, v105
    v_exp_f32 v106, v106
    v_exp_f32 v107, v107
    v_cvt_pk_bf16_f32 v116, v104, v105
    v_cvt_pk_bf16_f32 v117, v106, v107
    v_mfma_f32_32x32x16_bf16 v[32:47], v[178:181], v[112:115], v[32:47]
    v_exp_f32 v108, v108
    v_exp_f32 v109, v109
    v_exp_f32 v110, v110
    v_exp_f32 v111, v111
    v_cvt_pk_bf16_f32 v118, v108, v109
    v_cvt_pk_bf16_f32 v119, v110, v111
    s_add_i32 s37, s31, 4
    s_max_i32 s37, s37, 0
    s_lshl_b32 s38, s37, 10
    s_add_u32 s38, s38, s32
    buffer_load_dwordx4 v[216:219], v1, s[8:11], s38 offen
    s_lshl_b32 s38, s37, 7
    s_add_u32 s38, s38, s33
    buffer_load_dword v220, v2, s[8:11], s38 offen
    s_mov_b32 s68, 0xffc00000
    s_mov_b32 s69, 0xc0000000
    v_mfma_f32_32x32x16_bf16 v[96:111], v[172:175], v[138:141], 0
    v_exp_f32 v80, v80
    v_exp_f32 v81, v81
    v_exp_f32 v82, v82
    v_exp_f32 v83, v83
    v_cvt_pk_bf16_f32 v112, v80, v81
    v_cvt_pk_bf16_f32 v113, v82, v83
    v_mfma_f32_32x32x8_bf16 v[96:111], v[176:177], v[142:143], v[96:111]
    v_exp_f32 v84, v84
    v_exp_f32 v85, v85
    v_exp_f32 v86, v86
    v_exp_f32 v87, v87
    v_cvt_pk_bf16_f32 v114, v84, v85
    v_cvt_pk_bf16_f32 v115, v86, v87
    v_mfma_f32_32x32x16_bf16 v[32:47], v[182:185], v[116:119], v[32:47]
    v_exp_f32 v88, v88
    v_exp_f32 v89, v89
    v_exp_f32 v90, v90
    v_exp_f32 v91, v91
    v_cvt_pk_bf16_f32 v116, v88, v89
    v_cvt_pk_bf16_f32 v117, v90, v91
    v_mfma_f32_32x32x16_bf16 v[48:63], v[178:181], v[112:115], v[48:63]
    v_exp_f32 v92, v92
    v_exp_f32 v93, v93
    v_exp_f32 v94, v94
    v_exp_f32 v95, v95
    v_cvt_pk_bf16_f32 v118, v92, v93
    v_cvt_pk_bf16_f32 v119, v94, v95
    buffer_load_dwordx4 v[172:175], v1, s[8:11], s18 offen offset:3072
    buffer_load_dword v176, v2, s[8:11], s20 offen offset:1408
    s_mov_b32 s70, 0xff800000
    s_mov_b32 s71, 0x80000000
    s_waitcnt vmcnt(16)
    v_mfma_f32_32x32x16_bf16 v[80:95], v[144:147], v[120:123], 0
    v_exp_f32 v96, v96
    v_exp_f32 v97, v97
    v_exp_f32 v98, v98
    v_exp_f32 v99, v99
    v_cvt_pk_bf16_f32 v112, v96, v97
    v_cvt_pk_bf16_f32 v113, v98, v99
    v_mfma_f32_32x32x8_bf16 v[80:95], v[148:149], v[124:125], v[80:95]
    v_exp_f32 v100, v100
    v_exp_f32 v101, v101
    v_exp_f32 v102, v102
    v_exp_f32 v103, v103
    v_cvt_pk_bf16_f32 v114, v100, v101
    v_cvt_pk_bf16_f32 v115, v102, v103
    v_mfma_f32_32x32x16_bf16 v[48:63], v[182:185], v[116:119], v[48:63]
    v_exp_f32 v104, v104
    v_exp_f32 v105, v105
    v_exp_f32 v106, v106
    v_exp_f32 v107, v107
    v_cvt_pk_bf16_f32 v116, v104, v105
    v_cvt_pk_bf16_f32 v117, v106, v107
    v_mfma_f32_32x32x16_bf16 v[64:79], v[178:181], v[112:115], v[64:79]
    v_exp_f32 v108, v108
    v_exp_f32 v109, v109
    v_exp_f32 v110, v110
    v_exp_f32 v111, v111
    v_cvt_pk_bf16_f32 v118, v108, v109
    v_cvt_pk_bf16_f32 v119, v110, v111
    v_mfma_f32_32x32x16_bf16 v[96:111], v[144:147], v[126:129], 0
    v_exp_f32 v80, v80
    v_exp_f32 v81, v81
    v_exp_f32 v82, v82
    v_exp_f32 v83, v83
    v_cvt_pk_bf16_f32 v112, v80, v81
    v_cvt_pk_bf16_f32 v113, v82, v83
    v_mfma_f32_32x32x8_bf16 v[96:111], v[148:149], v[130:131], v[96:111]
    v_exp_f32 v84, v84
    v_exp_f32 v85, v85
    v_exp_f32 v86, v86
    v_exp_f32 v87, v87
    v_cvt_pk_bf16_f32 v114, v84, v85
    v_cvt_pk_bf16_f32 v115, v86, v87
    v_mfma_f32_32x32x16_bf16 v[64:79], v[182:185], v[116:119], v[64:79]
    v_exp_f32 v88, v88
    v_exp_f32 v89, v89
    v_exp_f32 v90, v90
    v_exp_f32 v91, v91
    v_cvt_pk_bf16_f32 v116, v88, v89
    v_cvt_pk_bf16_f32 v117, v90, v91
    s_waitcnt vmcnt(14)
    v_mfma_f32_32x32x16_bf16 v[16:31], v[150:153], v[112:115], v[16:31]
    v_exp_f32 v92, v92
    v_exp_f32 v93, v93
    v_exp_f32 v94, v94
    v_exp_f32 v95, v95
    v_cvt_pk_bf16_f32 v118, v92, v93
    v_cvt_pk_bf16_f32 v119, v94, v95
    buffer_load_dwordx4 v[178:181], v3, s[8:11], s24 offen offset:2432
    buffer_load_dwordx4 v[182:185], v3, s[8:11], s24 offen offset:3040
    v_mfma_f32_32x32x16_bf16 v[80:95], v[144:147], v[132:135], 0
    v_exp_f32 v96, v96
    v_exp_f32 v97, v97
    v_exp_f32 v98, v98
    v_exp_f32 v99, v99
    v_cvt_pk_bf16_f32 v112, v96, v97
    v_cvt_pk_bf16_f32 v113, v98, v99
    v_mfma_f32_32x32x8_bf16 v[80:95], v[148:149], v[136:137], v[80:95]
    v_exp_f32 v100, v100
    v_exp_f32 v101, v101
    v_exp_f32 v102, v102
    v_exp_f32 v103, v103
    v_cvt_pk_bf16_f32 v114, v100, v101
    v_cvt_pk_bf16_f32 v115, v102, v103
    v_mfma_f32_32x32x16_bf16 v[16:31], v[154:157], v[116:119], v[16:31]
    v_exp_f32 v104, v104
    v_exp_f32 v105, v105
    v_exp_f32 v106, v106
    v_exp_f32 v107, v107
    v_cvt_pk_bf16_f32 v116, v104, v105
    v_cvt_pk_bf16_f32 v117, v106, v107
    v_mfma_f32_32x32x16_bf16 v[32:47], v[150:153], v[112:115], v[32:47]
    v_exp_f32 v108, v108
    v_exp_f32 v109, v109
    v_exp_f32 v110, v110
    v_exp_f32 v111, v111
    v_cvt_pk_bf16_f32 v118, v108, v109
    v_cvt_pk_bf16_f32 v119, v110, v111
    s_add_i32 s37, s31, 5
    s_max_i32 s37, s37, 0
    s_lshl_b32 s38, s37, 10
    s_add_u32 s38, s38, s32
    buffer_load_dwordx4 v[222:225], v1, s[8:11], s38 offen
    s_lshl_b32 s38, s37, 7
    s_add_u32 s38, s38, s33
    buffer_load_dword v226, v2, s[8:11], s38 offen
    v_mfma_f32_32x32x16_bf16 v[96:111], v[144:147], v[138:141], 0
    v_exp_f32 v80, v80
    v_exp_f32 v81, v81
    v_exp_f32 v82, v82
    v_exp_f32 v83, v83
    v_cvt_pk_bf16_f32 v112, v80, v81
    v_cvt_pk_bf16_f32 v113, v82, v83
    v_mfma_f32_32x32x8_bf16 v[96:111], v[148:149], v[142:143], v[96:111]
    v_exp_f32 v84, v84
    v_exp_f32 v85, v85
    v_exp_f32 v86, v86
    v_exp_f32 v87, v87
    v_cvt_pk_bf16_f32 v114, v84, v85
    v_cvt_pk_bf16_f32 v115, v86, v87
    v_mfma_f32_32x32x16_bf16 v[32:47], v[154:157], v[116:119], v[32:47]
    v_exp_f32 v88, v88
    v_exp_f32 v89, v89
    v_exp_f32 v90, v90
    v_exp_f32 v91, v91
    v_cvt_pk_bf16_f32 v116, v88, v89
    v_cvt_pk_bf16_f32 v117, v90, v91
    v_mfma_f32_32x32x16_bf16 v[48:63], v[150:153], v[112:115], v[48:63]
    v_exp_f32 v92, v92
    v_exp_f32 v93, v93
    v_exp_f32 v94, v94
    v_exp_f32 v95, v95
    v_cvt_pk_bf16_f32 v118, v92, v93
    v_cvt_pk_bf16_f32 v119, v94, v95
    buffer_load_dwordx4 v[144:147], v1, s[8:11], s19 offen offset:0
    buffer_load_dword v148, v2, s[8:11], s20 offen offset:1536
    s_waitcnt vmcnt(16)
    v_mfma_f32_32x32x16_bf16 v[80:95], v[158:161], v[120:123], 0
    v_exp_f32 v96, v96
    v_exp_f32 v97, v97
    v_exp_f32 v98, v98
    v_exp_f32 v99, v99
    v_cvt_pk_bf16_f32 v112, v96, v97
    v_cvt_pk_bf16_f32 v113, v98, v99
    v_mfma_f32_32x32x8_bf16 v[80:95], v[162:163], v[124:125], v[80:95]
    v_exp_f32 v100, v100
    v_exp_f32 v101, v101
    v_exp_f32 v102, v102
    v_exp_f32 v103, v103
    v_cvt_pk_bf16_f32 v114, v100, v101
    v_cvt_pk_bf16_f32 v115, v102, v103
    v_mfma_f32_32x32x16_bf16 v[48:63], v[154:157], v[116:119], v[48:63]
    v_exp_f32 v104, v104
    v_exp_f32 v105, v105
    v_exp_f32 v106, v106
    v_exp_f32 v107, v107
    v_cvt_pk_bf16_f32 v116, v104, v105
    v_cvt_pk_bf16_f32 v117, v106, v107
    v_mfma_f32_32x32x16_bf16 v[64:79], v[150:153], v[112:115], v[64:79]
    v_exp_f32 v108, v108
    v_exp_f32 v109, v109
    v_exp_f32 v110, v110
    v_exp_f32 v111, v111
    v_cvt_pk_bf16_f32 v118, v108, v109
    v_cvt_pk_bf16_f32 v119, v110, v111
    v_mfma_f32_32x32x16_bf16 v[96:111], v[158:161], v[126:129], 0
    v_exp_f32 v80, v80
    v_exp_f32 v81, v81
    v_exp_f32 v82, v82
    v_exp_f32 v83, v83
    v_cvt_pk_bf16_f32 v112, v80, v81
    v_cvt_pk_bf16_f32 v113, v82, v83
    v_mfma_f32_32x32x8_bf16 v[96:111], v[162:163], v[130:131], v[96:111]
    v_exp_f32 v84, v84
    v_exp_f32 v85, v85
    v_exp_f32 v86, v86
    v_exp_f32 v87, v87
    v_cvt_pk_bf16_f32 v114, v84, v85
    v_cvt_pk_bf16_f32 v115, v86, v87
    v_mfma_f32_32x32x16_bf16 v[64:79], v[154:157], v[116:119], v[64:79]
    v_exp_f32 v88, v88
    v_exp_f32 v89, v89
    v_exp_f32 v90, v90
    v_exp_f32 v91, v91
    v_cvt_pk_bf16_f32 v116, v88, v89
    v_cvt_pk_bf16_f32 v117, v90, v91
    s_waitcnt vmcnt(14)
    v_mfma_f32_32x32x16_bf16 v[16:31], v[164:167], v[112:115], v[16:31]
    v_exp_f32 v92, v92
    v_exp_f32 v93, v93
    v_exp_f32 v94, v94
    v_exp_f32 v95, v95
    v_cvt_pk_bf16_f32 v118, v92, v93
    v_cvt_pk_bf16_f32 v119, v94, v95
    buffer_load_dwordx4 v[150:153], v3, s[8:11], s25 offen offset:0
    buffer_load_dwordx4 v[154:157], v3, s[8:11], s25 offen offset:608
    v_mfma_f32_32x32x16_bf16 v[80:95], v[158:161], v[132:135], 0
    v_exp_f32 v96, v96
    v_exp_f32 v97, v97
    v_exp_f32 v98, v98
    v_exp_f32 v99, v99
    v_cvt_pk_bf16_f32 v112, v96, v97
    v_cvt_pk_bf16_f32 v113, v98, v99
    v_mfma_f32_32x32x8_bf16 v[80:95], v[162:163], v[136:137], v[80:95]
    v_exp_f32 v100, v100
    v_exp_f32 v101, v101
    v_exp_f32 v102, v102
    v_exp_f32 v103, v103
    v_cvt_pk_bf16_f32 v114, v100, v101
    v_cvt_pk_bf16_f32 v115, v102, v103
    v_mfma_f32_32x32x16_bf16 v[16:31], v[168:171], v[116:119], v[16:31]
    v_exp_f32 v104, v104
    v_exp_f32 v105, v105
    v_exp_f32 v106, v106
    v_exp_f32 v107, v107
    v_cvt_pk_bf16_f32 v116, v104, v105
    v_cvt_pk_bf16_f32 v117, v106, v107
    v_mfma_f32_32x32x16_bf16 v[32:47], v[164:167], v[112:115], v[32:47]
    v_exp_f32 v108, v108
    v_exp_f32 v109, v109
    v_exp_f32 v110, v110
    v_exp_f32 v111, v111
    v_cvt_pk_bf16_f32 v118, v108, v109
    v_cvt_pk_bf16_f32 v119, v110, v111
    s_add_i32 s37, s31, 6
    s_max_i32 s37, s37, 0
    s_lshl_b32 s38, s37, 10
    s_add_u32 s38, s38, s32
    buffer_load_dwordx4 v[228:231], v1, s[8:11], s38 offen
    s_lshl_b32 s38, s37, 7
    s_add_u32 s38, s38, s33
    buffer_load_dword v232, v2, s[8:11], s38 offen
    v_mfma_f32_32x32x16_bf16 v[96:111], v[158:161], v[138:141], 0
    v_exp_f32 v80, v80
    v_exp_f32 v81, v81
    v_exp_f32 v82, v82
    v_exp_f32 v83, v83
    v_cvt_pk_bf16_f32 v112, v80, v81
    v_cvt_pk_bf16_f32 v113, v82, v83
    v_mfma_f32_32x32x8_bf16 v[96:111], v[162:163], v[142:143], v[96:111]
    v_exp_f32 v84, v84
    v_exp_f32 v85, v85
    v_exp_f32 v86, v86
    v_exp_f32 v87, v87
    v_cvt_pk_bf16_f32 v114, v84, v85
    v_cvt_pk_bf16_f32 v115, v86, v87
    v_mfma_f32_32x32x16_bf16 v[32:47], v[168:171], v[116:119], v[32:47]
    v_exp_f32 v88, v88
    v_exp_f32 v89, v89
    v_exp_f32 v90, v90
    v_exp_f32 v91, v91
    v_cvt_pk_bf16_f32 v116, v88, v89
    v_cvt_pk_bf16_f32 v117, v90, v91
    v_mfma_f32_32x32x16_bf16 v[48:63], v[164:167], v[112:115], v[48:63]
    v_exp_f32 v92, v92
    v_exp_f32 v93, v93
    v_exp_f32 v94, v94
    v_exp_f32 v95, v95
    v_cvt_pk_bf16_f32 v118, v92, v93
    v_cvt_pk_bf16_f32 v119, v94, v95
    buffer_load_dwordx4 v[158:161], v1, s[8:11], s19 offen offset:1024
    buffer_load_dword v162, v2, s[8:11], s20 offen offset:1664
    s_waitcnt vmcnt(12)
    v_mfma_f32_32x32x16_bf16 v[80:95], v[172:175], v[120:123], 0
    v_exp_f32 v96, v96
    v_exp_f32 v97, v97
    v_exp_f32 v98, v98
    v_exp_f32 v99, v99
    v_cvt_pk_bf16_f32 v112, v96, v97
    v_cvt_pk_bf16_f32 v113, v98, v99
    v_mfma_f32_32x32x8_bf16 v[80:95], v[176:177], v[124:125], v[80:95]
    v_exp_f32 v100, v100
    v_exp_f32 v101, v101
    v_exp_f32 v102, v102
    v_exp_f32 v103, v103
    v_cvt_pk_bf16_f32 v114, v100, v101
    v_cvt_pk_bf16_f32 v115, v102, v103
    v_mfma_f32_32x32x16_bf16 v[48:63], v[168:171], v[116:119], v[48:63]
    v_exp_f32 v104, v104
    v_exp_f32 v105, v105
    v_exp_f32 v106, v106
    v_exp_f32 v107, v107
    v_cvt_pk_bf16_f32 v116, v104, v105
    v_cvt_pk_bf16_f32 v117, v106, v107
    v_mfma_f32_32x32x16_bf16 v[64:79], v[164:167], v[112:115], v[64:79]
    v_exp_f32 v108, v108
    v_exp_f32 v109, v109
    v_exp_f32 v110, v110
    v_exp_f32 v111, v111
    v_cvt_pk_bf16_f32 v118, v108, v109
    v_cvt_pk_bf16_f32 v119, v110, v111
    v_mfma_f32_32x32x16_bf16 v[96:111], v[172:175], v[126:129], 0
    v_exp_f32 v80, v80
    v_exp_f32 v81, v81
    v_exp_f32 v82, v82
    v_exp_f32 v83, v83
    v_cvt_pk_bf16_f32 v112, v80, v81
    v_cvt_pk_bf16_f32 v113, v82, v83
    v_mfma_f32_32x32x8_bf16 v[96:111], v[176:177], v[130:131], v[96:111]
    v_exp_f32 v84, v84
    v_exp_f32 v85, v85
    v_exp_f32 v86, v86
    v_exp_f32 v87, v87
    v_cvt_pk_bf16_f32 v114, v84, v85
    v_cvt_pk_bf16_f32 v115, v86, v87
    v_mfma_f32_32x32x16_bf16 v[64:79], v[168:171], v[116:119], v[64:79]
    v_exp_f32 v88, v88
    v_exp_f32 v89, v89
    v_exp_f32 v90, v90
    v_exp_f32 v91, v91
    v_cvt_pk_bf16_f32 v116, v88, v89
    v_cvt_pk_bf16_f32 v117, v90, v91
    s_waitcnt vmcnt(10)
    v_mfma_f32_32x32x16_bf16 v[16:31], v[178:181], v[112:115], v[16:31]
    v_exp_f32 v92, v92
    v_exp_f32 v93, v93
    v_exp_f32 v94, v94
    v_exp_f32 v95, v95
    v_cvt_pk_bf16_f32 v118, v92, v93
    v_cvt_pk_bf16_f32 v119, v94, v95
    buffer_load_dwordx4 v[164:167], v3, s[8:11], s25 offen offset:1216
    buffer_load_dwordx4 v[168:171], v3, s[8:11], s25 offen offset:1824
    v_mfma_f32_32x32x16_bf16 v[80:95], v[172:175], v[132:135], 0
    v_exp_f32 v96, v96
    v_exp_f32 v97, v97
    v_exp_f32 v98, v98
    v_exp_f32 v99, v99
    v_cvt_pk_bf16_f32 v112, v96, v97
    v_cvt_pk_bf16_f32 v113, v98, v99
    v_mfma_f32_32x32x8_bf16 v[80:95], v[176:177], v[136:137], v[80:95]
    v_exp_f32 v100, v100
    v_exp_f32 v101, v101
    v_exp_f32 v102, v102
    v_exp_f32 v103, v103
    v_cvt_pk_bf16_f32 v114, v100, v101
    v_cvt_pk_bf16_f32 v115, v102, v103
    v_mfma_f32_32x32x16_bf16 v[16:31], v[182:185], v[116:119], v[16:31]
    v_exp_f32 v104, v104
    v_exp_f32 v105, v105
    v_exp_f32 v106, v106
    v_exp_f32 v107, v107
    v_cvt_pk_bf16_f32 v116, v104, v105
    v_cvt_pk_bf16_f32 v117, v106, v107
    v_mfma_f32_32x32x16_bf16 v[32:47], v[178:181], v[112:115], v[32:47]
    v_exp_f32 v108, v108
    v_exp_f32 v109, v109
    v_exp_f32 v110, v110
    v_exp_f32 v111, v111
    v_cvt_pk_bf16_f32 v118, v108, v109
    v_cvt_pk_bf16_f32 v119, v110, v111
    s_add_i32 s37, s31, 7
    s_max_i32 s37, s37, 0
    s_lshl_b32 s38, s37, 10
    s_add_u32 s38, s38, s32
    buffer_load_dwordx4 v[234:237], v1, s[8:11], s38 offen
    s_lshl_b32 s38, s37, 7
    s_add_u32 s38, s38, s33
    buffer_load_dword v238, v2, s[8:11], s38 offen
    v_mfma_f32_32x32x16_bf16 v[96:111], v[172:175], v[138:141], 0
    v_exp_f32 v80, v80
    v_exp_f32 v81, v81
    v_exp_f32 v82, v82
    v_exp_f32 v83, v83
    v_cvt_pk_bf16_f32 v112, v80, v81
    v_cvt_pk_bf16_f32 v113, v82, v83
    v_mfma_f32_32x32x8_bf16 v[96:111], v[176:177], v[142:143], v[96:111]
    v_exp_f32 v84, v84
    v_exp_f32 v85, v85
    v_exp_f32 v86, v86
    v_exp_f32 v87, v87
    v_cvt_pk_bf16_f32 v114, v84, v85
    v_cvt_pk_bf16_f32 v115, v86, v87
    v_mfma_f32_32x32x16_bf16 v[32:47], v[182:185], v[116:119], v[32:47]
    v_exp_f32 v88, v88
    v_exp_f32 v89, v89
    v_exp_f32 v90, v90
    v_exp_f32 v91, v91
    v_cvt_pk_bf16_f32 v116, v88, v89
    v_cvt_pk_bf16_f32 v117, v90, v91
    v_mfma_f32_32x32x16_bf16 v[48:63], v[178:181], v[112:115], v[48:63]
    v_exp_f32 v92, v92
    v_exp_f32 v93, v93
    v_exp_f32 v94, v94
    v_exp_f32 v95, v95
    v_cvt_pk_bf16_f32 v118, v92, v93
    v_cvt_pk_bf16_f32 v119, v94, v95
    buffer_load_dwordx4 v[172:175], v1, s[8:11], s19 offen offset:2048
    buffer_load_dword v176, v2, s[8:11], s20 offen offset:1792
    s_waitcnt vmcnt(12)
    v_mfma_f32_32x32x16_bf16 v[80:95], v[144:147], v[120:123], 0
    v_exp_f32 v96, v96
    v_exp_f32 v97, v97
    v_exp_f32 v98, v98
    v_exp_f32 v99, v99
    v_cvt_pk_bf16_f32 v112, v96, v97
    v_cvt_pk_bf16_f32 v113, v98, v99
    v_mfma_f32_32x32x8_bf16 v[80:95], v[148:149], v[124:125], v[80:95]
    v_exp_f32 v100, v100
    v_exp_f32 v101, v101
    v_exp_f32 v102, v102
    v_exp_f32 v103, v103
    v_cvt_pk_bf16_f32 v114, v100, v101
    v_cvt_pk_bf16_f32 v115, v102, v103
    v_mfma_f32_32x32x16_bf16 v[48:63], v[182:185], v[116:119], v[48:63]
    v_exp_f32 v104, v104
    v_exp_f32 v105, v105
    v_exp_f32 v106, v106
    v_exp_f32 v107, v107
    v_cvt_pk_bf16_f32 v116, v104, v105
    v_cvt_pk_bf16_f32 v117, v106, v107
    v_mfma_f32_32x32x16_bf16 v[64:79], v[178:181], v[112:115], v[64:79]
    v_exp_f32 v108, v108
    v_exp_f32 v109, v109
    v_exp_f32 v110, v110
    v_exp_f32 v111, v111
    v_cvt_pk_bf16_f32 v118, v108, v109
    v_cvt_pk_bf16_f32 v119, v110, v111
    v_mfma_f32_32x32x16_bf16 v[96:111], v[144:147], v[126:129], 0
    v_exp_f32 v80, v80
    v_exp_f32 v81, v81
    v_exp_f32 v82, v82
    v_exp_f32 v83, v83
    v_cvt_pk_bf16_f32 v112, v80, v81
    v_cvt_pk_bf16_f32 v113, v82, v83
    v_mfma_f32_32x32x8_bf16 v[96:111], v[148:149], v[130:131], v[96:111]
    v_exp_f32 v84, v84
    v_exp_f32 v85, v85
    v_exp_f32 v86, v86
    v_exp_f32 v87, v87
    v_cvt_pk_bf16_f32 v114, v84, v85
    v_cvt_pk_bf16_f32 v115, v86, v87
    v_mfma_f32_32x32x16_bf16 v[64:79], v[182:185], v[116:119], v[64:79]
    v_exp_f32 v88, v88
    v_exp_f32 v89, v89
    v_exp_f32 v90, v90
    v_exp_f32 v91, v91
    v_cvt_pk_bf16_f32 v116, v88, v89
    v_cvt_pk_bf16_f32 v117, v90, v91
    s_waitcnt vmcnt(10)
    v_mfma_f32_32x32x16_bf16 v[16:31], v[150:153], v[112:115], v[16:31]
    v_exp_f32 v92, v92
    v_exp_f32 v93, v93
    v_exp_f32 v94, v94
    v_exp_f32 v95, v95
    v_cvt_pk_bf16_f32 v118, v92, v93
    v_cvt_pk_bf16_f32 v119, v94, v95
    buffer_load_dwordx4 v[178:181], v3, s[8:11], s25 offen offset:2432
    buffer_load_dwordx4 v[182:185], v3, s[8:11], s25 offen offset:3040
    v_mfma_f32_32x32x16_bf16 v[80:95], v[144:147], v[132:135], 0
    v_exp_f32 v96, v96
    v_exp_f32 v97, v97
    v_exp_f32 v98, v98
    v_exp_f32 v99, v99
    v_cvt_pk_bf16_f32 v112, v96, v97
    v_cvt_pk_bf16_f32 v113, v98, v99
    v_mfma_f32_32x32x8_bf16 v[80:95], v[148:149], v[136:137], v[80:95]
    v_exp_f32 v100, v100
    v_exp_f32 v101, v101
    v_exp_f32 v102, v102
    v_exp_f32 v103, v103
    v_cvt_pk_bf16_f32 v114, v100, v101
    v_cvt_pk_bf16_f32 v115, v102, v103
    v_mfma_f32_32x32x16_bf16 v[16:31], v[154:157], v[116:119], v[16:31]
    v_exp_f32 v104, v104
    v_exp_f32 v105, v105
    v_exp_f32 v106, v106
    v_exp_f32 v107, v107
    v_cvt_pk_bf16_f32 v116, v104, v105
    v_cvt_pk_bf16_f32 v117, v106, v107
    v_mfma_f32_32x32x16_bf16 v[32:47], v[150:153], v[112:115], v[32:47]
    v_exp_f32 v108, v108
    v_exp_f32 v109, v109
    v_exp_f32 v110, v110
    v_exp_f32 v111, v111
    v_cvt_pk_bf16_f32 v118, v108, v109
    v_cvt_pk_bf16_f32 v119, v110, v111
    s_setprio 1
    s_add_i32 s37, s31, 8
    s_max_i32 s37, s37, 0
    s_lshl_b32 s38, s37, 10
    s_add_u32 s38, s38, s32
    buffer_load_dwordx4 v[240:243], v1, s[8:11], s38 offen
    s_lshl_b32 s38, s37, 7
    s_add_u32 s38, s38, s33
    buffer_load_dword v244, v2, s[8:11], s38 offen
    v_mfma_f32_32x32x16_bf16 v[96:111], v[144:147], v[138:141], 0
    v_exp_f32 v80, v80
    v_exp_f32 v81, v81
    v_exp_f32 v82, v82
    v_exp_f32 v83, v83
    v_cvt_pk_bf16_f32 v112, v80, v81
    v_cvt_pk_bf16_f32 v113, v82, v83
    v_mfma_f32_32x32x8_bf16 v[96:111], v[148:149], v[142:143], v[96:111]
    v_exp_f32 v84, v84
    v_exp_f32 v85, v85
    v_exp_f32 v86, v86
    v_exp_f32 v87, v87
    v_cvt_pk_bf16_f32 v114, v84, v85
    v_cvt_pk_bf16_f32 v115, v86, v87
    v_mfma_f32_32x32x16_bf16 v[32:47], v[154:157], v[116:119], v[32:47]
    v_exp_f32 v88, v88
    v_exp_f32 v89, v89
    v_exp_f32 v90, v90
    v_exp_f32 v91, v91
    v_cvt_pk_bf16_f32 v116, v88, v89
    v_cvt_pk_bf16_f32 v117, v90, v91
    v_mfma_f32_32x32x16_bf16 v[48:63], v[150:153], v[112:115], v[48:63]
    v_exp_f32 v92, v92
    v_exp_f32 v93, v93
    v_exp_f32 v94, v94
    v_exp_f32 v95, v95
    v_cvt_pk_bf16_f32 v118, v92, v93
    v_cvt_pk_bf16_f32 v119, v94, v95
    buffer_load_dwordx4 v[144:147], v1, s[8:11], s19 offen offset:3072
    buffer_load_dword v148, v2, s[8:11], s20 offen offset:1920
    s_waitcnt vmcnt(12)
    v_mfma_f32_32x32x16_bf16 v[80:95], v[158:161], v[120:123], 0
    v_exp_f32 v96, v96
    v_exp_f32 v97, v97
    v_exp_f32 v98, v98
    v_exp_f32 v99, v99
    v_cvt_pk_bf16_f32 v112, v96, v97
    v_cvt_pk_bf16_f32 v113, v98, v99
    v_mfma_f32_32x32x8_bf16 v[80:95], v[162:163], v[124:125], v[80:95]
    v_exp_f32 v100, v100
    v_exp_f32 v101, v101
    v_exp_f32 v102, v102
    v_exp_f32 v103, v103
    v_cvt_pk_bf16_f32 v114, v100, v101
    v_cvt_pk_bf16_f32 v115, v102, v103
    v_mfma_f32_32x32x16_bf16 v[48:63], v[154:157], v[116:119], v[48:63]
    v_exp_f32 v104, v104
    v_exp_f32 v105, v105
    v_exp_f32 v106, v106
    v_exp_f32 v107, v107
    v_cvt_pk_bf16_f32 v116, v104, v105
    v_cvt_pk_bf16_f32 v117, v106, v107
    v_mfma_f32_32x32x16_bf16 v[64:79], v[150:153], v[112:115], v[64:79]
    v_exp_f32 v108, v108
    v_exp_f32 v109, v109
    v_exp_f32 v110, v110
    v_exp_f32 v111, v111
    v_cvt_pk_bf16_f32 v118, v108, v109
    v_cvt_pk_bf16_f32 v119, v110, v111
    v_mfma_f32_32x32x16_bf16 v[96:111], v[158:161], v[126:129], 0
    v_exp_f32 v80, v80
    v_exp_f32 v81, v81
    v_exp_f32 v82, v82
    v_exp_f32 v83, v83
    v_cvt_pk_bf16_f32 v112, v80, v81
    v_cvt_pk_bf16_f32 v113, v82, v83
    v_mfma_f32_32x32x8_bf16 v[96:111], v[162:163], v[130:131], v[96:111]
    v_exp_f32 v84, v84
    v_exp_f32 v85, v85
    v_exp_f32 v86, v86
    v_exp_f32 v87, v87
    v_cvt_pk_bf16_f32 v114, v84, v85
    v_cvt_pk_bf16_f32 v115, v86, v87
    v_mfma_f32_32x32x16_bf16 v[64:79], v[154:157], v[116:119], v[64:79]
    v_exp_f32 v88, v88
    v_exp_f32 v89, v89
    v_exp_f32 v90, v90
    v_exp_f32 v91, v91
    v_cvt_pk_bf16_f32 v116, v88, v89
    v_cvt_pk_bf16_f32 v117, v90, v91
    s_waitcnt vmcnt(10)
    v_mfma_f32_32x32x16_bf16 v[16:31], v[164:167], v[112:115], v[16:31]
    v_exp_f32 v92, v92
    v_exp_f32 v93, v93
    v_exp_f32 v94, v94
    v_exp_f32 v95, v95
    v_cvt_pk_bf16_f32 v118, v92, v93
    v_cvt_pk_bf16_f32 v119, v94, v95
    buffer_load_dwordx4 v[150:153], v3, s[8:11], s26 offen offset:0
    buffer_load_dwordx4 v[154:157], v3, s[8:11], s26 offen offset:608
    v_mfma_f32_32x32x16_bf16 v[80:95], v[158:161], v[132:135], 0
    v_exp_f32 v96, v96
    v_exp_f32 v97, v97
    v_exp_f32 v98, v98
    v_exp_f32 v99, v99
    v_cvt_pk_bf16_f32 v112, v96, v97
    v_cvt_pk_bf16_f32 v113, v98, v99
    v_mfma_f32_32x32x8_bf16 v[80:95], v[162:163], v[136:137], v[80:95]
    v_exp_f32 v100, v100
    v_exp_f32 v101, v101
    v_exp_f32 v102, v102
    v_exp_f32 v103, v103
    v_cvt_pk_bf16_f32 v114, v100, v101
    v_cvt_pk_bf16_f32 v115, v102, v103
    v_mfma_f32_32x32x16_bf16 v[16:31], v[168:171], v[116:119], v[16:31]
    v_exp_f32 v104, v104
    v_exp_f32 v105, v105
    v_exp_f32 v106, v106
    v_exp_f32 v107, v107
    v_cvt_pk_bf16_f32 v116, v104, v105
    v_cvt_pk_bf16_f32 v117, v106, v107
    v_mfma_f32_32x32x16_bf16 v[32:47], v[164:167], v[112:115], v[32:47]
    v_exp_f32 v108, v108
    v_exp_f32 v109, v109
    v_exp_f32 v110, v110
    v_exp_f32 v111, v111
    v_cvt_pk_bf16_f32 v118, v108, v109
    v_cvt_pk_bf16_f32 v119, v110, v111
    buffer_load_dwordx4 v[186:189], v1, s[8:11], s35 offen
    buffer_load_dword v190, v4, s[8:11], s36 offen
    v_mfma_f32_32x32x16_bf16 v[96:111], v[158:161], v[138:141], 0
    v_exp_f32 v80, v80
    v_exp_f32 v81, v81
    v_exp_f32 v82, v82
    v_exp_f32 v83, v83
    v_cvt_pk_bf16_f32 v112, v80, v81
    v_cvt_pk_bf16_f32 v113, v82, v83
    v_mfma_f32_32x32x8_bf16 v[96:111], v[162:163], v[142:143], v[96:111]
    v_exp_f32 v84, v84
    v_exp_f32 v85, v85
    v_exp_f32 v86, v86
    v_exp_f32 v87, v87
    v_cvt_pk_bf16_f32 v114, v84, v85
    v_cvt_pk_bf16_f32 v115, v86, v87
    v_mfma_f32_32x32x16_bf16 v[32:47], v[168:171], v[116:119], v[32:47]
    v_exp_f32 v88, v88
    v_exp_f32 v89, v89
    v_exp_f32 v90, v90
    v_exp_f32 v91, v91
    v_cvt_pk_bf16_f32 v116, v88, v89
    v_cvt_pk_bf16_f32 v117, v90, v91
    v_mfma_f32_32x32x16_bf16 v[48:63], v[164:167], v[112:115], v[48:63]
    v_exp_f32 v92, v92
    v_exp_f32 v93, v93
    v_exp_f32 v94, v94
    v_exp_f32 v95, v95
    v_cvt_pk_bf16_f32 v118, v92, v93
    v_cvt_pk_bf16_f32 v119, v94, v95
    s_waitcnt vmcnt(10)
    v_mfma_f32_32x32x16_bf16 v[80:95], v[172:175], v[120:123], 0
    v_exp_f32 v96, v96
    v_exp_f32 v97, v97
    v_exp_f32 v98, v98
    v_exp_f32 v99, v99
    v_cvt_pk_bf16_f32 v112, v96, v97
    v_cvt_pk_bf16_f32 v113, v98, v99
    v_mfma_f32_32x32x8_bf16 v[80:95], v[176:177], v[124:125], v[80:95]
    v_exp_f32 v100, v100
    v_exp_f32 v101, v101
    v_exp_f32 v102, v102
    v_exp_f32 v103, v103
    v_cvt_pk_bf16_f32 v114, v100, v101
    v_cvt_pk_bf16_f32 v115, v102, v103
    v_mfma_f32_32x32x16_bf16 v[48:63], v[168:171], v[116:119], v[48:63]
    v_exp_f32 v104, v104
    v_exp_f32 v105, v105
    v_exp_f32 v106, v106
    v_exp_f32 v107, v107
    v_cvt_pk_bf16_f32 v116, v104, v105
    v_cvt_pk_bf16_f32 v117, v106, v107
    v_mfma_f32_32x32x16_bf16 v[64:79], v[164:167], v[112:115], v[64:79]
    v_exp_f32 v108, v108
    v_exp_f32 v109, v109
    v_exp_f32 v110, v110
    v_exp_f32 v111, v111
    v_cvt_pk_bf16_f32 v118, v108, v109
    v_cvt_pk_bf16_f32 v119, v110, v111
    v_mfma_f32_32x32x16_bf16 v[96:111], v[172:175], v[126:129], 0
    v_exp_f32 v80, v80
    v_exp_f32 v81, v81
    v_exp_f32 v82, v82
    v_exp_f32 v83, v83
    v_cvt_pk_bf16_f32 v112, v80, v81
    v_cvt_pk_bf16_f32 v113, v82, v83
    v_mfma_f32_32x32x8_bf16 v[96:111], v[176:177], v[130:131], v[96:111]
    v_exp_f32 v84, v84
    v_exp_f32 v85, v85
    v_exp_f32 v86, v86
    v_exp_f32 v87, v87
    v_cvt_pk_bf16_f32 v114, v84, v85
    v_cvt_pk_bf16_f32 v115, v86, v87
    v_mfma_f32_32x32x16_bf16 v[64:79], v[168:171], v[116:119], v[64:79]
    v_exp_f32 v88, v88
    v_exp_f32 v89, v89
    v_exp_f32 v90, v90
    v_exp_f32 v91, v91
    v_cvt_pk_bf16_f32 v116, v88, v89
    v_cvt_pk_bf16_f32 v117, v90, v91
    s_waitcnt vmcnt(8)
    v_mfma_f32_32x32x16_bf16 v[16:31], v[178:181], v[112:115], v[16:31]
    v_exp_f32 v92, v92
    v_exp_f32 v93, v93
    v_exp_f32 v94, v94
    v_exp_f32 v95, v95
    v_cvt_pk_bf16_f32 v118, v92, v93
    v_cvt_pk_bf16_f32 v119, v94, v95
    v_mfma_f32_32x32x16_bf16 v[80:95], v[172:175], v[132:135], 0
    v_exp_f32 v96, v96
    v_exp_f32 v97, v97
    v_exp_f32 v98, v98
    v_exp_f32 v99, v99
    v_cvt_pk_bf16_f32 v112, v96, v97
    v_cvt_pk_bf16_f32 v113, v98, v99
    v_mfma_f32_32x32x8_bf16 v[80:95], v[176:177], v[136:137], v[80:95]
    v_exp_f32 v100, v100
    v_exp_f32 v101, v101
    v_exp_f32 v102, v102
    v_exp_f32 v103, v103
    v_cvt_pk_bf16_f32 v114, v100, v101
    v_cvt_pk_bf16_f32 v115, v102, v103
    v_mfma_f32_32x32x16_bf16 v[16:31], v[182:185], v[116:119], v[16:31]
    v_exp_f32 v104, v104
    v_exp_f32 v105, v105
    v_exp_f32 v106, v106
    v_exp_f32 v107, v107
    v_cvt_pk_bf16_f32 v116, v104, v105
    v_cvt_pk_bf16_f32 v117, v106, v107
    v_mfma_f32_32x32x16_bf16 v[32:47], v[178:181], v[112:115], v[32:47]
    v_exp_f32 v108, v108
    v_exp_f32 v109, v109
    v_exp_f32 v110, v110
    v_exp_f32 v111, v111
    v_cvt_pk_bf16_f32 v118, v108, v109
    v_cvt_pk_bf16_f32 v119, v110, v111
    v_mfma_f32_32x32x16_bf16 v[96:111], v[172:175], v[138:141], 0
    v_exp_f32 v80, v80
    v_exp_f32 v81, v81
    v_exp_f32 v82, v82
    v_exp_f32 v83, v83
    v_cvt_pk_bf16_f32 v112, v80, v81
    v_cvt_pk_bf16_f32 v113, v82, v83
    v_mfma_f32_32x32x8_bf16 v[96:111], v[176:177], v[142:143], v[96:111]
    v_exp_f32 v84, v84
    v_exp_f32 v85, v85
    v_exp_f32 v86, v86
    v_exp_f32 v87, v87
    v_cvt_pk_bf16_f32 v114, v84, v85
    v_cvt_pk_bf16_f32 v115, v86, v87
    v_mfma_f32_32x32x16_bf16 v[32:47], v[182:185], v[116:119], v[32:47]
    v_exp_f32 v88, v88
    v_exp_f32 v89, v89
    v_exp_f32 v90, v90
    v_exp_f32 v91, v91
    v_cvt_pk_bf16_f32 v116, v88, v89
    v_cvt_pk_bf16_f32 v117, v90, v91
    v_mfma_f32_32x32x16_bf16 v[48:63], v[178:181], v[112:115], v[48:63]
    v_exp_f32 v92, v92
    v_exp_f32 v93, v93
    v_exp_f32 v94, v94
    v_exp_f32 v95, v95
    v_cvt_pk_bf16_f32 v118, v92, v93
    v_cvt_pk_bf16_f32 v119, v94, v95
    s_waitcnt vmcnt(4)
    v_mfma_f32_32x32x16_bf16 v[80:95], v[144:147], v[120:123], 0
    v_exp_f32 v96, v96
    v_exp_f32 v97, v97
    v_exp_f32 v98, v98
    v_exp_f32 v99, v99
    v_cvt_pk_bf16_f32 v112, v96, v97
    v_cvt_pk_bf16_f32 v113, v98, v99
    v_mfma_f32_32x32x8_bf16 v[80:95], v[148:149], v[124:125], v[80:95]
    v_exp_f32 v100, v100
    v_exp_f32 v101, v101
    v_exp_f32 v102, v102
    v_exp_f32 v103, v103
    v_cvt_pk_bf16_f32 v114, v100, v101
    v_cvt_pk_bf16_f32 v115, v102, v103
    v_mfma_f32_32x32x16_bf16 v[48:63], v[182:185], v[116:119], v[48:63]
    v_exp_f32 v104, v104
    v_exp_f32 v105, v105
    v_exp_f32 v106, v106
    v_exp_f32 v107, v107
    v_cvt_pk_bf16_f32 v116, v104, v105
    v_cvt_pk_bf16_f32 v117, v106, v107
    v_mfma_f32_32x32x16_bf16 v[64:79], v[178:181], v[112:115], v[64:79]
    v_exp_f32 v108, v108
    v_exp_f32 v109, v109
    v_exp_f32 v110, v110
    v_exp_f32 v111, v111
    v_cvt_pk_bf16_f32 v118, v108, v109
    v_cvt_pk_bf16_f32 v119, v110, v111
    s_setprio 0
    v_mfma_f32_32x32x16_bf16 v[96:111], v[144:147], v[126:129], 0
    v_exp_f32 v80, v80
    v_exp_f32 v81, v81
    v_exp_f32 v82, v82
    v_exp_f32 v83, v83
    v_cvt_pk_bf16_f32 v112, v80, v81
    v_cvt_pk_bf16_f32 v113, v82, v83
    v_mfma_f32_32x32x8_bf16 v[96:111], v[148:149], v[130:131], v[96:111]
    v_exp_f32 v84, v84
    v_exp_f32 v85, v85
    v_exp_f32 v86, v86
    v_exp_f32 v87, v87
    v_cvt_pk_bf16_f32 v114, v84, v85
    v_cvt_pk_bf16_f32 v115, v86, v87
    v_mfma_f32_32x32x16_bf16 v[64:79], v[182:185], v[116:119], v[64:79]
    v_exp_f32 v88, v88
    v_exp_f32 v89, v89
    v_exp_f32 v90, v90
    v_exp_f32 v91, v91
    v_cvt_pk_bf16_f32 v116, v88, v89
    v_cvt_pk_bf16_f32 v117, v90, v91
    s_waitcnt vmcnt(2)
    v_mfma_f32_32x32x16_bf16 v[16:31], v[150:153], v[112:115], v[16:31]
    v_exp_f32 v92, v92
    v_exp_f32 v93, v93
    v_exp_f32 v94, v94
    v_exp_f32 v95, v95
    v_cvt_pk_bf16_f32 v118, v92, v93
    v_cvt_pk_bf16_f32 v119, v94, v95
    v_mfma_f32_32x32x16_bf16 v[80:95], v[144:147], v[132:135], 0
    v_exp_f32 v96, v96
    v_exp_f32 v97, v97
    v_exp_f32 v98, v98
    v_exp_f32 v99, v99
    v_cvt_pk_bf16_f32 v112, v96, v97
    v_cvt_pk_bf16_f32 v113, v98, v99
    v_mfma_f32_32x32x8_bf16 v[80:95], v[148:149], v[136:137], v[80:95]
    v_exp_f32 v100, v100
    v_exp_f32 v101, v101
    v_exp_f32 v102, v102
    v_exp_f32 v103, v103
    v_cvt_pk_bf16_f32 v114, v100, v101
    v_cvt_pk_bf16_f32 v115, v102, v103
    v_mfma_f32_32x32x16_bf16 v[16:31], v[154:157], v[116:119], v[16:31]
    v_exp_f32 v104, v104
    v_exp_f32 v105, v105
    v_exp_f32 v106, v106
    v_exp_f32 v107, v107
    v_cvt_pk_bf16_f32 v116, v104, v105
    v_cvt_pk_bf16_f32 v117, v106, v107
    v_mfma_f32_32x32x16_bf16 v[32:47], v[150:153], v[112:115], v[32:47]
    v_exp_f32 v108, v108
    v_exp_f32 v109, v109
    v_exp_f32 v110, v110
    v_exp_f32 v111, v111
    v_cvt_pk_bf16_f32 v118, v108, v109
    v_cvt_pk_bf16_f32 v119, v110, v111
    v_mfma_f32_32x32x16_bf16 v[96:111], v[144:147], v[138:141], 0
    v_exp_f32 v80, v80
    v_exp_f32 v81, v81
    v_exp_f32 v82, v82
    v_exp_f32 v83, v83
    v_cvt_pk_bf16_f32 v112, v80, v81
    v_cvt_pk_bf16_f32 v113, v82, v83
    v_mfma_f32_32x32x8_bf16 v[96:111], v[148:149], v[142:143], v[96:111]
    v_exp_f32 v84, v84
    v_exp_f32 v85, v85
    v_exp_f32 v86, v86
    v_exp_f32 v87, v87
    v_cvt_pk_bf16_f32 v114, v84, v85
    v_cvt_pk_bf16_f32 v115, v86, v87
    v_mfma_f32_32x32x16_bf16 v[32:47], v[154:157], v[116:119], v[32:47]
    v_exp_f32 v88, v88
    v_exp_f32 v89, v89
    v_exp_f32 v90, v90
    v_exp_f32 v91, v91
    v_cvt_pk_bf16_f32 v116, v88, v89
    v_cvt_pk_bf16_f32 v117, v90, v91
    v_mfma_f32_32x32x16_bf16 v[48:63], v[150:153], v[112:115], v[48:63]
    v_exp_f32 v92, v92
    v_exp_f32 v93, v93
    v_exp_f32 v94, v94
    v_exp_f32 v95, v95
    v_cvt_pk_bf16_f32 v118, v92, v93
    v_cvt_pk_bf16_f32 v119, v94, v95
    v_exp_f32 v96, v96
    v_exp_f32 v97, v97
    v_exp_f32 v98, v98
    v_exp_f32 v99, v99
    v_cvt_pk_bf16_f32 v112, v96, v97
    v_cvt_pk_bf16_f32 v113, v98, v99
    v_exp_f32 v100, v100
    v_exp_f32 v101, v101
    v_exp_f32 v102, v102
    v_exp_f32 v103, v103
    v_cvt_pk_bf16_f32 v114, v100, v101
    v_cvt_pk_bf16_f32 v115, v102, v103
    v_mfma_f32_32x32x16_bf16 v[48:63], v[154:157], v[116:119], v[48:63]
    v_exp_f32 v104, v104
    v_exp_f32 v105, v105
    v_exp_f32 v106, v106
    v_exp_f32 v107, v107
    v_cvt_pk_bf16_f32 v116, v104, v105
    v_cvt_pk_bf16_f32 v117, v106, v107
    v_mfma_f32_32x32x16_bf16 v[64:79], v[150:153], v[112:115], v[64:79]
    v_exp_f32 v108, v108
    v_exp_f32 v109, v109
    v_exp_f32 v110, v110
    v_exp_f32 v111, v111
    v_cvt_pk_bf16_f32 v118, v108, v109
    v_cvt_pk_bf16_f32 v119, v110, v111
    s_nop 1
    v_mfma_f32_32x32x16_bf16 v[64:79], v[154:157], v[116:119], v[64:79]
    s_nop 11
    s_cmp_lg_u32 s14, 0
    s_cbranch_scc1 K2_CMB1
    ds_write_b128 v1, v[32:35] offset:7680
    ds_write_b128 v1, v[36:39] offset:8704
    ds_write_b128 v1, v[48:51] offset:15360
    ds_write_b128 v1, v[52:55] offset:16384
    ds_write_b128 v1, v[64:67] offset:23040
    ds_write_b128 v1, v[68:71] offset:24064
    s_mov_b64 exec, s[72:73]
    ds_write_b128 v1, v[40:43] offset:9728
    ds_write_b128 v1, v[56:59] offset:17408
    ds_write_b128 v1, v[72:75] offset:25088
    s_mov_b64 exec, -1
    v_mov_b32 v144, v16
    v_mov_b32 v145, v17
    v_mov_b32 v146, v18
    v_mov_b32 v147, v19
    v_mov_b32 v148, v20
    v_mov_b32 v149, v21
    v_mov_b32 v150, v22
    v_mov_b32 v151, v23
    v_mov_b32 v152, v24
    v_mov_b32 v153, v25
    v_mov_b32 v154, v26
    s_branch K2_CMBD
K2_CMB1:
    s_cmp_lg_u32 s14, 1
    s_cbranch_scc1 K2_CMB2
    ds_write_b128 v1, v[16:19] offset:0
    ds_write_b128 v1, v[20:23] offset:1024
    ds_write_b128 v1, v[48:51] offset:17920
    ds_write_b128 v1, v[52:55] offset:18944
    ds_write_b128 v1, v[64:67] offset:25600
    ds_write_b128 v1, v[68:71] offset:26624
    s_mov_b64 exec, s[72:73]
    ds_write_b128 v1, v[24:27] offset:2048
    ds_write_b128 v1, v[56:59] offset:19968
    ds_write_b128 v1, v[72:75] offset:27648
    s_mov_b64 exec, -1
    v_mov_b32 v144, v32
    v_mov_b32 v145, v33
    v_mov_b32 v146, v34
    v_mov_b32 v147, v35
    v_mov_b32 v148, v36
    v_mov_b32 v149, v37
    v_mov_b32 v150, v38
    v_mov_b32 v151, v39
    v_mov_b32 v152, v40
    v_mov_b32 v153, v41
    v_mov_b32 v154, v42
    s_branch K2_CMBD
K2_CMB2:
    s_cmp_lg_u32 s14, 2
    s_cbranch_scc1 K2_CMB3
    ds_write_b128 v1, v[16:19] offset:2560
    ds_write_b128 v1, v[20:23] offset:3584
    ds_write_b128 v1, v[32:35] offset:10240
    ds_write_b128 v1, v[36:39] offset:11264
    ds_write_b128 v1, v[64:67] offset:28160
    ds_write_b128 v1, v[68:71] offset:29184
    s_mov_b64 exec, s[72:73]
    ds_write_b128 v1, v[24:27] offset:4608
    ds_write_b128 v1, v[40:43] offset:12288
    ds_write_b128 v1, v[72:75] offset:30208
    s_mov_b64 exec, -1
    v_mov_b32 v144, v48
    v_mov_b32 v145, v49
    v_mov_b32 v146, v50
    v_mov_b32 v147, v51
    v_mov_b32 v148, v52
    v_mov_b32 v149, v53
    v_mov_b32 v150, v54
    v_mov_b32 v151, v55
    v_mov_b32 v152, v56
    v_mov_b32 v153, v57
    v_mov_b32 v154, v58
    s_branch K2_CMBD
K2_CMB3:
    ds_write_b128 v1, v[16:19] offset:5120
    ds_write_b128 v1, v[20:23] offset:6144
    ds_write_b128 v1, v[32:35] offset:12800
    ds_write_b128 v1, v[36:39] offset:13824
    ds_write_b128 v1, v[48:51] offset:20480
    ds_write_b128 v1, v[52:55] offset:21504
    s_mov_b64 exec, s[72:73]
    ds_write_b128 v1, v[24:27] offset:7168
    ds_write_b128 v1, v[40:43] offset:14848
    ds_write_b128 v1, v[56:59] offset:22528
    s_mov_b64 exec, -1
    v_mov_b32 v144, v64
    v_mov_b32 v145, v65
    v_mov_b32 v146, v66
    v_mov_b32 v147, v67
    v_mov_b32 v148, v68
    v_mov_b32 v149, v69
    v_mov_b32 v150, v70
    v_mov_b32 v151, v71
    v_mov_b32 v152, v72
    v_mov_b32 v153, v73
    v_mov_b32 v154, v74
K2_CMBD:
    s_waitcnt lgkmcnt(0)
    s_barrier
    ds_read_b128 v[156:159], v8 offset:0
    ds_read_b128 v[160:163], v8 offset:1024
    ds_read_b128 v[168:171], v8 offset:2560
    ds_read_b128 v[172:175], v8 offset:3584
    ds_read_b128 v[16:19], v8 offset:5120
    ds_read_b128 v[20:23], v8 offset:6144
    s_mov_b64 exec, s[72:73]
    ds_read_b128 v[164:167], v8 offset:2048
    ds_read_b128 v[176:179], v8 offset:4608
    ds_read_b128 v[24:27], v8 offset:7168
    s_mov_b64 exec, -1
    s_waitcnt lgkmcnt(5)
    v_add_f32 v144, v144, v156
    v_add_f32 v145, v145, v157
    v_add_f32 v146, v146, v158
    v_add_f32 v147, v147, v159
    v_add_f32 v148, v148, v160
    v_add_f32 v149, v149, v161
    v_add_f32 v150, v150, v162
    v_add_f32 v151, v151, v163
    s_waitcnt lgkmcnt(3)
    v_add_f32 v168, v168, v16
    v_add_f32 v169, v169, v17
    v_add_f32 v170, v170, v18
    v_add_f32 v171, v171, v19
    v_add_f32 v172, v172, v20
    v_add_f32 v173, v173, v21
    v_add_f32 v174, v174, v22
    v_add_f32 v175, v175, v23
    v_add_f32 v144, v144, v168
    v_add_f32 v145, v145, v169
    v_add_f32 v146, v146, v170
    v_add_f32 v147, v147, v171
    v_add_f32 v148, v148, v172
    v_add_f32 v149, v149, v173
    v_add_f32 v150, v150, v174
    v_add_f32 v151, v151, v175
    s_waitcnt lgkmcnt(0)
    s_mov_b64 exec, s[72:73]
    v_add_f32 v152, v152, v164
    v_add_f32 v176, v176, v24
    v_add_f32 v153, v153, v165
    v_add_f32 v177, v177, v25
    v_add_f32 v154, v154, v166
    v_add_f32 v178, v178, v26
    v_add_f32 v152, v152, v176
    v_add_f32 v153, v153, v177
    v_add_f32 v154, v154, v178
    s_mov_b64 exec, -1
    v_mov_b32 v9, v154
    v_mov_b32 v10, v154
    s_nop 1
    v_permlane32_swap_b32 v9, v10
    v_add_f32 v11, |v144|, |v145|
    v_add_f32 v11, v11, |v146|
    v_add_f32 v11, v11, |v147|
    v_add_f32 v11, v11, |v148|
    v_add_f32 v11, v11, |v149|
    v_add_f32 v11, v11, |v150|
    v_add_f32 v11, v11, |v151|
    v_add_f32 v11, v11, |v152|
    v_add_f32 v11, v11, |v153|
    s_mov_b32 s37, 0x1f800000
    s_mov_b32 s38, 0x5f800000
    v_cmp_le_f32 s[78:79], s37, v9
    v_cmp_ge_f32 s[80:81], s38, v9
    s_mov_b32 s37, 0x7e800000
    v_cmp_gt_f32 s[6:7], s37, v11
    v_rcp_f32 v9, v9
    s_nop 3
    s_and_b64 s[78:79], s[78:79], s[80:81]
    s_and_b64 s[78:79], s[78:79], s[6:7]
    s_cmp_eq_u64 s[78:79], -1
    s_cselect_b32 s39, 0, 1
    v_mul_f32 v144, v144, v9
    v_mul_f32 v145, v145, v9
    v_mul_f32 v146, v146, v9
    v_mul_f32 v147, v147, v9
    v_mul_f32 v148, v148, v9
    v_mul_f32 v149, v149, v9
    v_mul_f32 v150, v150, v9
    v_mul_f32 v151, v151, v9
    v_mul_f32 v152, v152, v9
    v_mul_f32 v153, v153, v9
    v_cvt_pk_bf16_f32 v10, v152, v153
    v_cvt_pk_bf16_f32 v12, v144, v145
    v_cvt_pk_bf16_f32 v13, v146, v147
    v_cvt_pk_bf16_f32 v14, v148, v149
    v_cvt_pk_bf16_f32 v15, v150, v151
    buffer_store_dword v10, v6, s[8:11], s29 offen sc1
    buffer_store_dwordx4 v[12:15], v5, s[8:11], s29 offen sc1
    s_cmp_lg_u32 s15, 0
    s_cbranch_scc1 K2_FIN
    v_mov_b32 v9, s39
    s_lshl_b32 s37, s14, 2
    s_add_u32 s37, s37, 49152
    v_mov_b32 v10, s37
    ds_write_b32 v10, v9
    v_mov_b32 v10, 0xf149f2ca
    v_cndmask_b32 v144, v10, 0, s[40:41]
    v_cndmask_b32 v145, v10, 0, s[42:43]
    v_cndmask_b32 v146, v10, 0, s[44:45]
    v_cndmask_b32 v147, v10, 0, s[46:47]
    v_cndmask_b32 v148, v10, 0, s[48:49]
    v_cndmask_b32 v149, v10, 0, s[50:51]
    v_cndmask_b32 v150, v10, 0, s[52:53]
    v_cndmask_b32 v151, v10, 0, s[54:55]
    v_cndmask_b32 v152, v10, 0, s[56:57]
    v_cndmask_b32 v153, v10, 0, s[58:59]
    v_cndmask_b32 v154, v10, 0, s[60:61]
    v_cndmask_b32 v155, v10, 0, s[62:63]
    v_cndmask_b32 v156, v10, 0, s[64:65]
    v_cndmask_b32 v157, v10, 0, s[66:67]
    v_cndmask_b32 v158, v10, 0, s[68:69]
    v_cndmask_b32 v159, v10, 0, s[70:71]
    v_xor_b32 v160, v10, v144
    v_xor_b32 v161, v10, v145
    v_xor_b32 v162, v10, v146
    v_xor_b32 v163, v10, v147
    v_xor_b32 v164, v10, v148
    v_xor_b32 v165, v10, v149
    v_xor_b32 v166, v10, v150
    v_xor_b32 v167, v10, v151
    v_xor_b32 v168, v10, v152
    v_xor_b32 v169, v10, v153
    v_xor_b32 v170, v10, v154
    v_xor_b32 v171, v10, v155
    v_xor_b32 v172, v10, v156
    v_xor_b32 v173, v10, v157
    v_xor_b32 v174, v10, v158
    v_xor_b32 v175, v10, v159
    v_mov_b32 v9, 0x3f803f80
    v_mov_b32 v10, 0x3f80
    v_cndmask_b32 v191, v10, 0, s[72:73]
    v_cndmask_b32 v197, 0, v9, s[72:73]
    v_cndmask_b32 v203, 0, v9, s[72:73]
    v_cndmask_b32 v209, 0, v9, s[72:73]
    v_cndmask_b32 v215, 0, v9, s[72:73]
    v_cndmask_b32 v221, 0, v9, s[72:73]
    v_cndmask_b32 v227, 0, v9, s[72:73]
    v_cndmask_b32 v233, 0, v9, s[72:73]
    v_cndmask_b32 v239, 0, v9, s[72:73]
    v_cndmask_b32 v245, 0, v9, s[72:73]
    s_cmp_ge_i32 s31, 0
    s_cbranch_scc1 K2_B_VALID
    s_add_i32 s37, s31, 0
    s_cmp_lt_i32 s37, 0
    s_cselect_b32 s37, 0xf14a, 0
    v_mov_b32 v10, s37
    v_cndmask_b32 v197, v10, v9, s[72:73]
    s_add_i32 s37, s31, 1
    s_cmp_lt_i32 s37, 0
    s_cselect_b32 s37, 0xf14a, 0
    v_mov_b32 v10, s37
    v_cndmask_b32 v203, v10, v9, s[72:73]
    s_add_i32 s37, s31, 2
    s_cmp_lt_i32 s37, 0
    s_cselect_b32 s37, 0xf14a, 0
    v_mov_b32 v10, s37
    v_cndmask_b32 v209, v10, v9, s[72:73]
    s_add_i32 s37, s31, 3
    s_cmp_lt_i32 s37, 0
    s_cselect_b32 s37, 0xf14a, 0
    v_mov_b32 v10, s37
    v_cndmask_b32 v215, v10, v9, s[72:73]
    s_add_i32 s37, s31, 4
    s_cmp_lt_i32 s37, 0
    s_cselect_b32 s37, 0xf14a, 0
    v_mov_b32 v10, s37
    v_cndmask_b32 v221, v10, v9, s[72:73]
    s_add_i32 s37, s31, 5
    s_cmp_lt_i32 s37, 0
    s_cselect_b32 s37, 0xf14a, 0
    v_mov_b32 v10, s37
    v_cndmask_b32 v227, v10, v9, s[72:73]
    s_add_i32 s37, s31, 6
    s_cmp_lt_i32 s37, 0
    s_cselect_b32 s37, 0xf14a, 0
    v_mov_b32 v10, s37
    v_cndmask_b32 v233, v10, v9, s[72:73]
    s_add_i32 s37, s31, 7
    s_cmp_lt_i32 s37, 0
    s_cselect_b32 s37, 0xf14a, 0
    v_mov_b32 v10, s37
    v_cndmask_b32 v239, v10, v9, s[72:73]
K2_B_VALID:
    s_waitcnt vmcnt(2)
    v_mfma_f32_32x32x16_bf16 v[80:95], v[192:195], v[186:189], v[160:175]
    v_mfma_f32_32x32x8_bf16 v[80:95], v[196:197], v[190:191], v[80:95]
    v_mfma_f32_32x32x16_bf16 v[96:111], v[198:201], v[186:189], 0
    v_mfma_f32_32x32x8_bf16 v[96:111], v[202:203], v[190:191], v[96:111]
    s_nop 9
    v_max_f32 v9, v80, v81
    v_max_f32 v10, v82, v83
    v_max3_f32 v9, v9, v84, v85
    v_max3_f32 v10, v10, v86, v87
    v_max3_f32 v9, v9, v88, v89
    v_max3_f32 v10, v10, v90, v91
    v_max3_f32 v9, v9, v92, v93
    v_max3_f32 v10, v10, v94, v95
    v_mfma_f32_32x32x16_bf16 v[80:95], v[204:207], v[186:189], 0
    v_mfma_f32_32x32x8_bf16 v[80:95], v[208:209], v[190:191], v[80:95]
    s_nop 1
    v_max3_f32 v9, v9, v96, v97
    v_max3_f32 v10, v10, v98, v99
    v_max3_f32 v9, v9, v100, v101
    v_max3_f32 v10, v10, v102, v103
    v_max3_f32 v9, v9, v104, v105
    v_max3_f32 v10, v10, v106, v107
    v_max3_f32 v9, v9, v108, v109
    v_max3_f32 v10, v10, v110, v111
    v_mfma_f32_32x32x16_bf16 v[96:111], v[210:213], v[186:189], 0
    v_mfma_f32_32x32x8_bf16 v[96:111], v[214:215], v[190:191], v[96:111]
    s_nop 1
    v_max3_f32 v9, v9, v80, v81
    v_max3_f32 v10, v10, v82, v83
    v_max3_f32 v9, v9, v84, v85
    v_max3_f32 v10, v10, v86, v87
    v_max3_f32 v9, v9, v88, v89
    v_max3_f32 v10, v10, v90, v91
    v_max3_f32 v9, v9, v92, v93
    v_max3_f32 v10, v10, v94, v95
    v_mfma_f32_32x32x16_bf16 v[80:95], v[216:219], v[186:189], 0
    v_mfma_f32_32x32x8_bf16 v[80:95], v[220:221], v[190:191], v[80:95]
    s_nop 1
    v_max3_f32 v9, v9, v96, v97
    v_max3_f32 v10, v10, v98, v99
    v_max3_f32 v9, v9, v100, v101
    v_max3_f32 v10, v10, v102, v103
    v_max3_f32 v9, v9, v104, v105
    v_max3_f32 v10, v10, v106, v107
    v_max3_f32 v9, v9, v108, v109
    v_max3_f32 v10, v10, v110, v111
    v_mfma_f32_32x32x16_bf16 v[96:111], v[222:225], v[186:189], 0
    v_mfma_f32_32x32x8_bf16 v[96:111], v[226:227], v[190:191], v[96:111]
    s_nop 1
    v_max3_f32 v9, v9, v80, v81
    v_max3_f32 v10, v10, v82, v83
    v_max3_f32 v9, v9, v84, v85
    v_max3_f32 v10, v10, v86, v87
    v_max3_f32 v9, v9, v88, v89
    v_max3_f32 v10, v10, v90, v91
    v_max3_f32 v9, v9, v92, v93
    v_max3_f32 v10, v10, v94, v95
    v_mfma_f32_32x32x16_bf16 v[80:95], v[228:231], v[186:189], 0
    v_mfma_f32_32x32x8_bf16 v[80:95], v[232:233], v[190:191], v[80:95]
    s_nop 1
    v_max3_f32 v9, v9, v96, v97
    v_max3_f32 v10, v10, v98, v99
    v_max3_f32 v9, v9, v100, v101
    v_max3_f32 v10, v10, v102, v103
    v_max3_f32 v9, v9, v104, v105
    v_max3_f32 v10, v10, v106, v107
    v_max3_f32 v9, v9, v108, v109
    v_max3_f32 v10, v10, v110, v111
    v_mfma_f32_32x32x16_bf16 v[96:111], v[234:237], v[186:189], 0
    v_mfma_f32_32x32x8_bf16 v[96:111], v[238:239], v[190:191], v[96:111]
    s_nop 1
    v_max3_f32 v9, v9, v80, v81
    v_max3_f32 v10, v10, v82, v83
    v_max3_f32 v9, v9, v84, v85
    v_max3_f32 v10, v10, v86, v87
    v_max3_f32 v9, v9, v88, v89
    v_max3_f32 v10, v10, v90, v91
    v_max3_f32 v9, v9, v92, v93
    v_max3_f32 v10, v10, v94, v95
    v_mfma_f32_32x32x16_bf16 v[80:95], v[240:243], v[186:189], v[144:159]
    v_mfma_f32_32x32x8_bf16 v[80:95], v[244:245], v[190:191], v[80:95]
    s_nop 1
    v_max3_f32 v9, v9, v96, v97
    v_max3_f32 v10, v10, v98, v99
    v_max3_f32 v9, v9, v100, v101
    v_max3_f32 v10, v10, v102, v103
    v_max3_f32 v9, v9, v104, v105
    v_max3_f32 v10, v10, v106, v107
    v_max3_f32 v9, v9, v108, v109
    v_max3_f32 v10, v10, v110, v111
    s_nop 3
    v_max3_f32 v9, v9, v80, v81
    v_max3_f32 v10, v10, v82, v83
    v_max3_f32 v9, v9, v84, v85
    v_max3_f32 v10, v10, v86, v87
    v_max3_f32 v9, v9, v88, v89
    v_max3_f32 v10, v10, v90, v91
    v_max3_f32 v9, v9, v92, v93
    v_max3_f32 v10, v10, v94, v95
    v_max_f32 v9, v9, v10
    v_mov_b32 v10, v9
    s_nop 1
    v_permlane32_swap_b32 v9, v10
    v_max_f32 v9, v9, v10
    v_sub_f32 v11, 0, v9
    v_and_b32 v12, 0xffff0000, v11
    v_sub_f32 v11, v11, v12
    v_cvt_pk_bf16_f32 v11, v12, v11
    v_cndmask_b32 v191, v191, v11, s[72:73]
    s_nop 1
    v_and_b32 v13, 31, v0
    v_lshrrev_b32 v14, 5, v0
    v_mul_u32_u24 v14, 304, v14
    v_lshl_add_u32 v13, v13, 4, v14
    s_add_i32 s37, s31, 0
    s_max_i32 s37, s37, 0
    s_sub_u32 s37, s37, s74
    s_mul_i32 s37, s37, 1216
    s_add_u32 s37, s37, 49280
    v_add_u32 v14, s37, v13
    ds_read_b128 v[16:19], v14
    ds_read_b128 v[20:23], v14 offset:608
    v_mfma_f32_32x32x16_bf16 v[80:95], v[192:195], v[186:189], v[160:175]
    v_mfma_f32_32x32x8_bf16 v[80:95], v[196:197], v[190:191], v[80:95]
    s_nop 11
    v_mfma_f32_32x32x16_bf16 v[96:111], v[198:201], v[186:189], 0
    v_exp_f32 v80, v80
    v_exp_f32 v81, v81
    v_exp_f32 v82, v82
    v_exp_f32 v83, v83
    v_cvt_pk_bf16_f32 v112, v80, v81
    v_cvt_pk_bf16_f32 v113, v82, v83
    v_mfma_f32_32x32x8_bf16 v[96:111], v[202:203], v[190:191], v[96:111]
    v_exp_f32 v84, v84
    v_exp_f32 v85, v85
    v_exp_f32 v86, v86
    v_exp_f32 v87, v87
    v_cvt_pk_bf16_f32 v114, v84, v85
    v_cvt_pk_bf16_f32 v115, v86, v87
    v_exp_f32 v88, v88
    v_exp_f32 v89, v89
    v_exp_f32 v90, v90
    v_exp_f32 v91, v91
    v_cvt_pk_bf16_f32 v116, v88, v89
    v_cvt_pk_bf16_f32 v117, v90, v91
    s_waitcnt lgkmcnt(0)
    v_mfma_f32_32x32x16_bf16 v[128:143], v[16:19], v[112:115], 0
    s_add_i32 s37, s31, 1
    s_max_i32 s37, s37, 0
    s_sub_u32 s37, s37, s74
    s_mul_i32 s37, s37, 1216
    s_add_u32 s37, s37, 49280
    v_add_u32 v14, s37, v13
    ds_read_b128 v[24:27], v14
    ds_read_b128 v[28:31], v14 offset:608
    v_exp_f32 v92, v92
    v_exp_f32 v93, v93
    v_exp_f32 v94, v94
    v_exp_f32 v95, v95
    v_cvt_pk_bf16_f32 v118, v92, v93
    v_cvt_pk_bf16_f32 v119, v94, v95
    v_mfma_f32_32x32x16_bf16 v[80:95], v[204:207], v[186:189], 0
    v_exp_f32 v96, v96
    v_exp_f32 v97, v97
    v_exp_f32 v98, v98
    v_exp_f32 v99, v99
    v_cvt_pk_bf16_f32 v112, v96, v97
    v_cvt_pk_bf16_f32 v113, v98, v99
    v_mfma_f32_32x32x8_bf16 v[80:95], v[208:209], v[190:191], v[80:95]
    v_exp_f32 v100, v100
    v_exp_f32 v101, v101
    v_exp_f32 v102, v102
    v_exp_f32 v103, v103
    v_cvt_pk_bf16_f32 v114, v100, v101
    v_cvt_pk_bf16_f32 v115, v102, v103
    v_mfma_f32_32x32x16_bf16 v[128:143], v[20:23], v[116:119], v[128:143]
    v_exp_f32 v104, v104
    v_exp_f32 v105, v105
    v_exp_f32 v106, v106
    v_exp_f32 v107, v107
    v_cvt_pk_bf16_f32 v116, v104, v105
    v_cvt_pk_bf16_f32 v117, v106, v107
    s_waitcnt lgkmcnt(0)
    v_mfma_f32_32x32x16_bf16 v[128:143], v[24:27], v[112:115], v[128:143]
    s_add_i32 s37, s31, 2
    s_max_i32 s37, s37, 0
    s_sub_u32 s37, s37, s74
    s_mul_i32 s37, s37, 1216
    s_add_u32 s37, s37, 49280
    v_add_u32 v14, s37, v13
    ds_read_b128 v[16:19], v14
    ds_read_b128 v[20:23], v14 offset:608
    v_exp_f32 v108, v108
    v_exp_f32 v109, v109
    v_exp_f32 v110, v110
    v_exp_f32 v111, v111
    v_cvt_pk_bf16_f32 v118, v108, v109
    v_cvt_pk_bf16_f32 v119, v110, v111
    v_mfma_f32_32x32x16_bf16 v[96:111], v[210:213], v[186:189], 0
    v_exp_f32 v80, v80
    v_exp_f32 v81, v81
    v_exp_f32 v82, v82
    v_exp_f32 v83, v83
    v_cvt_pk_bf16_f32 v112, v80, v81
    v_cvt_pk_bf16_f32 v113, v82, v83
    v_mfma_f32_32x32x8_bf16 v[96:111], v[214:215], v[190:191], v[96:111]
    v_exp_f32 v84, v84
    v_exp_f32 v85, v85
    v_exp_f32 v86, v86
    v_exp_f32 v87, v87
    v_cvt_pk_bf16_f32 v114, v84, v85
    v_cvt_pk_bf16_f32 v115, v86, v87
    v_mfma_f32_32x32x16_bf16 v[128:143], v[28:31], v[116:119], v[128:143]
    v_exp_f32 v88, v88
    v_exp_f32 v89, v89
    v_exp_f32 v90, v90
    v_exp_f32 v91, v91
    v_cvt_pk_bf16_f32 v116, v88, v89
    v_cvt_pk_bf16_f32 v117, v90, v91
    s_waitcnt lgkmcnt(0)
    v_mfma_f32_32x32x16_bf16 v[128:143], v[16:19], v[112:115], v[128:143]
    s_add_i32 s37, s31, 3
    s_max_i32 s37, s37, 0
    s_sub_u32 s37, s37, s74
    s_mul_i32 s37, s37, 1216
    s_add_u32 s37, s37, 49280
    v_add_u32 v14, s37, v13
    ds_read_b128 v[24:27], v14
    ds_read_b128 v[28:31], v14 offset:608
    v_exp_f32 v92, v92
    v_exp_f32 v93, v93
    v_exp_f32 v94, v94
    v_exp_f32 v95, v95
    v_cvt_pk_bf16_f32 v118, v92, v93
    v_cvt_pk_bf16_f32 v119, v94, v95
    v_mfma_f32_32x32x16_bf16 v[80:95], v[216:219], v[186:189], 0
    v_exp_f32 v96, v96
    v_exp_f32 v97, v97
    v_exp_f32 v98, v98
    v_exp_f32 v99, v99
    v_cvt_pk_bf16_f32 v112, v96, v97
    v_cvt_pk_bf16_f32 v113, v98, v99
    v_mfma_f32_32x32x8_bf16 v[80:95], v[220:221], v[190:191], v[80:95]
    v_exp_f32 v100, v100
    v_exp_f32 v101, v101
    v_exp_f32 v102, v102
    v_exp_f32 v103, v103
    v_cvt_pk_bf16_f32 v114, v100, v101
    v_cvt_pk_bf16_f32 v115, v102, v103
    v_mfma_f32_32x32x16_bf16 v[128:143], v[20:23], v[116:119], v[128:143]
    v_exp_f32 v104, v104
    v_exp_f32 v105, v105
    v_exp_f32 v106, v106
    v_exp_f32 v107, v107
    v_cvt_pk_bf16_f32 v116, v104, v105
    v_cvt_pk_bf16_f32 v117, v106, v107
    s_waitcnt lgkmcnt(0)
    v_mfma_f32_32x32x16_bf16 v[128:143], v[24:27], v[112:115], v[128:143]
    s_add_i32 s37, s31, 4
    s_max_i32 s37, s37, 0
    s_sub_u32 s37, s37, s74
    s_mul_i32 s37, s37, 1216
    s_add_u32 s37, s37, 49280
    v_add_u32 v14, s37, v13
    ds_read_b128 v[16:19], v14
    ds_read_b128 v[20:23], v14 offset:608
    v_exp_f32 v108, v108
    v_exp_f32 v109, v109
    v_exp_f32 v110, v110
    v_exp_f32 v111, v111
    v_cvt_pk_bf16_f32 v118, v108, v109
    v_cvt_pk_bf16_f32 v119, v110, v111
    v_mfma_f32_32x32x16_bf16 v[96:111], v[222:225], v[186:189], 0
    v_exp_f32 v80, v80
    v_exp_f32 v81, v81
    v_exp_f32 v82, v82
    v_exp_f32 v83, v83
    v_cvt_pk_bf16_f32 v112, v80, v81
    v_cvt_pk_bf16_f32 v113, v82, v83
    v_mfma_f32_32x32x8_bf16 v[96:111], v[226:227], v[190:191], v[96:111]
    v_exp_f32 v84, v84
    v_exp_f32 v85, v85
    v_exp_f32 v86, v86
    v_exp_f32 v87, v87
    v_cvt_pk_bf16_f32 v114, v84, v85
    v_cvt_pk_bf16_f32 v115, v86, v87
    v_mfma_f32_32x32x16_bf16 v[128:143], v[28:31], v[116:119], v[128:143]
    v_exp_f32 v88, v88
    v_exp_f32 v89, v89
    v_exp_f32 v90, v90
    v_exp_f32 v91, v91
    v_cvt_pk_bf16_f32 v116, v88, v89
    v_cvt_pk_bf16_f32 v117, v90, v91
    s_waitcnt lgkmcnt(0)
    v_mfma_f32_32x32x16_bf16 v[128:143], v[16:19], v[112:115], v[128:143]
    s_add_i32 s37, s31, 5
    s_max_i32 s37, s37, 0
    s_sub_u32 s37, s37, s74
    s_mul_i32 s37, s37, 1216
    s_add_u32 s37, s37, 49280
    v_add_u32 v14, s37, v13
    ds_read_b128 v[24:27], v14
    ds_read_b128 v[28:31], v14 offset:608
    v_exp_f32 v92, v92
    v_exp_f32 v93, v93
    v_exp_f32 v94, v94
    v_exp_f32 v95, v95
    v_cvt_pk_bf16_f32 v118, v92, v93
    v_cvt_pk_bf16_f32 v119, v94, v95
    v_mfma_f32_32x32x16_bf16 v[80:95], v[228:231], v[186:189], 0
    v_exp_f32 v96, v96
    v_exp_f32 v97, v97
    v_exp_f32 v98, v98
    v_exp_f32 v99, v99
    v_cvt_pk_bf16_f32 v112, v96, v97
    v_cvt_pk_bf16_f32 v113, v98, v99
    v_mfma_f32_32x32x8_bf16 v[80:95], v[232:233], v[190:191], v[80:95]
    v_exp_f32 v100, v100
    v_exp_f32 v101, v101
    v_exp_f32 v102, v102
    v_exp_f32 v103, v103
    v_cvt_pk_bf16_f32 v114, v100, v101
    v_cvt_pk_bf16_f32 v115, v102, v103
    v_mfma_f32_32x32x16_bf16 v[128:143], v[20:23], v[116:119], v[128:143]
    v_exp_f32 v104, v104
    v_exp_f32 v105, v105
    v_exp_f32 v106, v106
    v_exp_f32 v107, v107
    v_cvt_pk_bf16_f32 v116, v104, v105
    v_cvt_pk_bf16_f32 v117, v106, v107
    s_waitcnt lgkmcnt(0)
    v_mfma_f32_32x32x16_bf16 v[128:143], v[24:27], v[112:115], v[128:143]
    s_add_i32 s37, s31, 6
    s_max_i32 s37, s37, 0
    s_sub_u32 s37, s37, s74
    s_mul_i32 s37, s37, 1216
    s_add_u32 s37, s37, 49280
    v_add_u32 v14, s37, v13
    ds_read_b128 v[16:19], v14
    ds_read_b128 v[20:23], v14 offset:608
    v_exp_f32 v108, v108
    v_exp_f32 v109, v109
    v_exp_f32 v110, v110
    v_exp_f32 v111, v111
    v_cvt_pk_bf16_f32 v118, v108, v109
    v_cvt_pk_bf16_f32 v119, v110, v111
    v_mfma_f32_32x32x16_bf16 v[96:111], v[234:237], v[186:189], 0
    v_exp_f32 v80, v80
    v_exp_f32 v81, v81
    v_exp_f32 v82, v82
    v_exp_f32 v83, v83
    v_cvt_pk_bf16_f32 v112, v80, v81
    v_cvt_pk_bf16_f32 v113, v82, v83
    v_mfma_f32_32x32x8_bf16 v[96:111], v[238:239], v[190:191], v[96:111]
    v_exp_f32 v84, v84
    v_exp_f32 v85, v85
    v_exp_f32 v86, v86
    v_exp_f32 v87, v87
    v_cvt_pk_bf16_f32 v114, v84, v85
    v_cvt_pk_bf16_f32 v115, v86, v87
    v_mfma_f32_32x32x16_bf16 v[128:143], v[28:31], v[116:119], v[128:143]
    v_exp_f32 v88, v88
    v_exp_f32 v89, v89
    v_exp_f32 v90, v90
    v_exp_f32 v91, v91
    v_cvt_pk_bf16_f32 v116, v88, v89
    v_cvt_pk_bf16_f32 v117, v90, v91
    s_waitcnt lgkmcnt(0)
    v_mfma_f32_32x32x16_bf16 v[128:143], v[16:19], v[112:115], v[128:143]
    s_add_i32 s37, s31, 7
    s_max_i32 s37, s37, 0
    s_sub_u32 s37, s37, s74
    s_mul_i32 s37, s37, 1216
    s_add_u32 s37, s37, 49280
    v_add_u32 v14, s37, v13
    ds_read_b128 v[24:27], v14
    ds_read_b128 v[28:31], v14 offset:608
    v_exp_f32 v92, v92
    v_exp_f32 v93, v93
    v_exp_f32 v94, v94
    v_exp_f32 v95, v95
    v_cvt_pk_bf16_f32 v118, v92, v93
    v_cvt_pk_bf16_f32 v119, v94, v95
    v_mfma_f32_32x32x16_bf16 v[80:95], v[240:243], v[186:189], v[144:159]
    v_exp_f32 v96, v96
    v_exp_f32 v97, v97
    v_exp_f32 v98, v98
    v_exp_f32 v99, v99
    v_cvt_pk_bf16_f32 v112, v96, v97
    v_cvt_pk_bf16_f32 v113, v98, v99
    v_mfma_f32_32x32x8_bf16 v[80:95], v[244:245], v[190:191], v[80:95]
    v_exp_f32 v100, v100
    v_exp_f32 v101, v101
    v_exp_f32 v102, v102
    v_exp_f32 v103, v103
    v_cvt_pk_bf16_f32 v114, v100, v101
    v_cvt_pk_bf16_f32 v115, v102, v103
    v_mfma_f32_32x32x16_bf16 v[128:143], v[20:23], v[116:119], v[128:143]
    v_exp_f32 v104, v104
    v_exp_f32 v105, v105
    v_exp_f32 v106, v106
    v_exp_f32 v107, v107
    v_cvt_pk_bf16_f32 v116, v104, v105
    v_cvt_pk_bf16_f32 v117, v106, v107
    s_waitcnt lgkmcnt(0)
    v_mfma_f32_32x32x16_bf16 v[128:143], v[24:27], v[112:115], v[128:143]
    s_add_i32 s37, s31, 8
    s_max_i32 s37, s37, 0
    s_sub_u32 s37, s37, s74
    s_mul_i32 s37, s37, 1216
    s_add_u32 s37, s37, 49280
    v_add_u32 v14, s37, v13
    ds_read_b128 v[16:19], v14
    ds_read_b128 v[20:23], v14 offset:608
    v_exp_f32 v108, v108
    v_exp_f32 v109, v109
    v_exp_f32 v110, v110
    v_exp_f32 v111, v111
    v_cvt_pk_bf16_f32 v118, v108, v109
    v_cvt_pk_bf16_f32 v119, v110, v111
    v_exp_f32 v80, v80
    v_exp_f32 v81, v81
    v_exp_f32 v82, v82
    v_exp_f32 v83, v83
    v_cvt_pk_bf16_f32 v112, v80, v81
    v_cvt_pk_bf16_f32 v113, v82, v83
    v_exp_f32 v84, v84
    v_exp_f32 v85, v85
    v_exp_f32 v86, v86
    v_exp_f32 v87, v87
    v_cvt_pk_bf16_f32 v114, v84, v85
    v_cvt_pk_bf16_f32 v115, v86, v87
    v_mfma_f32_32x32x16_bf16 v[128:143], v[28:31], v[116:119], v[128:143]
    v_exp_f32 v88, v88
    v_exp_f32 v89, v89
    v_exp_f32 v90, v90
    v_exp_f32 v91, v91
    v_cvt_pk_bf16_f32 v116, v88, v89
    v_cvt_pk_bf16_f32 v117, v90, v91
    s_waitcnt lgkmcnt(0)
    v_mfma_f32_32x32x16_bf16 v[128:143], v[16:19], v[112:115], v[128:143]
    v_exp_f32 v92, v92
    v_exp_f32 v93, v93
    v_exp_f32 v94, v94
    v_exp_f32 v95, v95
    v_cvt_pk_bf16_f32 v118, v92, v93
    v_cvt_pk_bf16_f32 v119, v94, v95
    s_nop 1
    v_mfma_f32_32x32x16_bf16 v[128:143], v[20:23], v[116:119], v[128:143]
    s_nop 11
    v_mov_b32 v9, v138
    v_mov_b32 v10, v138
    s_nop 1
    v_permlane32_swap_b32 v9, v10
    v_rcp_f32 v9, v9
    s_nop 0
    v_mul_f32 v128, v128, v9
    v_mul_f32 v129, v129, v9
    v_mul_f32 v130, v130, v9
    v_mul_f32 v131, v131, v9
    v_mul_f32 v132, v132, v9
    v_mul_f32 v133, v133, v9
    v_mul_f32 v134, v134, v9
    v_mul_f32 v135, v135, v9
    v_mul_f32 v136, v136, v9
    v_mul_f32 v137, v137, v9
    v_cvt_pk_bf16_f32 v10, v136, v137
    v_cvt_pk_bf16_f32 v12, v128, v129
    v_cvt_pk_bf16_f32 v13, v130, v131
    v_cvt_pk_bf16_f32 v14, v132, v133
    v_cvt_pk_bf16_f32 v15, v134, v135
    buffer_store_dword v10, v6, s[8:11], s30 offen sc1
    buffer_store_dwordx4 v[12:15], v5, s[8:11], s30 offen sc1
    s_waitcnt lgkmcnt(0)
    s_barrier
    v_mov_b32 v9, 49152
    ds_read_b128 v[12:15], v9
    s_waitcnt lgkmcnt(0)
    v_or_b32 v12, v12, v13
    v_or3_b32 v12, v12, v14, v15
    s_nop 0
    v_readfirstlane_b32 s37, v12
    s_nop 3
    s_cmp_eq_u32 s37, 0
    s_cbranch_scc1 K2_FIN
    s_waitcnt vmcnt(0)
    s_mov_b32 s15, 1
    v_mov_b32 v149, 0x3f803f80
    v_mov_b32 v163, 0x3f803f80
    v_mov_b32 v177, 0x3f803f80
    v_mov_b32 v125, 0
    buffer_load_dwordx4 v[120:123], v1, s[8:11], s27 offen offset:0
    buffer_load_dword v124, v4, s[8:11], s28 offen offset:0
    v_mov_b32 v131, 0
    buffer_load_dwordx4 v[126:129], v1, s[8:11], s27 offen offset:1024
    buffer_load_dword v130, v4, s[8:11], s28 offen offset:128
    v_mov_b32 v137, 0
    buffer_load_dwordx4 v[132:135], v1, s[8:11], s27 offen offset:2048
    buffer_load_dword v136, v4, s[8:11], s28 offen offset:256
    v_mov_b32 v143, 0
    buffer_load_dwordx4 v[138:141], v1, s[8:11], s27 offen offset:3072
    buffer_load_dword v142, v4, s[8:11], s28 offen offset:384
    v_mov_b32 v9, 0xff7fffff
    v_mov_b32 v10, 0xff7fffff
    v_mov_b32 v11, 0xff7fffff
    v_mov_b32 v12, 0xff7fffff
    s_mov_b32 s37, s16
    s_mov_b32 s38, s20
    s_mov_b32 s40, 16
K2_FB_LOOP:
    buffer_load_dwordx4 v[144:147], v1, s[8:11], s37 offen
    buffer_load_dword v148, v2, s[8:11], s38 offen
    s_waitcnt vmcnt(0)
    v_mfma_f32_32x32x16_bf16 v[80:95], v[144:147], v[120:123], 0
    v_mfma_f32_32x32x8_bf16 v[80:95], v[148:149], v[124:125], v[80:95]
    s_nop 11
    v_max3_f32 v9, v9, v80, v81
    v_max3_f32 v9, v9, v82, v83
    v_max3_f32 v9, v9, v84, v85
    v_max3_f32 v9, v9, v86, v87
    v_max3_f32 v9, v9, v88, v89
    v_max3_f32 v9, v9, v90, v91
    v_max3_f32 v9, v9, v92, v93
    v_max3_f32 v9, v9, v94, v95
    v_mfma_f32_32x32x16_bf16 v[80:95], v[144:147], v[126:129], 0
    v_mfma_f32_32x32x8_bf16 v[80:95], v[148:149], v[130:131], v[80:95]
    s_nop 11
    v_max3_f32 v10, v10, v80, v81
    v_max3_f32 v10, v10, v82, v83
    v_max3_f32 v10, v10, v84, v85
    v_max3_f32 v10, v10, v86, v87
    v_max3_f32 v10, v10, v88, v89
    v_max3_f32 v10, v10, v90, v91
    v_max3_f32 v10, v10, v92, v93
    v_max3_f32 v10, v10, v94, v95
    v_mfma_f32_32x32x16_bf16 v[80:95], v[144:147], v[132:135], 0
    v_mfma_f32_32x32x8_bf16 v[80:95], v[148:149], v[136:137], v[80:95]
    s_nop 11
    v_max3_f32 v11, v11, v80, v81
    v_max3_f32 v11, v11, v82, v83
    v_max3_f32 v11, v11, v84, v85
    v_max3_f32 v11, v11, v86, v87
    v_max3_f32 v11, v11, v88, v89
    v_max3_f32 v11, v11, v90, v91
    v_max3_f32 v11, v11, v92, v93
    v_max3_f32 v11, v11, v94, v95
    v_mfma_f32_32x32x16_bf16 v[80:95], v[144:147], v[138:141], 0
    v_mfma_f32_32x32x8_bf16 v[80:95], v[148:149], v[142:143], v[80:95]
    s_nop 11
    v_max3_f32 v12, v12, v80, v81
    v_max3_f32 v12, v12, v82, v83
    v_max3_f32 v12, v12, v84, v85
    v_max3_f32 v12, v12, v86, v87
    v_max3_f32 v12, v12, v88, v89
    v_max3_f32 v12, v12, v90, v91
    v_max3_f32 v12, v12, v92, v93
    v_max3_f32 v12, v12, v94, v95
    s_add_u32 s37, s37, 1024
    s_add_u32 s38, s38, 128
    s_sub_u32 s40, s40, 1
    s_cmp_lg_u32 s40, 0
    s_cbranch_scc1 K2_FB_LOOP
    v_mov_b32 v13, v9
    s_nop 1
    v_permlane32_swap_b32 v9, v13
    v_max_f32 v9, v9, v13
    v_mov_b32 v13, v10
    s_nop 1
    v_permlane32_swap_b32 v10, v13
    v_max_f32 v10, v10, v13
    v_mov_b32 v13, v11
    s_nop 1
    v_permlane32_swap_b32 v11, v13
    v_max_f32 v11, v11, v13
    v_mov_b32 v13, v12
    s_nop 1
    v_permlane32_swap_b32 v12, v13
    v_max_f32 v12, v12, v13
    s_lshl_b32 s37, s14, 10
    v_add_u32 v13, s37, v1
    v_mov_b32 v80, v9
    v_mov_b32 v81, v10
    v_mov_b32 v82, v11
    v_mov_b32 v83, v12
    ds_write_b128 v13, v[80:83]
    s_waitcnt lgkmcnt(0)
    s_barrier
    ds_read_b128 v[96:99], v1 offset:0
    ds_read_b128 v[100:103], v1 offset:1024
    ds_read_b128 v[104:107], v1 offset:2048
    ds_read_b128 v[108:111], v1 offset:3072
    s_waitcnt lgkmcnt(0)
    v_max3_f32 v9, v96, v100, v104
    v_max_f32 v9, v9, v108
    v_max3_f32 v10, v97, v101, v105
    v_max_f32 v10, v10, v109
    v_max3_f32 v11, v98, v102, v106
    v_max_f32 v11, v11, v110
    v_max3_f32 v12, v99, v103, v107
    v_max_f32 v12, v12, v111
    v_sub_f32 v13, 0, v9
    v_and_b32 v14, 0xffff0000, v13
    v_sub_f32 v13, v13, v14
    v_cvt_pk_bf16_f32 v13, v14, v13
    v_cndmask_b32 v125, v125, v13, s[72:73]
    v_sub_f32 v13, 0, v10
    v_and_b32 v14, 0xffff0000, v13
    v_sub_f32 v13, v13, v14
    v_cvt_pk_bf16_f32 v13, v14, v13
    v_cndmask_b32 v131, v131, v13, s[72:73]
    v_sub_f32 v13, 0, v11
    v_and_b32 v14, 0xffff0000, v13
    v_sub_f32 v13, v13, v14
    v_cvt_pk_bf16_f32 v13, v14, v13
    v_cndmask_b32 v137, v137, v13, s[72:73]
    v_sub_f32 v13, 0, v12
    v_and_b32 v14, 0xffff0000, v13
    v_sub_f32 v13, v13, v14
    v_cvt_pk_bf16_f32 v13, v14, v13
    v_cndmask_b32 v143, v143, v13, s[72:73]
    s_barrier
    s_branch K2_A_START
K2_FIN:
K2_END:
    s_endpgm

.globl proj_kernel
    .p2align 8
    .type proj_kernel,@function
proj_kernel:
    s_cmp_ge_u32 s2, 256
    s_cbranch_scc1 K3_END
    s_load_dwordx2 s[10:11], s[0:1], 64
    s_load_dwordx2 s[8:9], s[0:1], 48
    v_lshrrev_b32 v1, 6, v0
    v_and_b32 v0, 63, v0
    v_readfirstlane_b32 s3, v1
    v_lshlrev_b32 v224, 4, v0
    s_bfe_u32 s12, s2, 0x10002
    s_and_b32 s15, s2, 3
    s_lshl_b32 s15, s15, 2
    s_bfe_u32 s13, s2, 0x20003
    s_or_b32 s13, s13, s15
    s_lshr_b32 s14, s2, 5
    s_lshl_b32 s35, s13, 2
    s_add_u32 s35, s35, s3
    s_mul_i32 s30, s35, 36864
    s_mul_i32 s16, s12, 2359296
    s_add_u32 s30, s30, s16
    s_add_u32 s30, s30, 14680064
    s_lshl_b32 s16, s12, 3
    s_add_u32 s16, s16, s14
    s_mul_i32 s32, s16, 82944
    s_lshl_b32 s33, s3, 10
    s_add_u32 s32, s32, s33
    s_add_u32 s32, s32, 19922944
    s_max_u32 s15, s3, 0
    s_sub_u32 s15, s15, 0
    s_lshl_b32 s15, s15, 10
    s_sub_u32 s36, s32, s15
    s_sub_u32 s37, s33, s15
    s_waitcnt lgkmcnt(0)
    s_mov_b32 s24, s10
    s_and_b32 s25, s11, 0xffff
    s_mov_b32 s26, 21397504
    s_mov_b32 s27, 0x00020000
    s_add_u32 m0, s33, 0
    s_add_u32 s34, s32, 0
    buffer_load_dwordx4 v224, s[24:27], s34 offen lds
    s_add_u32 m0, s33, 4096
    s_add_u32 s34, s32, 4096
    buffer_load_dwordx4 v224, s[24:27], s34 offen lds
    s_add_u32 s40, s30, 0
    buffer_load_dwordx4 v[0:3], v224, s[24:27], s40 offen offset:0
    s_add_u32 s41, s30, 16384
    buffer_load_dwordx4 v[4:7], v224, s[24:27], s41 offen offset:2048
    s_add_u32 m0, s33, 8192
    s_add_u32 s34, s32, 8192
    buffer_load_dwordx4 v224, s[24:27], s34 offen lds
    buffer_load_dwordx4 v[8:11], v224, s[24:27], s40 offen offset:1024
    s_add_u32 s41, s30, 16384
    buffer_load_dwordx4 v[12:15], v224, s[24:27], s41 offen offset:3072
    s_add_u32 m0, s33, 12288
    s_add_u32 s34, s32, 12288
    buffer_load_dwordx4 v224, s[24:27], s34 offen lds
    buffer_load_dwordx4 v[16:19], v224, s[24:27], s40 offen offset:2048
    s_add_u32 s41, s30, 20480
    buffer_load_dwordx4 v[20:23], v224, s[24:27], s41 offen offset:0
    s_add_u32 m0, s33, 16384
    s_add_u32 s34, s32, 16384
    buffer_load_dwordx4 v224, s[24:27], s34 offen lds
    buffer_load_dwordx4 v[24:27], v224, s[24:27], s40 offen offset:3072
    s_add_u32 s41, s30, 20480
    buffer_load_dwordx4 v[28:31], v224, s[24:27], s41 offen offset:1024
    s_add_u32 m0, s33, 20480
    s_add_u32 s34, s32, 20480
    buffer_load_dwordx4 v224, s[24:27], s34 offen lds
    s_add_u32 s40, s30, 4096
    buffer_load_dwordx4 v[32:35], v224, s[24:27], s40 offen offset:0
    s_add_u32 s41, s30, 20480
    buffer_load_dwordx4 v[36:39], v224, s[24:27], s41 offen offset:2048
    s_add_u32 m0, s33, 24576
    s_add_u32 s34, s32, 24576
    buffer_load_dwordx4 v224, s[24:27], s34 offen lds
    buffer_load_dwordx4 v[40:43], v224, s[24:27], s40 offen offset:1024
    s_add_u32 s41, s30, 20480
    buffer_load_dwordx4 v[44:47], v224, s[24:27], s41 offen offset:3072
    s_mul_i32 s31, s35, 73728
    s_mul_i32 s16, s12, 1152
    s_add_u32 s31, s31, s16
    s_mul_i32 s16, s14, 144
    s_add_u32 s31, s31, s16
    s_mov_b32 s44, s8
    s_and_b32 s45, s9, 0xffff
    s_mov_b32 s46, 4718592
    s_mov_b32 s47, 0x00020000
    v_add_u32 v227, 61440, v224
    v_and_b32 v234, 0x70, v224
    v_lshrrev_b32 v235, 8, v224
    v_lshl_add_u32 v234, v235, 7, v234
    v_add_u32 v235, 61440, v234
    s_waitcnt vmcnt(17)
    s_barrier
    ds_read_b128 v[184:187], v224 offset:0
    ds_read_b128 v[188:191], v224 offset:1024
    ds_read_b128 v[192:195], v224 offset:2048
    ds_read_b128 v[196:199], v224 offset:3072
    ds_read_b128 v[200:203], v234 offset:4096
    s_waitcnt vmcnt(15) lgkmcnt(0)
    s_waitcnt vmcnt(14)
    s_barrier
    v_mfma_f32_16x16x32_bf16 v[144:147], v[184:187], v[0:3], 0
    ds_read_b128 v[204:207], v224 offset:4608
    v_mfma_f32_16x16x32_bf16 v[148:151], v[184:187], v[4:7], 0
    ds_read_b128 v[208:211], v224 offset:5632
    s_add_u32 m0, s33, 28672
    s_add_u32 s34, s32, 28672
    buffer_load_dwordx4 v224, s[24:27], s34 offen lds
    v_mfma_f32_16x16x32_bf16 v[152:155], v[188:191], v[0:3], 0
    ds_read_b128 v[212:215], v224 offset:6656
    v_mfma_f32_16x16x32_bf16 v[156:159], v[188:191], v[4:7], 0
    ds_read_b128 v[216:219], v224 offset:7680
    buffer_load_dwordx4 v[48:51], v224, s[24:27], s40 offen offset:2048
    v_mfma_f32_16x16x32_bf16 v[160:163], v[192:195], v[0:3], 0
    ds_read_b128 v[220:223], v234 offset:8704
    v_mfma_f32_16x16x32_bf16 v[164:167], v[192:195], v[4:7], 0
    s_add_u32 s41, s30, 24576
    buffer_load_dwordx4 v[52:55], v224, s[24:27], s41 offen offset:0
    v_mfma_f32_16x16x32_bf16 v[168:171], v[196:199], v[0:3], 0
    v_mfma_f32_16x16x32_bf16 v[172:175], v[196:199], v[4:7], 0
    v_mfma_f32_16x16x32_bf16 v[176:179], v[200:203], v[0:3], 0
    v_mfma_f32_16x16x32_bf16 v[180:183], v[200:203], v[4:7], 0
    s_waitcnt vmcnt(15) lgkmcnt(0)
    s_waitcnt vmcnt(14)
    s_barrier
    v_mfma_f32_16x16x32_bf16 v[144:147], v[204:207], v[8:11], v[144:147]
    ds_read_b128 v[184:187], v224 offset:9216
    v_mfma_f32_16x16x32_bf16 v[148:151], v[204:207], v[12:15], v[148:151]
    ds_read_b128 v[188:191], v224 offset:10240
    s_add_u32 m0, s33, 32768
    s_add_u32 s34, s32, 32768
    buffer_load_dwordx4 v224, s[24:27], s34 offen lds
    v_mfma_f32_16x16x32_bf16 v[152:155], v[208:211], v[8:11], v[152:155]
    ds_read_b128 v[192:195], v224 offset:11264
    v_mfma_f32_16x16x32_bf16 v[156:159], v[208:211], v[12:15], v[156:159]
    ds_read_b128 v[196:199], v224 offset:12288
    buffer_load_dwordx4 v[56:59], v224, s[24:27], s40 offen offset:3072
    v_mfma_f32_16x16x32_bf16 v[160:163], v[212:215], v[8:11], v[160:163]
    ds_read_b128 v[200:203], v234 offset:13312
    v_mfma_f32_16x16x32_bf16 v[164:167], v[212:215], v[12:15], v[164:167]
    s_add_u32 s41, s30, 24576
    buffer_load_dwordx4 v[60:63], v224, s[24:27], s41 offen offset:1024
    v_mfma_f32_16x16x32_bf16 v[168:171], v[216:219], v[8:11], v[168:171]
    v_mfma_f32_16x16x32_bf16 v[172:175], v[216:219], v[12:15], v[172:175]
    v_mfma_f32_16x16x32_bf16 v[176:179], v[220:223], v[8:11], v[176:179]
    v_mfma_f32_16x16x32_bf16 v[180:183], v[220:223], v[12:15], v[180:183]
    s_waitcnt vmcnt(15) lgkmcnt(0)
    s_waitcnt vmcnt(14)
    s_barrier
    v_mfma_f32_16x16x32_bf16 v[144:147], v[184:187], v[16:19], v[144:147]
    ds_read_b128 v[204:207], v224 offset:13824
    v_mfma_f32_16x16x32_bf16 v[148:151], v[184:187], v[20:23], v[148:151]
    ds_read_b128 v[208:211], v224 offset:14848
    s_add_u32 m0, s33, 36864
    s_add_u32 s34, s32, 36864
    buffer_load_dwordx4 v224, s[24:27], s34 offen lds
    v_mfma_f32_16x16x32_bf16 v[152:155], v[188:191], v[16:19], v[152:155]
    ds_read_b128 v[212:215], v224 offset:15872
    v_mfma_f32_16x16x32_bf16 v[156:159], v[188:191], v[20:23], v[156:159]
    ds_read_b128 v[216:219], v224 offset:16896
    s_add_u32 m0, s33, 40960
    s_add_u32 s34, s32, 40960
    buffer_load_dwordx4 v224, s[24:27], s34 offen lds
    v_mfma_f32_16x16x32_bf16 v[160:163], v[192:195], v[16:19], v[160:163]
    ds_read_b128 v[220:223], v234 offset:17920
    v_mfma_f32_16x16x32_bf16 v[164:167], v[192:195], v[20:23], v[164:167]
    s_add_u32 s40, s30, 8192
    buffer_load_dwordx4 v[64:67], v224, s[24:27], s40 offen offset:0
    v_mfma_f32_16x16x32_bf16 v[168:171], v[196:199], v[16:19], v[168:171]
    v_mfma_f32_16x16x32_bf16 v[172:175], v[196:199], v[20:23], v[172:175]
    s_add_u32 s41, s30, 24576
    buffer_load_dwordx4 v[68:71], v224, s[24:27], s41 offen offset:2048
    v_mfma_f32_16x16x32_bf16 v[176:179], v[200:203], v[16:19], v[176:179]
    v_mfma_f32_16x16x32_bf16 v[180:183], v[200:203], v[20:23], v[180:183]
    s_waitcnt vmcnt(16) lgkmcnt(0)
    s_waitcnt vmcnt(15)
    s_barrier
    v_mfma_f32_16x16x32_bf16 v[144:147], v[204:207], v[24:27], v[144:147]
    ds_read_b128 v[184:187], v224 offset:18432
    v_mfma_f32_16x16x32_bf16 v[148:151], v[204:207], v[28:31], v[148:151]
    ds_read_b128 v[188:191], v224 offset:19456
    s_add_u32 m0, s33, 45056
    s_add_u32 s34, s32, 45056
    buffer_load_dwordx4 v224, s[24:27], s34 offen lds
    v_mfma_f32_16x16x32_bf16 v[152:155], v[208:211], v[24:27], v[152:155]
    ds_read_b128 v[192:195], v224 offset:20480
    v_mfma_f32_16x16x32_bf16 v[156:159], v[208:211], v[28:31], v[156:159]
    ds_read_b128 v[196:199], v224 offset:21504
    buffer_load_dwordx4 v[72:75], v224, s[24:27], s40 offen offset:1024
    v_mfma_f32_16x16x32_bf16 v[160:163], v[212:215], v[24:27], v[160:163]
    ds_read_b128 v[200:203], v234 offset:22528
    v_mfma_f32_16x16x32_bf16 v[164:167], v[212:215], v[28:31], v[164:167]
    s_add_u32 s41, s30, 24576
    buffer_load_dwordx4 v[76:79], v224, s[24:27], s41 offen offset:3072
    v_mfma_f32_16x16x32_bf16 v[168:171], v[216:219], v[24:27], v[168:171]
    v_mfma_f32_16x16x32_bf16 v[172:175], v[216:219], v[28:31], v[172:175]
    v_mfma_f32_16x16x32_bf16 v[176:179], v[220:223], v[24:27], v[176:179]
    v_mfma_f32_16x16x32_bf16 v[180:183], v[220:223], v[28:31], v[180:183]
    s_waitcnt vmcnt(16) lgkmcnt(0)
    s_waitcnt vmcnt(15)
    s_barrier
    v_mfma_f32_16x16x32_bf16 v[144:147], v[184:187], v[32:35], v[144:147]
    ds_read_b128 v[204:207], v224 offset:23040
    v_mfma_f32_16x16x32_bf16 v[148:151], v[184:187], v[36:39], v[148:151]
    ds_read_b128 v[208:211], v224 offset:24064
    s_add_u32 m0, s33, 49152
    s_add_u32 s34, s32, 49152
    buffer_load_dwordx4 v224, s[24:27], s34 offen lds
    v_mfma_f32_16x16x32_bf16 v[152:155], v[188:191], v[32:35], v[152:155]
    ds_read_b128 v[212:215], v224 offset:25088
    v_mfma_f32_16x16x32_bf16 v[156:159], v[188:191], v[36:39], v[156:159]
    ds_read_b128 v[216:219], v224 offset:26112
    buffer_load_dwordx4 v[80:83], v224, s[24:27], s40 offen offset:2048
    v_mfma_f32_16x16x32_bf16 v[160:163], v[192:195], v[32:35], v[160:163]
    ds_read_b128 v[220:223], v234 offset:27136
    v_mfma_f32_16x16x32_bf16 v[164:167], v[192:195], v[36:39], v[164:167]
    s_add_u32 s41, s30, 28672
    buffer_load_dwordx4 v[84:87], v224, s[24:27], s41 offen offset:0
    v_mfma_f32_16x16x32_bf16 v[168:171], v[196:199], v[32:35], v[168:171]
    v_mfma_f32_16x16x32_bf16 v[172:175], v[196:199], v[36:39], v[172:175]
    v_mfma_f32_16x16x32_bf16 v[176:179], v[200:203], v[32:35], v[176:179]
    v_mfma_f32_16x16x32_bf16 v[180:183], v[200:203], v[36:39], v[180:183]
    s_waitcnt vmcnt(16) lgkmcnt(0)
    s_waitcnt vmcnt(15)
    s_barrier
    v_mfma_f32_16x16x32_bf16 v[144:147], v[204:207], v[40:43], v[144:147]
    ds_read_b128 v[184:187], v224 offset:27648
    v_mfma_f32_16x16x32_bf16 v[148:151], v[204:207], v[44:47], v[148:151]
    ds_read_b128 v[188:191], v224 offset:28672
    s_add_u32 m0, s33, 53248
    s_add_u32 s34, s32, 53248
    buffer_load_dwordx4 v224, s[24:27], s34 offen lds
    v_mfma_f32_16x16x32_bf16 v[152:155], v[208:211], v[40:43], v[152:155]
    ds_read_b128 v[192:195], v224 offset:29696
    v_mfma_f32_16x16x32_bf16 v[156:159], v[208:211], v[44:47], v[156:159]
    ds_read_b128 v[196:199], v224 offset:30720
    buffer_load_dwordx4 v[88:91], v224, s[24:27], s40 offen offset:3072
    v_mfma_f32_16x16x32_bf16 v[160:163], v[212:215], v[40:43], v[160:163]
    ds_read_b128 v[200:203], v234 offset:31744
    v_mfma_f32_16x16x32_bf16 v[164:167], v[212:215], v[44:47], v[164:167]
    s_add_u32 s41, s30, 28672
    buffer_load_dwordx4 v[92:95], v224, s[24:27], s41 offen offset:1024
    v_mfma_f32_16x16x32_bf16 v[168:171], v[216:219], v[40:43], v[168:171]
    v_mfma_f32_16x16x32_bf16 v[172:175], v[216:219], v[44:47], v[172:175]
    v_mfma_f32_16x16x32_bf16 v[176:179], v[220:223], v[40:43], v[176:179]
    v_mfma_f32_16x16x32_bf16 v[180:183], v[220:223], v[44:47], v[180:183]
    s_waitcnt vmcnt(16) lgkmcnt(0)
    s_waitcnt vmcnt(15)
    s_barrier
    v_mfma_f32_16x16x32_bf16 v[144:147], v[184:187], v[48:51], v[144:147]
    ds_read_b128 v[204:207], v224 offset:32256
    v_mfma_f32_16x16x32_bf16 v[148:151], v[184:187], v[52:55], v[148:151]
    ds_read_b128 v[208:211], v224 offset:33280
    s_add_u32 m0, s33, 57344
    s_add_u32 s34, s32, 57344
    buffer_load_dwordx4 v224, s[24:27], s34 offen lds
    v_mfma_f32_16x16x32_bf16 v[152:155], v[188:191], v[48:51], v[152:155]
    ds_read_b128 v[212:215], v224 offset:34304
    v_mfma_f32_16x16x32_bf16 v[156:159], v[188:191], v[52:55], v[156:159]
    ds_read_b128 v[216:219], v224 offset:35328
    s_add_u32 s40, s30, 12288
    buffer_load_dwordx4 v[96:99], v224, s[24:27], s40 offen offset:0
    v_mfma_f32_16x16x32_bf16 v[160:163], v[192:195], v[48:51], v[160:163]
    ds_read_b128 v[220:223], v234 offset:36352
    v_mfma_f32_16x16x32_bf16 v[164:167], v[192:195], v[52:55], v[164:167]
    s_add_u32 s41, s30, 28672
    buffer_load_dwordx4 v[100:103], v224, s[24:27], s41 offen offset:2048
    v_mfma_f32_16x16x32_bf16 v[168:171], v[196:199], v[48:51], v[168:171]
    v_mfma_f32_16x16x32_bf16 v[172:175], v[196:199], v[52:55], v[172:175]
    v_mfma_f32_16x16x32_bf16 v[176:179], v[200:203], v[48:51], v[176:179]
    v_mfma_f32_16x16x32_bf16 v[180:183], v[200:203], v[52:55], v[180:183]
    s_waitcnt vmcnt(16) lgkmcnt(0)
    s_waitcnt vmcnt(14)
    s_barrier
    v_mfma_f32_16x16x32_bf16 v[144:147], v[204:207], v[56:59], v[144:147]
    ds_read_b128 v[184:187], v224 offset:36864
    v_mfma_f32_16x16x32_bf16 v[148:151], v[204:207], v[60:63], v[148:151]
    ds_read_b128 v[188:191], v224 offset:37888
    s_add_u32 m0, s33, 61440
    s_add_u32 s34, s32, 61440
    buffer_load_dwordx4 v224, s[24:27], s34 offen lds
    v_mfma_f32_16x16x32_bf16 v[152:155], v[208:211], v[56:59], v[152:155]
    ds_read_b128 v[192:195], v224 offset:38912
    v_mfma_f32_16x16x32_bf16 v[156:159], v[208:211], v[60:63], v[156:159]
    ds_read_b128 v[196:199], v224 offset:39936
    buffer_load_dwordx4 v[104:107], v224, s[24:27], s40 offen offset:1024
    v_mfma_f32_16x16x32_bf16 v[160:163], v[212:215], v[56:59], v[160:163]
    ds_read_b128 v[200:203], v234 offset:40960
    v_mfma_f32_16x16x32_bf16 v[164:167], v[212:215], v[60:63], v[164:167]
    s_add_u32 s41, s30, 28672
    buffer_load_dwordx4 v[108:111], v224, s[24:27], s41 offen offset:3072
    v_mfma_f32_16x16x32_bf16 v[168:171], v[216:219], v[56:59], v[168:171]
    v_mfma_f32_16x16x32_bf16 v[172:175], v[216:219], v[60:63], v[172:175]
    v_mfma_f32_16x16x32_bf16 v[176:179], v[220:223], v[56:59], v[176:179]
    v_mfma_f32_16x16x32_bf16 v[180:183], v[220:223], v[60:63], v[180:183]
    s_waitcnt vmcnt(15) lgkmcnt(0)
    s_waitcnt vmcnt(14)
    s_barrier
    v_mfma_f32_16x16x32_bf16 v[144:147], v[184:187], v[64:67], v[144:147]
    ds_read_b128 v[204:207], v224 offset:41472
    v_mfma_f32_16x16x32_bf16 v[148:151], v[184:187], v[68:71], v[148:151]
    ds_read_b128 v[208:211], v224 offset:42496
    s_add_u32 m0, s33, 65536
    s_add_u32 s34, s32, 65536
    buffer_load_dwordx4 v224, s[24:27], s34 offen lds
    v_mfma_f32_16x16x32_bf16 v[152:155], v[188:191], v[64:67], v[152:155]
    ds_read_b128 v[212:215], v224 offset:43520
    v_mfma_f32_16x16x32_bf16 v[156:159], v[188:191], v[68:71], v[156:159]
    ds_read_b128 v[216:219], v224 offset:44544
    buffer_load_dwordx4 v[112:115], v224, s[24:27], s40 offen offset:2048
    v_mfma_f32_16x16x32_bf16 v[160:163], v[192:195], v[64:67], v[160:163]
    ds_read_b128 v[220:223], v234 offset:45568
    v_mfma_f32_16x16x32_bf16 v[164:167], v[192:195], v[68:71], v[164:167]
    s_add_u32 s41, s30, 32768
    buffer_load_dwordx4 v[116:119], v224, s[24:27], s41 offen offset:0
    v_mfma_f32_16x16x32_bf16 v[168:171], v[196:199], v[64:67], v[168:171]
    v_mfma_f32_16x16x32_bf16 v[172:175], v[196:199], v[68:71], v[172:175]
    v_mfma_f32_16x16x32_bf16 v[176:179], v[200:203], v[64:67], v[176:179]
    v_mfma_f32_16x16x32_bf16 v[180:183], v[200:203], v[68:71], v[180:183]
    s_mul_i32 s15, s3, 4608
    v_bfe_u32 v228, v224, 4, 4
    v_lshrrev_b32 v229, 8, v224
    v_mul_u32_u24 v228, 144, v228
    v_lshl_add_u32 v228, v229, 3, v228
    v_add_u32 v245, s15, v228
    v_add_u32 v246, s15, v224
    v_lshrrev_b32 v228, 4, v224
    v_add_u32 v228, 0, v228
    v_mul_u32_u24 v229, 7282, v228
    v_lshrrev_b32 v229, 16, v229
    v_mul_u32_u24 v229, 2160, v229
    v_lshl_add_u32 v240, v228, 4, v229
    v_lshrrev_b32 v228, 4, v224
    v_add_u32 v228, 64, v228
    v_mul_u32_u24 v229, 7282, v228
    v_lshrrev_b32 v229, 16, v229
    v_mul_u32_u24 v229, 2160, v229
    v_lshl_add_u32 v241, v228, 4, v229
    v_lshrrev_b32 v228, 4, v224
    v_add_u32 v228, 128, v228
    v_mul_u32_u24 v229, 7282, v228
    v_lshrrev_b32 v229, 16, v229
    v_mul_u32_u24 v229, 2160, v229
    v_lshl_add_u32 v242, v228, 4, v229
    v_lshrrev_b32 v228, 4, v224
    v_add_u32 v228, 192, v228
    v_mul_u32_u24 v229, 7282, v228
    v_lshrrev_b32 v229, 16, v229
    v_mul_u32_u24 v229, 2160, v229
    v_lshl_add_u32 v243, v228, 4, v229
    v_lshrrev_b32 v228, 4, v224
    v_add_u32 v228, 256, v228
    v_mul_u32_u24 v229, 7282, v228
    v_lshrrev_b32 v229, 16, v229
    v_mul_u32_u24 v229, 2160, v229
    v_lshl_add_u32 v244, v228, 4, v229
    v_bfrev_b32 v228, 1
    v_cmp_gt_u32 vcc, 0x200, v224
    s_nop 1
    v_cndmask_b32 v244, v228, v244, vcc
    s_mov_b32 s50, -1
    s_mov_b32 s51, 0
    s_waitcnt vmcnt(15) lgkmcnt(0)
    s_waitcnt vmcnt(14)
    s_barrier
    v_mfma_f32_16x16x32_bf16 v[144:147], v[204:207], v[72:75], v[144:147]
    ds_read_b128 v[184:187], v224 offset:46080
    v_mfma_f32_16x16x32_bf16 v[148:151], v[204:207], v[76:79], v[148:151]
    ds_read_b128 v[188:191], v224 offset:47104
    s_add_u32 m0, s33, 69632
    s_add_u32 s34, s32, 69632
    buffer_load_dwordx4 v224, s[24:27], s34 offen lds
    v_mfma_f32_16x16x32_bf16 v[152:155], v[208:211], v[72:75], v[152:155]
    ds_read_b128 v[192:195], v224 offset:48128
    v_mfma_f32_16x16x32_bf16 v[156:159], v[208:211], v[76:79], v[156:159]
    ds_read_b128 v[196:199], v224 offset:49152
    buffer_load_dwordx4 v[120:123], v224, s[24:27], s40 offen offset:3072
    v_mfma_f32_16x16x32_bf16 v[160:163], v[212:215], v[72:75], v[160:163]
    ds_read_b128 v[200:203], v234 offset:50176
    v_mfma_f32_16x16x32_bf16 v[164:167], v[212:215], v[76:79], v[164:167]
    s_add_u32 s41, s30, 32768
    buffer_load_dwordx4 v[124:127], v224, s[24:27], s41 offen offset:1024
    v_mfma_f32_16x16x32_bf16 v[168:171], v[216:219], v[72:75], v[168:171]
    v_mfma_f32_16x16x32_bf16 v[172:175], v[216:219], v[76:79], v[172:175]
    v_mfma_f32_16x16x32_bf16 v[176:179], v[220:223], v[72:75], v[176:179]
    v_mfma_f32_16x16x32_bf16 v[180:183], v[220:223], v[76:79], v[180:183]
    s_waitcnt vmcnt(15) lgkmcnt(0)
    s_waitcnt vmcnt(14)
    s_barrier
    v_mfma_f32_16x16x32_bf16 v[144:147], v[184:187], v[80:83], v[144:147]
    ds_read_b128 v[204:207], v224 offset:50688
    v_mfma_f32_16x16x32_bf16 v[148:151], v[184:187], v[84:87], v[148:151]
    ds_read_b128 v[208:211], v224 offset:51712
    s_add_u32 m0, s33, 73728
    s_add_u32 s34, s32, 73728
    buffer_load_dwordx4 v224, s[24:27], s34 offen lds
    v_mfma_f32_16x16x32_bf16 v[152:155], v[188:191], v[80:83], v[152:155]
    ds_read_b128 v[212:215], v224 offset:52736
    v_mfma_f32_16x16x32_bf16 v[156:159], v[188:191], v[84:87], v[156:159]
    ds_read_b128 v[216:219], v224 offset:53760
    s_add_u32 m0, s33, 77824
    s_add_u32 s34, s32, 77824
    buffer_load_dwordx4 v224, s[24:27], s34 offen lds
    v_mfma_f32_16x16x32_bf16 v[160:163], v[192:195], v[80:83], v[160:163]
    ds_read_b128 v[220:223], v234 offset:54784
    v_mfma_f32_16x16x32_bf16 v[164:167], v[192:195], v[84:87], v[164:167]
    s_add_u32 s40, s30, 16384
    buffer_load_dwordx4 v[128:131], v224, s[24:27], s40 offen offset:0
    v_mfma_f32_16x16x32_bf16 v[168:171], v[196:199], v[80:83], v[168:171]
    v_mfma_f32_16x16x32_bf16 v[172:175], v[196:199], v[84:87], v[172:175]
    s_add_u32 s41, s30, 32768
    buffer_load_dwordx4 v[132:135], v224, s[24:27], s41 offen offset:2048
    v_mfma_f32_16x16x32_bf16 v[176:179], v[200:203], v[80:83], v[176:179]
    v_mfma_f32_16x16x32_bf16 v[180:183], v[200:203], v[84:87], v[180:183]
    s_waitcnt vmcnt(16) lgkmcnt(0)
    s_waitcnt vmcnt(15)
    s_barrier
    v_mfma_f32_16x16x32_bf16 v[144:147], v[204:207], v[88:91], v[144:147]
    ds_read_b128 v[184:187], v224 offset:55296
    v_mfma_f32_16x16x32_bf16 v[148:151], v[204:207], v[92:95], v[148:151]
    ds_read_b128 v[188:191], v224 offset:56320
    s_add_u32 m0, s37, 81920
    s_add_u32 s34, s36, 81920
    buffer_load_dwordx4 v224, s[24:27], s34 offen lds
    v_mfma_f32_16x16x32_bf16 v[152:155], v[208:211], v[88:91], v[152:155]
    ds_read_b128 v[192:195], v224 offset:57344
    v_mfma_f32_16x16x32_bf16 v[156:159], v[208:211], v[92:95], v[156:159]
    ds_read_b128 v[196:199], v224 offset:58368
    buffer_load_dwordx4 v[136:139], v224, s[24:27], s40 offen offset:1024
    v_mfma_f32_16x16x32_bf16 v[160:163], v[212:215], v[88:91], v[160:163]
    ds_read_b128 v[200:203], v234 offset:59392
    v_mfma_f32_16x16x32_bf16 v[164:167], v[212:215], v[92:95], v[164:167]
    s_add_u32 s41, s30, 32768
    buffer_load_dwordx4 v[140:143], v224, s[24:27], s41 offen offset:3072
    v_mfma_f32_16x16x32_bf16 v[168:171], v[216:219], v[88:91], v[168:171]
    v_mfma_f32_16x16x32_bf16 v[172:175], v[216:219], v[92:95], v[172:175]
    v_mfma_f32_16x16x32_bf16 v[176:179], v[220:223], v[88:91], v[176:179]
    v_mfma_f32_16x16x32_bf16 v[180:183], v[220:223], v[92:95], v[180:183]
    s_waitcnt vmcnt(16) lgkmcnt(0)
    s_waitcnt vmcnt(15)
    s_barrier
    v_mfma_f32_16x16x32_bf16 v[144:147], v[184:187], v[96:99], v[144:147]
    ds_read_b128 v[204:207], v224 offset:59904
    v_mfma_f32_16x16x32_bf16 v[148:151], v[184:187], v[100:103], v[148:151]
    ds_read_b128 v[208:211], v224 offset:60928
    v_mfma_f32_16x16x32_bf16 v[152:155], v[188:191], v[96:99], v[152:155]
    ds_read_b128 v[212:215], v224 offset:61952
    v_mfma_f32_16x16x32_bf16 v[156:159], v[188:191], v[100:103], v[156:159]
    ds_read_b128 v[216:219], v224 offset:62976
    v_mfma_f32_16x16x32_bf16 v[160:163], v[192:195], v[96:99], v[160:163]
    ds_read_b128 v[220:223], v234 offset:64000
    v_mfma_f32_16x16x32_bf16 v[164:167], v[192:195], v[100:103], v[164:167]
    v_mfma_f32_16x16x32_bf16 v[168:171], v[196:199], v[96:99], v[168:171]
    v_mfma_f32_16x16x32_bf16 v[172:175], v[196:199], v[100:103], v[172:175]
    v_mfma_f32_16x16x32_bf16 v[176:179], v[200:203], v[96:99], v[176:179]
    v_mfma_f32_16x16x32_bf16 v[180:183], v[200:203], v[100:103], v[180:183]
    s_waitcnt vmcnt(13) lgkmcnt(0)
    s_waitcnt vmcnt(12)
    s_barrier
    v_mfma_f32_16x16x32_bf16 v[144:147], v[204:207], v[104:107], v[144:147]
    ds_read_b128 v[184:187], v224 offset:64512
    v_mfma_f32_16x16x32_bf16 v[148:151], v[204:207], v[108:111], v[148:151]
    ds_read_b128 v[188:191], v227 offset:4096
    v_mfma_f32_16x16x32_bf16 v[152:155], v[208:211], v[104:107], v[152:155]
    ds_read_b128 v[192:195], v227 offset:5120
    v_mfma_f32_16x16x32_bf16 v[156:159], v[208:211], v[108:111], v[156:159]
    ds_read_b128 v[196:199], v227 offset:6144
    v_mfma_f32_16x16x32_bf16 v[160:163], v[212:215], v[104:107], v[160:163]
    ds_read_b128 v[200:203], v235 offset:7168
    v_mfma_f32_16x16x32_bf16 v[164:167], v[212:215], v[108:111], v[164:167]
    v_mfma_f32_16x16x32_bf16 v[168:171], v[216:219], v[104:107], v[168:171]
    v_mfma_f32_16x16x32_bf16 v[172:175], v[216:219], v[108:111], v[172:175]
    v_mfma_f32_16x16x32_bf16 v[176:179], v[220:223], v[104:107], v[176:179]
    v_mfma_f32_16x16x32_bf16 v[180:183], v[220:223], v[108:111], v[180:183]
    s_waitcnt vmcnt(10) lgkmcnt(0)
    s_waitcnt vmcnt(9)
    s_barrier
    v_mfma_f32_16x16x32_bf16 v[144:147], v[184:187], v[112:115], v[144:147]
    ds_read_b128 v[204:207], v227 offset:7680
    v_mfma_f32_16x16x32_bf16 v[148:151], v[184:187], v[116:119], v[148:151]
    ds_read_b128 v[208:211], v227 offset:8704
    v_mfma_f32_16x16x32_bf16 v[152:155], v[188:191], v[112:115], v[152:155]
    ds_read_b128 v[212:215], v227 offset:9728
    v_mfma_f32_16x16x32_bf16 v[156:159], v[188:191], v[116:119], v[156:159]
    ds_read_b128 v[216:219], v227 offset:10752
    v_mfma_f32_16x16x32_bf16 v[160:163], v[192:195], v[112:115], v[160:163]
    ds_read_b128 v[220:223], v235 offset:11776
    v_mfma_f32_16x16x32_bf16 v[164:167], v[192:195], v[116:119], v[164:167]
    v_mfma_f32_16x16x32_bf16 v[168:171], v[196:199], v[112:115], v[168:171]
    v_mfma_f32_16x16x32_bf16 v[172:175], v[196:199], v[116:119], v[172:175]
    v_mfma_f32_16x16x32_bf16 v[176:179], v[200:203], v[112:115], v[176:179]
    v_mfma_f32_16x16x32_bf16 v[180:183], v[200:203], v[116:119], v[180:183]
    s_waitcnt vmcnt(7) lgkmcnt(0)
    s_waitcnt vmcnt(5)
    s_barrier
    v_mfma_f32_16x16x32_bf16 v[144:147], v[204:207], v[120:123], v[144:147]
    ds_read_b128 v[184:187], v227 offset:12288
    v_mfma_f32_16x16x32_bf16 v[148:151], v[204:207], v[124:127], v[148:151]
    ds_read_b128 v[188:191], v227 offset:13312
    v_mfma_f32_16x16x32_bf16 v[152:155], v[208:211], v[120:123], v[152:155]
    ds_read_b128 v[192:195], v227 offset:14336
    v_mfma_f32_16x16x32_bf16 v[156:159], v[208:211], v[124:127], v[156:159]
    ds_read_b128 v[196:199], v227 offset:15360
    v_mfma_f32_16x16x32_bf16 v[160:163], v[212:215], v[120:123], v[160:163]
    ds_read_b128 v[200:203], v235 offset:16384
    v_mfma_f32_16x16x32_bf16 v[164:167], v[212:215], v[124:127], v[164:167]
    v_mfma_f32_16x16x32_bf16 v[168:171], v[216:219], v[120:123], v[168:171]
    v_mfma_f32_16x16x32_bf16 v[172:175], v[216:219], v[124:127], v[172:175]
    v_mfma_f32_16x16x32_bf16 v[176:179], v[220:223], v[120:123], v[176:179]
    v_mfma_f32_16x16x32_bf16 v[180:183], v[220:223], v[124:127], v[180:183]
    s_waitcnt vmcnt(3) lgkmcnt(0)
    s_waitcnt vmcnt(2)
    s_barrier
    v_mfma_f32_16x16x32_bf16 v[144:147], v[184:187], v[128:131], v[144:147]
    ds_read_b128 v[204:207], v227 offset:16896
    v_mfma_f32_16x16x32_bf16 v[148:151], v[184:187], v[132:135], v[148:151]
    ds_read_b128 v[208:211], v227 offset:17920
    v_mfma_f32_16x16x32_bf16 v[152:155], v[188:191], v[128:131], v[152:155]
    ds_read_b128 v[212:215], v227 offset:18944
    v_mfma_f32_16x16x32_bf16 v[156:159], v[188:191], v[132:135], v[156:159]
    ds_read_b128 v[216:219], v227 offset:19968
    v_mfma_f32_16x16x32_bf16 v[160:163], v[192:195], v[128:131], v[160:163]
    ds_read_b128 v[220:223], v235 offset:20992
    v_mfma_f32_16x16x32_bf16 v[164:167], v[192:195], v[132:135], v[164:167]
    v_mfma_f32_16x16x32_bf16 v[168:171], v[196:199], v[128:131], v[168:171]
    v_mfma_f32_16x16x32_bf16 v[172:175], v[196:199], v[132:135], v[172:175]
    v_mfma_f32_16x16x32_bf16 v[176:179], v[200:203], v[128:131], v[176:179]
    v_mfma_f32_16x16x32_bf16 v[180:183], v[200:203], v[132:135], v[180:183]
    s_waitcnt vmcnt(0) lgkmcnt(0)
    v_mfma_f32_16x16x32_bf16 v[144:147], v[204:207], v[136:139], v[144:147]
    v_mfma_f32_16x16x32_bf16 v[148:151], v[204:207], v[140:143], v[148:151]
    v_mfma_f32_16x16x32_bf16 v[152:155], v[208:211], v[136:139], v[152:155]
    v_mfma_f32_16x16x32_bf16 v[156:159], v[208:211], v[140:143], v[156:159]
    s_nop 4
    v_cvt_pk_bf16_f32 v228, v144, v145
    v_cvt_pk_bf16_f32 v229, v146, v147
    v_cvt_pk_bf16_f32 v230, v148, v149
    v_cvt_pk_bf16_f32 v231, v150, v151
    ds_write_b64 v245, v[228:229] offset:0
    ds_write_b64 v245, v[230:231] offset:2304
    v_mfma_f32_16x16x32_bf16 v[160:163], v[212:215], v[136:139], v[160:163]
    v_mfma_f32_16x16x32_bf16 v[164:167], v[212:215], v[140:143], v[164:167]
    v_cvt_pk_bf16_f32 v232, v152, v153
    v_cvt_pk_bf16_f32 v233, v154, v155
    v_cvt_pk_bf16_f32 v234, v156, v157
    v_cvt_pk_bf16_f32 v235, v158, v159
    ds_write_b64 v245, v[232:233] offset:32
    ds_write_b64 v245, v[234:235] offset:2336
    v_mfma_f32_16x16x32_bf16 v[168:171], v[216:219], v[136:139], v[168:171]
    v_mfma_f32_16x16x32_bf16 v[172:175], v[216:219], v[140:143], v[172:175]
    v_cvt_pk_bf16_f32 v236, v160, v161
    v_cvt_pk_bf16_f32 v237, v162, v163
    v_cvt_pk_bf16_f32 v238, v164, v165
    v_cvt_pk_bf16_f32 v239, v166, v167
    ds_write_b64 v245, v[236:237] offset:64
    ds_write_b64 v245, v[238:239] offset:2368
    v_mfma_f32_16x16x32_bf16 v[176:179], v[220:223], v[136:139], v[176:179]
    v_mfma_f32_16x16x32_bf16 v[180:183], v[220:223], v[140:143], v[180:183]
    v_cvt_pk_bf16_f32 v228, v168, v169
    v_cvt_pk_bf16_f32 v229, v170, v171
    v_cvt_pk_bf16_f32 v230, v172, v173
    v_cvt_pk_bf16_f32 v231, v174, v175
    ds_write_b64 v245, v[228:229] offset:96
    ds_write_b64 v245, v[230:231] offset:2400
    s_nop 7
    v_cvt_pk_bf16_f32 v232, v176, v177
    v_cvt_pk_bf16_f32 v233, v178, v179
    v_cvt_pk_bf16_f32 v234, v180, v181
    v_cvt_pk_bf16_f32 v235, v182, v183
    s_mov_b64 exec, s[50:51]
    ds_write_b64 v245, v[232:233] offset:128
    ds_write_b64 v245, v[234:235] offset:2432
    s_mov_b64 exec, -1
    s_waitcnt lgkmcnt(0)
    ds_read_b128 v[0:3], v246 offset:0
    ds_read_b128 v[4:7], v246 offset:1024
    ds_read_b128 v[8:11], v246 offset:2048
    ds_read_b128 v[12:15], v246 offset:3072
    ds_read_b128 v[16:19], v246 offset:4096
    s_waitcnt lgkmcnt(4)
    buffer_store_dwordx4 v[0:3], v240, s[44:47], s31 offen
    s_waitcnt lgkmcnt(3)
    buffer_store_dwordx4 v[4:7], v241, s[44:47], s31 offen
    s_waitcnt lgkmcnt(2)
    buffer_store_dwordx4 v[8:11], v242, s[44:47], s31 offen
    s_waitcnt lgkmcnt(1)
    buffer_store_dwordx4 v[12:15], v243, s[44:47], s31 offen
    s_waitcnt lgkmcnt(0)
    buffer_store_dwordx4 v[16:19], v244, s[44:47], s31 offen
K3_END:
    s_endpgm

.section .rodata,"a"
.p2align 6
.amdhsa_kernel qkv_kernel
  .amdhsa_next_free_vgpr 240
  .amdhsa_next_free_sgpr 102
  .amdhsa_accum_offset 240
  .amdhsa_group_segment_fixed_size 0
  .amdhsa_kernarg_size 72
  .amdhsa_user_sgpr_count 2
  .amdhsa_user_sgpr_kernarg_segment_ptr 1
  .amdhsa_system_sgpr_workgroup_id_x 1
  .amdhsa_float_denorm_mode_32 3
.end_amdhsa_kernel
.p2align 6
.amdhsa_kernel attn_kernel
  .amdhsa_next_free_vgpr 248
  .amdhsa_next_free_sgpr 102
  .amdhsa_accum_offset 248
  .amdhsa_group_segment_fixed_size 0
  .amdhsa_kernarg_size 72
  .amdhsa_user_sgpr_count 2
  .amdhsa_user_sgpr_kernarg_segment_ptr 1
  .amdhsa_system_sgpr_workgroup_id_x 1
  .amdhsa_float_denorm_mode_32 3
.end_amdhsa_kernel
.p2align 6
.amdhsa_kernel proj_kernel
  .amdhsa_next_free_vgpr 248
  .amdhsa_next_free_sgpr 102
  .amdhsa_accum_offset 248
  .amdhsa_group_segment_fixed_size 0
  .amdhsa_kernarg_size 72
  .amdhsa_user_sgpr_count 2
  .amdhsa_user_sgpr_kernarg_segment_ptr 1
  .amdhsa_system_sgpr_workgroup_id_x 1
  .amdhsa_float_denorm_mode_32 3
.end_amdhsa_kernel
```
